```python
import torch

def _softmax(x, axis=-1):
    return torch.softmax(x, dim=axis)

def _gelu(x):
    return torch.nn.functional.gelu(x, approximate='tanh')

def _silu(x):
    return torch.nn.functional.silu(x)

def _sigmoid(x):
    return torch.sigmoid(x)

def _layernorm(x, axis=-1, eps=1e-05):
    m = x.mean(dim=axis, keepdim=True)
    v = x.var(dim=axis, keepdim=True, unbiased=False)
    return (x - m) / torch.sqrt(v + eps)

def _scatter_add(tgt, idx, src, axis=0):
    return tgt.clone().index_add_(axis, idx, src)

def _segment_sum(src, seg, n):
    out = torch.zeros((n,) + src.shape[1:], dtype=src.dtype)
    return out.index_add_(0, seg, src)

def _pad(x, pw):
    flat = tuple((v for pair in reversed(pw) for v in pair))
    return torch.nn.functional.pad(x, flat)
kernel_name = 'parallel_sum__ssm_conv_s4d__mixer_gmlp__prompt'

def setup_inputs():

    _w = lambda a: (lambda t: t.to(torch.bfloat16) if t.is_floating_point() else t)(torch.as_tensor(a))

    def _A_setup():
        Bsz, L, D, N = (1, 2048, 448, 256)
        return {'u': _w((lambda *s: torch.randn(*s, dtype=torch.bfloat16) * 0.05)(Bsz, L, D)), 'log_A_real': _w((lambda *s: torch.randn(*s, dtype=torch.bfloat16) * 12.8)(D, N) * 0.5), 'A_imag': _w((lambda *s: torch.randn(*s, dtype=torch.bfloat16) * 0.1)(D, N) * 3.14), 'C_real': _w((lambda *s: torch.randn(*s, dtype=torch.bfloat16) * 3.2)(D, N) / N ** 0.5), 'C_imag': _w((lambda *s: torch.randn(*s, dtype=torch.bfloat16) * 3.2)(D, N) / N ** 0.5), 'log_dt': _w((lambda *s: torch.randn(*s, dtype=torch.bfloat16) * 0.1)(D) * 0.5 - 4.0), 'D_skip': _w((lambda *s: torch.randn(*s, dtype=torch.bfloat16) * 0.8)(D))}
    _A_in = _A_setup()

    def _B_setup():
        B, S, D, F = (1, 2048, 448, 1792)
        Fh = F // 2
        return {'x': _w((lambda *s: torch.randn(*s, dtype=torch.bfloat16) * 0.05)(B, S, D)), 'w_in': _w((lambda *s: torch.randn(*s, dtype=torch.bfloat16) * 0.4)(D, 2 * Fh)), 'w_sp': _w(0.01 * (lambda *s: torch.randn(*s, dtype=torch.bfloat16) * 0.4)(S, S)), 'b_sp': _w(1.0 + 0.01 * (lambda *s: torch.randn(*s, dtype=torch.bfloat16) * 0.05)(S)), 'w_out': _w((lambda *s: torch.randn(*s, dtype=torch.bfloat16) * 0.05)(Fh, D))}
    _B_in = _B_setup()
    return {'A_u': _A_in['u'], 'A_log_A_real': _A_in['log_A_real'], 'A_A_imag': _A_in['A_imag'], 'A_C_real': _A_in['C_real'], 'A_C_imag': _A_in['C_imag'], 'A_log_dt': _A_in['log_dt'], 'A_D_skip': _A_in['D_skip'], 'B_x': _B_in['x'], 'B_w_in': _B_in['w_in'], 'B_w_sp': _B_in['w_sp'], 'B_b_sp': _B_in['b_sp'], 'B_w_out': _B_in['w_out']}

def reference(A_u, A_log_A_real, A_A_imag, A_C_real, A_C_imag, A_log_dt, A_D_skip, B_x, B_w_in, B_w_sp, B_b_sp, B_w_out):

    def _A_ref(u, log_A_real, A_imag, C_real, C_imag, log_dt, D_skip):
        L = u.shape[1]
        dt = torch.exp(log_dt)
        A = -torch.exp(log_A_real) + 1j * A_imag
        C = (C_real + 1j * C_imag) * dt[:, None]
        pos = (lambda x, dt: x.to(dt))(torch.arange(L), log_dt.dtype)
        P = torch.exp((A * dt[:, None])[:, :, None] * pos[None, None, :])
        K = 2.0 * torch.einsum('dn,dnl->dl', C, P).real
        L2 = 2 * L
        u_t = (lambda x, *d: x.permute(*d))(u, 0, 2, 1)
        Kf = (lambda x, *a, **k: torch.fft.rfft(x.float(), *a, **k))(K, L2)
        Uf = (lambda x, *a, **k: torch.fft.rfft(x.float(), *a, **k))(u_t, L2)
        y = (lambda x, *a, **k: torch.fft.irfft(x, *a, **k).to(torch.bfloat16))(Uf * Kf[None, :, :], L2)[:, :, :L]
        y = (lambda x, *d: x.permute(*d))(y, 0, 2, 1)
        return y + u * D_skip[None, None, :]

    def _B_ref(x, w_in, w_sp, b_sp, w_out):
        B, S, D = x.shape
        F = w_in.shape[-1]
        Fh = F // 2
        z = _gelu(torch.einsum('bsd,df->bsf', x, w_in))
        z1 = z[..., :Fh].clone()
        z2 = _layernorm(z[..., Fh:], axis=-1)
        g = torch.einsum('ts,bsf->btf', w_sp, z2) + b_sp[None, :, None]
        return torch.einsum('bsf,fd->bsd', z1 * g, w_out)
    x = A_u
    xn = _layernorm(x, axis=-1)
    return x + _A_ref(xn, A_log_A_real, A_A_imag, A_C_real, A_C_imag, A_log_dt, A_D_skip) + _B_ref(xn, B_w_in, B_w_sp, B_b_sp, B_w_out)
```

```asm
; @launch kernel=gf_kernel grid=(256,1,1) block=(512,1,1) lds=159232
.amdgcn_target "amdgcn-amd-amdhsa--gfx950"
.text
.globl gf_kernel
.p2align 8
.type gf_kernel,@function
gf_kernel:
    s_cmp_ge_u32 s2, 256
    s_cbranch_scc1 gf_kernel_end
    s_load_dwordx2 s[4:5], s[0:1], 0
    s_load_dwordx2 s[6:7], s[0:1], 64
    s_load_dwordx4 s[8:11], s[0:1], 104
    s_load_dwordx2 s[12:13], s[0:1], 88
    s_load_dwordx2 s[14:15], s[0:1], 72
    s_load_dwordx8 s[48:55], s[0:1], 8
    s_load_dwordx4 s[56:59], s[0:1], 40
    s_load_dwordx2 s[60:61], s[0:1], 80
    s_load_dwordx2 s[62:63], s[0:1], 96
    v_and_b32 v1, 63, v0
    v_lshrrev_b32 v2, 6, v0
    s_nop 0
    v_readfirstlane_b32 s3, v2
    s_and_b32 s28, s2, 7
    s_lshr_b32 s29, s2, 3
    s_and_b32 s32, s28, 1
    s_lshl_b32 s32, s32, 2
    s_and_b32 s30, s29, 7
    s_lshr_b32 s31, s29, 3
    s_add_u32 s33, s31, s32
    s_add_u32 s34, s30, s32
    s_cmp_ge_u32 s29, 24
    s_cselect_b32 s31, 3, s33
    s_cselect_b32 s30, s34, s30
    s_lshr_b32 s28, s28, 1
    s_lshl_b32 s28, s28, 3
    s_add_u32 s30, s30, s28
    s_lshl_b32 s64, s31, 6
    s_lshl_b32 s65, s30, 1
    s_add_u32 s64, s64, s65
    s_lshr_b32 s65, s3, 2
    s_add_u32 s64, s64, s65
    s_and_b32 s65, s3, 3
    s_waitcnt lgkmcnt(0)
    s_cmp_ge_u32 s2, 224
    s_cbranch_scc1 gf_kernel_prep
    s_mov_b32 s16, s4
    s_mov_b32 s17, s5
    s_mov_b32 s18, 1835008
    s_mov_b32 s19, 0x20000
    s_mov_b32 s20, s6
    s_mov_b32 s21, s7
    s_mov_b32 s22, 1605632
    s_mov_b32 s23, 0x20000
    s_mov_b32 s24, s10
    s_mov_b32 s25, s11
    s_mov_b32 s26, 18874368
    s_mov_b32 s27, 0x20000
    s_lshr_b32 s36, s3, 2
    s_and_b32 s37, s3, 3
    s_lshl_b32 s32, s31, 2
    s_add_u32 s32, s32, s37
    s_lshl_b32 s32, s32, 1
    s_add_u32 s32, s32, s36
    s_lshl_b32 s32, s32, 2
    s_lshl_b32 s33, s30, 8
    s_add_u32 s32, s32, s33
    s_add_u32 s96, s32, 18087936
    s_lshl_b32 s32, s31, 10
    s_lshl_b32 s33, s3, 7
    s_add_u32 s33, s33, s32
    s_lshl_b32 s34, s30, 2
    s_add_u32 s33, s33, s34
    s_add_u32 s97, s33, 18096128
    s_lshl_b32 s33, s37, 8
    s_add_u32 s33, s33, s32
    s_lshl_b32 s34, s30, 3
    s_add_u32 s33, s33, s34
    s_lshl_b32 s34, s36, 2
    s_add_u32 s33, s33, s34
    s_add_u32 s98, s33, 18104320
    s_mul_i32 s99, s30, 3584
    s_add_u32 s99, s99, 17825792
    s_add_u32 s43, s98, 8192
    s_lshr_b32 s33, s30, 3
    s_lshl_b32 s33, s33, 8
    s_add_u32 s47, s33, s32
    s_add_u32 s47, s47, 18112512
    v_lshrrev_b32 v3, 3, v0
    v_and_b32 v4, 7, v0
    s_mul_i32 s32, s30, 57344
    v_mul_u32_u24 v5, 896, v3
    v_lshl_add_u32 v5, v4, 4, v5
    buffer_load_dwordx4 v[64:67], v5, s[16:19], s32 offen offset:0
    buffer_load_dwordx4 v[68:71], v5, s[16:19], s32 offen offset:128
    buffer_load_dwordx4 v[72:75], v5, s[16:19], s32 offen offset:256
    buffer_load_dwordx4 v[76:79], v5, s[16:19], s32 offen offset:384
    buffer_load_dwordx4 v[80:83], v5, s[16:19], s32 offen offset:512
    buffer_load_dwordx4 v[84:87], v5, s[16:19], s32 offen offset:640
    buffer_load_dwordx4 v[88:91], v5, s[16:19], s32 offen offset:768
    v_lshrrev_b32 v6, 5, v1
    v_and_b32 v7, 31, v1
    v_lshl_add_u32 v8, v2, 2, v6
    v_add_u32 v9, 0, v8
    v_and_b32 v12, 7, v9
    v_lshlrev_b32 v12, 1, v12
    v_xor_b32 v12, v12, v7
    v_and_b32 v13, 15, v12
    v_lshlrev_b32 v13, 4, v13
    v_lshrrev_b32 v12, 4, v12
    v_mul_u32_u24 v12, 1792, v12
    v_mul_u32_u24 v10, 3584, v9
    v_add3_u32 v10, v10, v12, v13
    v_add_u32 v9, 2, v8
    v_and_b32 v12, 7, v9
    v_lshlrev_b32 v12, 1, v12
    v_xor_b32 v12, v12, v7
    v_and_b32 v13, 15, v12
    v_lshlrev_b32 v13, 4, v13
    v_lshrrev_b32 v12, 4, v12
    v_mul_u32_u24 v12, 1792, v12
    v_mul_u32_u24 v11, 3584, v9
    v_add3_u32 v11, v11, v12, v13
    s_lshl_b32 s33, s31, 8
    s_lshl_b32 s34, s3, 11
    s_add_u32 m0, s34, 0
    s_add_u32 s35, s33, 0
    buffer_load_dwordx4 v10, s[20:23], s35 offen lds
    s_add_u32 m0, s34, 1024
    s_add_u32 s35, s33, 0
    buffer_load_dwordx4 v11, s[20:23], s35 offen lds
    s_add_u32 m0, s34, 16384
    s_add_u32 s35, s33, 114688
    buffer_load_dwordx4 v10, s[20:23], s35 offen lds
    s_add_u32 m0, s34, 17408
    s_add_u32 s35, s33, 114688
    buffer_load_dwordx4 v11, s[20:23], s35 offen lds
    s_add_u32 m0, s34, 32768
    s_add_u32 s35, s33, 229376
    buffer_load_dwordx4 v10, s[20:23], s35 offen lds
    s_add_u32 m0, s34, 33792
    s_add_u32 s35, s33, 229376
    buffer_load_dwordx4 v11, s[20:23], s35 offen lds
    s_waitcnt vmcnt(6)
    s_add_u32 m0, s34, 49152
    s_add_u32 s35, s33, 344064
    buffer_load_dwordx4 v10, s[20:23], s35 offen lds
    v_lshlrev_b32 v96, 16, v64
    v_and_b32 v97, 0xffff0000, v64
    v_lshlrev_b32 v98, 16, v65
    v_and_b32 v99, 0xffff0000, v65
    v_lshlrev_b32 v100, 16, v66
    v_and_b32 v101, 0xffff0000, v66
    v_lshlrev_b32 v102, 16, v67
    v_and_b32 v103, 0xffff0000, v67
    v_lshlrev_b32 v104, 16, v68
    v_and_b32 v105, 0xffff0000, v68
    v_lshlrev_b32 v106, 16, v69
    v_and_b32 v107, 0xffff0000, v69
    v_lshlrev_b32 v108, 16, v70
    v_and_b32 v109, 0xffff0000, v70
    v_lshlrev_b32 v110, 16, v71
    v_and_b32 v111, 0xffff0000, v71
    v_lshlrev_b32 v112, 16, v72
    v_and_b32 v113, 0xffff0000, v72
    v_lshlrev_b32 v114, 16, v73
    v_and_b32 v115, 0xffff0000, v73
    v_lshlrev_b32 v116, 16, v74
    v_and_b32 v117, 0xffff0000, v74
    v_lshlrev_b32 v118, 16, v75
    v_and_b32 v119, 0xffff0000, v75
    v_lshlrev_b32 v120, 16, v76
    v_and_b32 v121, 0xffff0000, v76
    v_lshlrev_b32 v122, 16, v77
    v_and_b32 v123, 0xffff0000, v77
    v_lshlrev_b32 v124, 16, v78
    v_and_b32 v125, 0xffff0000, v78
    v_lshlrev_b32 v126, 16, v79
    v_and_b32 v127, 0xffff0000, v79
    s_add_u32 m0, s34, 50176
    s_add_u32 s35, s33, 344064
    buffer_load_dwordx4 v11, s[20:23], s35 offen lds
    v_lshlrev_b32 v128, 16, v80
    v_and_b32 v129, 0xffff0000, v80
    v_lshlrev_b32 v130, 16, v81
    v_and_b32 v131, 0xffff0000, v81
    v_lshlrev_b32 v132, 16, v82
    v_and_b32 v133, 0xffff0000, v82
    v_lshlrev_b32 v134, 16, v83
    v_and_b32 v135, 0xffff0000, v83
    v_lshlrev_b32 v136, 16, v84
    v_and_b32 v137, 0xffff0000, v84
    v_lshlrev_b32 v138, 16, v85
    v_and_b32 v139, 0xffff0000, v85
    v_lshlrev_b32 v140, 16, v86
    v_and_b32 v141, 0xffff0000, v86
    v_lshlrev_b32 v142, 16, v87
    v_and_b32 v143, 0xffff0000, v87
    v_lshlrev_b32 v144, 16, v88
    v_and_b32 v145, 0xffff0000, v88
    v_lshlrev_b32 v146, 16, v89
    v_and_b32 v147, 0xffff0000, v89
    v_lshlrev_b32 v148, 16, v90
    v_and_b32 v149, 0xffff0000, v90
    v_lshlrev_b32 v150, 16, v91
    v_and_b32 v151, 0xffff0000, v91
    v_pk_add_f32 v[16:17], v[96:97], v[104:105]
    v_pk_add_f32 v[18:19], v[98:99], v[106:107]
    v_pk_add_f32 v[20:21], v[100:101], v[108:109]
    v_pk_add_f32 v[22:23], v[102:103], v[110:111]
    v_pk_add_f32 v[16:17], v[16:17], v[112:113]
    v_pk_add_f32 v[18:19], v[18:19], v[114:115]
    v_pk_add_f32 v[20:21], v[20:21], v[116:117]
    v_pk_add_f32 v[22:23], v[22:23], v[118:119]
    s_add_u32 m0, s34, 65536
    s_add_u32 s35, s33, 458752
    buffer_load_dwordx4 v10, s[20:23], s35 offen lds
    v_pk_add_f32 v[16:17], v[16:17], v[120:121]
    v_pk_add_f32 v[18:19], v[18:19], v[122:123]
    v_pk_add_f32 v[20:21], v[20:21], v[124:125]
    v_pk_add_f32 v[22:23], v[22:23], v[126:127]
    v_pk_add_f32 v[16:17], v[16:17], v[128:129]
    v_pk_add_f32 v[18:19], v[18:19], v[130:131]
    v_pk_add_f32 v[20:21], v[20:21], v[132:133]
    v_pk_add_f32 v[22:23], v[22:23], v[134:135]
    v_pk_add_f32 v[16:17], v[16:17], v[136:137]
    v_pk_add_f32 v[18:19], v[18:19], v[138:139]
    v_pk_add_f32 v[20:21], v[20:21], v[140:141]
    v_pk_add_f32 v[22:23], v[22:23], v[142:143]
    v_pk_add_f32 v[16:17], v[16:17], v[144:145]
    v_pk_add_f32 v[18:19], v[18:19], v[146:147]
    v_pk_add_f32 v[20:21], v[20:21], v[148:149]
    v_pk_add_f32 v[22:23], v[22:23], v[150:151]
    v_pk_add_f32 v[16:17], v[16:17], v[18:19]
    v_pk_add_f32 v[20:21], v[20:21], v[22:23]
    v_pk_add_f32 v[16:17], v[16:17], v[20:21]
    v_add_f32 v16, v16, v17
    s_nop 1
    v_add_f32_dpp v16, v16, v16 quad_perm:[1,0,3,2] row_mask:0xf bank_mask:0xf
    s_nop 1
    v_add_f32_dpp v16, v16, v16 quad_perm:[2,3,0,1] row_mask:0xf bank_mask:0xf
    s_nop 1
    v_add_f32_dpp v16, v16, v16 row_half_mirror row_mask:0xf bank_mask:0xf
    v_mul_f32 v16, 0x3b124925, v16
    v_mov_b32 v17, v16
    v_pk_add_f32 v[24:25], v[96:97], v[16:17] neg_lo:[0,1] neg_hi:[0,1]
    v_pk_mul_f32 v[32:33], v[24:25], v[24:25]
    v_pk_add_f32 v[26:27], v[98:99], v[16:17] neg_lo:[0,1] neg_hi:[0,1]
    v_pk_mul_f32 v[34:35], v[26:27], v[26:27]
    s_add_u32 m0, s34, 66560
    s_add_u32 s35, s33, 458752
    buffer_load_dwordx4 v11, s[20:23], s35 offen lds
    v_pk_add_f32 v[28:29], v[100:101], v[16:17] neg_lo:[0,1] neg_hi:[0,1]
    v_pk_mul_f32 v[36:37], v[28:29], v[28:29]
    v_pk_add_f32 v[30:31], v[102:103], v[16:17] neg_lo:[0,1] neg_hi:[0,1]
    v_pk_mul_f32 v[38:39], v[30:31], v[30:31]
    v_pk_add_f32 v[24:25], v[104:105], v[16:17] neg_lo:[0,1] neg_hi:[0,1]
    v_pk_fma_f32 v[32:33], v[24:25], v[24:25], v[32:33]
    v_pk_add_f32 v[26:27], v[106:107], v[16:17] neg_lo:[0,1] neg_hi:[0,1]
    v_pk_fma_f32 v[34:35], v[26:27], v[26:27], v[34:35]
    v_pk_add_f32 v[28:29], v[108:109], v[16:17] neg_lo:[0,1] neg_hi:[0,1]
    v_pk_fma_f32 v[36:37], v[28:29], v[28:29], v[36:37]
    v_pk_add_f32 v[30:31], v[110:111], v[16:17] neg_lo:[0,1] neg_hi:[0,1]
    v_pk_fma_f32 v[38:39], v[30:31], v[30:31], v[38:39]
    v_pk_add_f32 v[24:25], v[112:113], v[16:17] neg_lo:[0,1] neg_hi:[0,1]
    v_pk_fma_f32 v[32:33], v[24:25], v[24:25], v[32:33]
    v_pk_add_f32 v[26:27], v[114:115], v[16:17] neg_lo:[0,1] neg_hi:[0,1]
    v_pk_fma_f32 v[34:35], v[26:27], v[26:27], v[34:35]
    v_pk_add_f32 v[28:29], v[116:117], v[16:17] neg_lo:[0,1] neg_hi:[0,1]
    v_pk_fma_f32 v[36:37], v[28:29], v[28:29], v[36:37]
    v_pk_add_f32 v[30:31], v[118:119], v[16:17] neg_lo:[0,1] neg_hi:[0,1]
    v_pk_fma_f32 v[38:39], v[30:31], v[30:31], v[38:39]
    v_pk_add_f32 v[24:25], v[120:121], v[16:17] neg_lo:[0,1] neg_hi:[0,1]
    v_pk_fma_f32 v[32:33], v[24:25], v[24:25], v[32:33]
    v_pk_add_f32 v[26:27], v[122:123], v[16:17] neg_lo:[0,1] neg_hi:[0,1]
    v_pk_fma_f32 v[34:35], v[26:27], v[26:27], v[34:35]
    v_pk_add_f32 v[28:29], v[124:125], v[16:17] neg_lo:[0,1] neg_hi:[0,1]
    v_pk_fma_f32 v[36:37], v[28:29], v[28:29], v[36:37]
    v_pk_add_f32 v[30:31], v[126:127], v[16:17] neg_lo:[0,1] neg_hi:[0,1]
    v_pk_fma_f32 v[38:39], v[30:31], v[30:31], v[38:39]
    v_pk_add_f32 v[24:25], v[128:129], v[16:17] neg_lo:[0,1] neg_hi:[0,1]
    v_pk_fma_f32 v[32:33], v[24:25], v[24:25], v[32:33]
    v_pk_add_f32 v[26:27], v[130:131], v[16:17] neg_lo:[0,1] neg_hi:[0,1]
    v_pk_fma_f32 v[34:35], v[26:27], v[26:27], v[34:35]
    s_add_u32 m0, s34, 81920
    s_add_u32 s35, s33, 573440
    buffer_load_dwordx4 v10, s[20:23], s35 offen lds
    v_pk_add_f32 v[28:29], v[132:133], v[16:17] neg_lo:[0,1] neg_hi:[0,1]
    v_pk_fma_f32 v[36:37], v[28:29], v[28:29], v[36:37]
    v_pk_add_f32 v[30:31], v[134:135], v[16:17] neg_lo:[0,1] neg_hi:[0,1]
    v_pk_fma_f32 v[38:39], v[30:31], v[30:31], v[38:39]
    v_pk_add_f32 v[24:25], v[136:137], v[16:17] neg_lo:[0,1] neg_hi:[0,1]
    v_pk_fma_f32 v[32:33], v[24:25], v[24:25], v[32:33]
    v_pk_add_f32 v[26:27], v[138:139], v[16:17] neg_lo:[0,1] neg_hi:[0,1]
    v_pk_fma_f32 v[34:35], v[26:27], v[26:27], v[34:35]
    v_pk_add_f32 v[28:29], v[140:141], v[16:17] neg_lo:[0,1] neg_hi:[0,1]
    v_pk_fma_f32 v[36:37], v[28:29], v[28:29], v[36:37]
    v_pk_add_f32 v[30:31], v[142:143], v[16:17] neg_lo:[0,1] neg_hi:[0,1]
    v_pk_fma_f32 v[38:39], v[30:31], v[30:31], v[38:39]
    v_pk_add_f32 v[24:25], v[144:145], v[16:17] neg_lo:[0,1] neg_hi:[0,1]
    v_pk_fma_f32 v[32:33], v[24:25], v[24:25], v[32:33]
    v_pk_add_f32 v[26:27], v[146:147], v[16:17] neg_lo:[0,1] neg_hi:[0,1]
    v_pk_fma_f32 v[34:35], v[26:27], v[26:27], v[34:35]
    v_pk_add_f32 v[28:29], v[148:149], v[16:17] neg_lo:[0,1] neg_hi:[0,1]
    v_pk_fma_f32 v[36:37], v[28:29], v[28:29], v[36:37]
    v_pk_add_f32 v[30:31], v[150:151], v[16:17] neg_lo:[0,1] neg_hi:[0,1]
    v_pk_fma_f32 v[38:39], v[30:31], v[30:31], v[38:39]
    v_pk_add_f32 v[32:33], v[32:33], v[34:35]
    v_pk_add_f32 v[36:37], v[36:37], v[38:39]
    v_pk_add_f32 v[32:33], v[32:33], v[36:37]
    v_add_f32 v32, v32, v33
    s_nop 1
    v_add_f32_dpp v32, v32, v32 quad_perm:[1,0,3,2] row_mask:0xf bank_mask:0xf
    s_nop 1
    v_add_f32_dpp v32, v32, v32 quad_perm:[2,3,0,1] row_mask:0xf bank_mask:0xf
    s_nop 1
    v_add_f32_dpp v32, v32, v32 row_half_mirror row_mask:0xf bank_mask:0xf
    v_mul_f32 v32, 0x3b124925, v32
    v_cvt_pk_bf16_f32 v32, v32, v32
    s_add_u32 m0, s34, 82944
    s_add_u32 s35, s33, 573440
    buffer_load_dwordx4 v11, s[20:23], s35 offen lds
    v_lshlrev_b32 v32, 16, v32
    v_add_f32 v32, 0x3727c5ac, v32
    v_cvt_pk_bf16_f32 v32, v32, v32
    v_lshlrev_b32 v32, 16, v32
    v_sqrt_f32 v32, v32
    s_nop 0
    v_cvt_pk_bf16_f32 v32, v32, v32
    v_lshlrev_b32 v32, 16, v32
    v_rcp_f32 v18, v32
    v_cvt_pk_bf16_f32 v16, v16, v16
    v_lshlrev_b32 v16, 16, v16
    v_mov_b32 v17, v16
    v_fma_f32 v19, -v32, v18, 1.0
    v_fma_f32 v18, v19, v18, v18
    v_mov_b32 v19, v18
    v_lshrrev_b32 v20, 2, v4
    v_lshlrev_b32 v20, 2, v20
    v_and_b32 v21, 1, v4
    v_lshl_add_u32 v20, v21, 1, v20
    v_bfe_u32 v21, v3, 1, 3
    v_xor_b32 v22, v20, v21
    v_xor_b32 v23, 1, v22
    v_bfe_u32 v21, v4, 1, 1
    v_lshlrev_b32 v21, 3, v21
    v_mul_u32_u24 v24, 896, v3
    v_add_u32 v24, v24, v21
    v_add_u32 v24, 98304, v24
    v_lshl_add_u32 v22, v22, 4, v24
    v_lshl_add_u32 v23, v23, 4, v24
    v_pk_add_f32 v[96:97], v[96:97], v[16:17] neg_lo:[0,1] neg_hi:[0,1]
    v_cvt_pk_bf16_f32 v64, v96, v97
    v_lshlrev_b32 v96, 16, v64
    v_and_b32 v97, 0xffff0000, v64
    v_pk_mul_f32 v[96:97], v[96:97], v[18:19]
    v_cvt_pk_bf16_f32 v64, v96, v97
    v_pk_add_f32 v[98:99], v[98:99], v[16:17] neg_lo:[0,1] neg_hi:[0,1]
    v_cvt_pk_bf16_f32 v65, v98, v99
    v_lshlrev_b32 v98, 16, v65
    v_and_b32 v99, 0xffff0000, v65
    v_pk_mul_f32 v[98:99], v[98:99], v[18:19]
    v_cvt_pk_bf16_f32 v65, v98, v99
    v_pk_add_f32 v[100:101], v[100:101], v[16:17] neg_lo:[0,1] neg_hi:[0,1]
    v_cvt_pk_bf16_f32 v66, v100, v101
    v_lshlrev_b32 v100, 16, v66
    v_and_b32 v101, 0xffff0000, v66
    v_pk_mul_f32 v[100:101], v[100:101], v[18:19]
    v_cvt_pk_bf16_f32 v66, v100, v101
    v_pk_add_f32 v[102:103], v[102:103], v[16:17] neg_lo:[0,1] neg_hi:[0,1]
    v_cvt_pk_bf16_f32 v67, v102, v103
    v_lshlrev_b32 v102, 16, v67
    v_and_b32 v103, 0xffff0000, v67
    v_pk_mul_f32 v[102:103], v[102:103], v[18:19]
    v_cvt_pk_bf16_f32 v67, v102, v103
    ds_write_b64 v22, v[64:65] offset:0
    ds_write_b64 v23, v[66:67] offset:0
    v_pk_add_f32 v[104:105], v[104:105], v[16:17] neg_lo:[0,1] neg_hi:[0,1]
    v_cvt_pk_bf16_f32 v68, v104, v105
    v_lshlrev_b32 v104, 16, v68
    v_and_b32 v105, 0xffff0000, v68
    v_pk_mul_f32 v[104:105], v[104:105], v[18:19]
    v_cvt_pk_bf16_f32 v68, v104, v105
    v_pk_add_f32 v[106:107], v[106:107], v[16:17] neg_lo:[0,1] neg_hi:[0,1]
    v_cvt_pk_bf16_f32 v69, v106, v107
    v_lshlrev_b32 v106, 16, v69
    v_and_b32 v107, 0xffff0000, v69
    v_pk_mul_f32 v[106:107], v[106:107], v[18:19]
    v_cvt_pk_bf16_f32 v69, v106, v107
    v_pk_add_f32 v[108:109], v[108:109], v[16:17] neg_lo:[0,1] neg_hi:[0,1]
    v_cvt_pk_bf16_f32 v70, v108, v109
    v_lshlrev_b32 v108, 16, v70
    v_and_b32 v109, 0xffff0000, v70
    v_pk_mul_f32 v[108:109], v[108:109], v[18:19]
    v_cvt_pk_bf16_f32 v70, v108, v109
    v_pk_add_f32 v[110:111], v[110:111], v[16:17] neg_lo:[0,1] neg_hi:[0,1]
    v_cvt_pk_bf16_f32 v71, v110, v111
    v_lshlrev_b32 v110, 16, v71
    v_and_b32 v111, 0xffff0000, v71
    v_pk_mul_f32 v[110:111], v[110:111], v[18:19]
    v_cvt_pk_bf16_f32 v71, v110, v111
    ds_write_b64 v22, v[68:69] offset:128
    ds_write_b64 v23, v[70:71] offset:128
    v_pk_add_f32 v[112:113], v[112:113], v[16:17] neg_lo:[0,1] neg_hi:[0,1]
    v_cvt_pk_bf16_f32 v72, v112, v113
    v_lshlrev_b32 v112, 16, v72
    v_and_b32 v113, 0xffff0000, v72
    v_pk_mul_f32 v[112:113], v[112:113], v[18:19]
    v_cvt_pk_bf16_f32 v72, v112, v113
    v_pk_add_f32 v[114:115], v[114:115], v[16:17] neg_lo:[0,1] neg_hi:[0,1]
    v_cvt_pk_bf16_f32 v73, v114, v115
    v_lshlrev_b32 v114, 16, v73
    v_and_b32 v115, 0xffff0000, v73
    v_pk_mul_f32 v[114:115], v[114:115], v[18:19]
    v_cvt_pk_bf16_f32 v73, v114, v115
    v_pk_add_f32 v[116:117], v[116:117], v[16:17] neg_lo:[0,1] neg_hi:[0,1]
    v_cvt_pk_bf16_f32 v74, v116, v117
    v_lshlrev_b32 v116, 16, v74
    v_and_b32 v117, 0xffff0000, v74
    v_pk_mul_f32 v[116:117], v[116:117], v[18:19]
    v_cvt_pk_bf16_f32 v74, v116, v117
    v_pk_add_f32 v[118:119], v[118:119], v[16:17] neg_lo:[0,1] neg_hi:[0,1]
    v_cvt_pk_bf16_f32 v75, v118, v119
    v_lshlrev_b32 v118, 16, v75
    v_and_b32 v119, 0xffff0000, v75
    v_pk_mul_f32 v[118:119], v[118:119], v[18:19]
    v_cvt_pk_bf16_f32 v75, v118, v119
    ds_write_b64 v22, v[72:73] offset:256
    ds_write_b64 v23, v[74:75] offset:256
    v_pk_add_f32 v[120:121], v[120:121], v[16:17] neg_lo:[0,1] neg_hi:[0,1]
    v_cvt_pk_bf16_f32 v76, v120, v121
    v_lshlrev_b32 v120, 16, v76
    v_and_b32 v121, 0xffff0000, v76
    v_pk_mul_f32 v[120:121], v[120:121], v[18:19]
    v_cvt_pk_bf16_f32 v76, v120, v121
    v_pk_add_f32 v[122:123], v[122:123], v[16:17] neg_lo:[0,1] neg_hi:[0,1]
    v_cvt_pk_bf16_f32 v77, v122, v123
    v_lshlrev_b32 v122, 16, v77
    v_and_b32 v123, 0xffff0000, v77
    v_pk_mul_f32 v[122:123], v[122:123], v[18:19]
    v_cvt_pk_bf16_f32 v77, v122, v123
    v_pk_add_f32 v[124:125], v[124:125], v[16:17] neg_lo:[0,1] neg_hi:[0,1]
    v_cvt_pk_bf16_f32 v78, v124, v125
    v_lshlrev_b32 v124, 16, v78
    v_and_b32 v125, 0xffff0000, v78
    v_pk_mul_f32 v[124:125], v[124:125], v[18:19]
    v_cvt_pk_bf16_f32 v78, v124, v125
    v_pk_add_f32 v[126:127], v[126:127], v[16:17] neg_lo:[0,1] neg_hi:[0,1]
    v_cvt_pk_bf16_f32 v79, v126, v127
    v_lshlrev_b32 v126, 16, v79
    v_and_b32 v127, 0xffff0000, v79
    v_pk_mul_f32 v[126:127], v[126:127], v[18:19]
    v_cvt_pk_bf16_f32 v79, v126, v127
    ds_write_b64 v22, v[76:77] offset:384
    ds_write_b64 v23, v[78:79] offset:384
    v_pk_add_f32 v[128:129], v[128:129], v[16:17] neg_lo:[0,1] neg_hi:[0,1]
    v_cvt_pk_bf16_f32 v80, v128, v129
    v_lshlrev_b32 v128, 16, v80
    v_and_b32 v129, 0xffff0000, v80
    v_pk_mul_f32 v[128:129], v[128:129], v[18:19]
    v_cvt_pk_bf16_f32 v80, v128, v129
    v_pk_add_f32 v[130:131], v[130:131], v[16:17] neg_lo:[0,1] neg_hi:[0,1]
    v_cvt_pk_bf16_f32 v81, v130, v131
    v_lshlrev_b32 v130, 16, v81
    v_and_b32 v131, 0xffff0000, v81
    v_pk_mul_f32 v[130:131], v[130:131], v[18:19]
    v_cvt_pk_bf16_f32 v81, v130, v131
    v_pk_add_f32 v[132:133], v[132:133], v[16:17] neg_lo:[0,1] neg_hi:[0,1]
    v_cvt_pk_bf16_f32 v82, v132, v133
    v_lshlrev_b32 v132, 16, v82
    v_and_b32 v133, 0xffff0000, v82
    v_pk_mul_f32 v[132:133], v[132:133], v[18:19]
    v_cvt_pk_bf16_f32 v82, v132, v133
    v_pk_add_f32 v[134:135], v[134:135], v[16:17] neg_lo:[0,1] neg_hi:[0,1]
    v_cvt_pk_bf16_f32 v83, v134, v135
    v_lshlrev_b32 v134, 16, v83
    v_and_b32 v135, 0xffff0000, v83
    v_pk_mul_f32 v[134:135], v[134:135], v[18:19]
    v_cvt_pk_bf16_f32 v83, v134, v135
    ds_write_b64 v22, v[80:81] offset:512
    ds_write_b64 v23, v[82:83] offset:512
    v_pk_add_f32 v[136:137], v[136:137], v[16:17] neg_lo:[0,1] neg_hi:[0,1]
    v_cvt_pk_bf16_f32 v84, v136, v137
    v_lshlrev_b32 v136, 16, v84
    v_and_b32 v137, 0xffff0000, v84
    v_pk_mul_f32 v[136:137], v[136:137], v[18:19]
    v_cvt_pk_bf16_f32 v84, v136, v137
    v_pk_add_f32 v[138:139], v[138:139], v[16:17] neg_lo:[0,1] neg_hi:[0,1]
    v_cvt_pk_bf16_f32 v85, v138, v139
    v_lshlrev_b32 v138, 16, v85
    v_and_b32 v139, 0xffff0000, v85
    v_pk_mul_f32 v[138:139], v[138:139], v[18:19]
    v_cvt_pk_bf16_f32 v85, v138, v139
    v_pk_add_f32 v[140:141], v[140:141], v[16:17] neg_lo:[0,1] neg_hi:[0,1]
    v_cvt_pk_bf16_f32 v86, v140, v141
    v_lshlrev_b32 v140, 16, v86
    v_and_b32 v141, 0xffff0000, v86
    v_pk_mul_f32 v[140:141], v[140:141], v[18:19]
    v_cvt_pk_bf16_f32 v86, v140, v141
    v_pk_add_f32 v[142:143], v[142:143], v[16:17] neg_lo:[0,1] neg_hi:[0,1]
    v_cvt_pk_bf16_f32 v87, v142, v143
    v_lshlrev_b32 v142, 16, v87
    v_and_b32 v143, 0xffff0000, v87
    v_pk_mul_f32 v[142:143], v[142:143], v[18:19]
    v_cvt_pk_bf16_f32 v87, v142, v143
    ds_write_b64 v22, v[84:85] offset:640
    ds_write_b64 v23, v[86:87] offset:640
    v_pk_add_f32 v[144:145], v[144:145], v[16:17] neg_lo:[0,1] neg_hi:[0,1]
    v_cvt_pk_bf16_f32 v88, v144, v145
    v_lshlrev_b32 v144, 16, v88
    v_and_b32 v145, 0xffff0000, v88
    v_pk_mul_f32 v[144:145], v[144:145], v[18:19]
    v_cvt_pk_bf16_f32 v88, v144, v145
    v_pk_add_f32 v[146:147], v[146:147], v[16:17] neg_lo:[0,1] neg_hi:[0,1]
    v_cvt_pk_bf16_f32 v89, v146, v147
    v_lshlrev_b32 v146, 16, v89
    v_and_b32 v147, 0xffff0000, v89
    v_pk_mul_f32 v[146:147], v[146:147], v[18:19]
    v_cvt_pk_bf16_f32 v89, v146, v147
    v_pk_add_f32 v[148:149], v[148:149], v[16:17] neg_lo:[0,1] neg_hi:[0,1]
    v_cvt_pk_bf16_f32 v90, v148, v149
    v_lshlrev_b32 v148, 16, v90
    v_and_b32 v149, 0xffff0000, v90
    v_pk_mul_f32 v[148:149], v[148:149], v[18:19]
    v_cvt_pk_bf16_f32 v90, v148, v149
    v_pk_add_f32 v[150:151], v[150:151], v[16:17] neg_lo:[0,1] neg_hi:[0,1]
    v_cvt_pk_bf16_f32 v91, v150, v151
    v_lshlrev_b32 v150, 16, v91
    v_and_b32 v151, 0xffff0000, v91
    v_pk_mul_f32 v[150:151], v[150:151], v[18:19]
    v_cvt_pk_bf16_f32 v91, v150, v151
    ds_write_b64 v22, v[88:89] offset:768
    ds_write_b64 v23, v[90:91] offset:768
    v_and_b32 v3, 15, v1
    v_lshrrev_b32 v4, 4, v1
    s_lshr_b32 s36, s3, 2
    s_and_b32 s37, s3, 3
    s_lshl_b32 s38, s36, 5
    v_add_u32 v5, s38, v3
    v_add_u32 v6, 0, v5
    v_bfe_u32 v7, v6, 1, 3
    v_xor_b32 v7, v7, v4
    v_mul_u32_u24 v6, 896, v6
    v_add_u32 v6, 98304, v6
    v_lshl_add_u32 v12, v7, 4, v6
    v_xor_b32 v7, 4, v7
    v_lshl_add_u32 v13, v7, 4, v6
    v_add_u32 v6, 16, v5
    v_bfe_u32 v7, v6, 1, 3
    v_xor_b32 v7, v7, v4
    v_mul_u32_u24 v6, 896, v6
    v_add_u32 v6, 98304, v6
    v_lshl_add_u32 v14, v7, 4, v6
    v_xor_b32 v7, 4, v7
    v_lshl_add_u32 v15, v7, 4, v6
    v_lshrrev_b32 v6, 2, v1
    v_and_b32 v7, 7, v6
    v_lshlrev_b32 v7, 1, v7
    v_bfe_u32 v8, v1, 1, 1
    s_lshl_b32 s38, s37, 2
    v_add_u32 v8, s38, v8
    v_xor_b32 v8, v8, v7
    v_and_b32 v9, 1, v1
    v_lshlrev_b32 v9, 3, v9
    v_lshl_add_u32 v9, v6, 9, v9
    v_lshl_add_u32 v16, v8, 4, v9
    v_xor_b32 v17, 32, v16
    v_add_u32 v29, 65536, v16
    v_add_u32 v30, 65536, v17
    v_bfe_u32 v6, v1, 2, 2
    v_lshl_add_u32 v6, v4, 3, v6
    s_lshl_b32 s38, s36, 5
    v_add_u32 v6, s38, v6
    v_and_b32 v7, 3, v1
    s_lshr_b32 s38, s37, 1
    s_lshl_b32 s38, s38, 2
    v_add_u32 v7, s38, v7
    s_and_b32 s38, s37, 1
    s_lshl_b32 s38, s38, 3
    s_lshl_b32 s39, s31, 7
    s_add_u32 s38, s38, s39
    s_add_u32 s38, s38, 98304
    v_add_u32 v8, 0, v6
    v_bfe_u32 v9, v8, 1, 3
    v_xor_b32 v9, v9, v7
    v_mul_u32_u24 v8, 896, v8
    v_lshl_add_u32 v8, v9, 4, v8
    v_add_u32 v18, s38, v8
    v_add_u32 v8, 4, v6
    v_bfe_u32 v9, v8, 1, 3
    v_xor_b32 v9, v9, v7
    v_mul_u32_u24 v8, 896, v8
    v_lshl_add_u32 v8, v9, 4, v8
    v_add_u32 v19, s38, v8
    s_lshl_b32 s38, s31, 6
    s_lshl_b32 s39, s37, 4
    s_add_u32 s38, s38, s39
    v_add_u32 v8, s38, v3
    v_lshlrev_b32 v8, 12, v8
    s_lshl_b32 s38, s30, 7
    s_lshl_b32 s39, s36, 6
    s_add_u32 s38, s38, s39
    v_lshl_add_u32 v8, v4, 4, v8
    v_add_u32 v20, s38, v8
    v_mov_b32 v32, 0
    v_mov_b32 v33, 0
    v_mov_b32 v34, 0
    v_mov_b32 v35, 0
    v_mov_b32 v36, 0
    v_mov_b32 v37, 0
    v_mov_b32 v38, 0
    v_mov_b32 v39, 0
    v_mov_b32 v40, 0
    v_mov_b32 v41, 0
    v_mov_b32 v42, 0
    v_mov_b32 v43, 0
    v_mov_b32 v44, 0
    v_mov_b32 v45, 0
    v_mov_b32 v46, 0
    v_mov_b32 v47, 0
    v_mov_b32 v48, 0
    v_mov_b32 v49, 0
    v_mov_b32 v50, 0
    v_mov_b32 v51, 0
    v_mov_b32 v52, 0
    v_mov_b32 v53, 0
    v_mov_b32 v54, 0
    v_mov_b32 v55, 0
    v_mov_b32 v56, 0
    v_mov_b32 v57, 0
    v_mov_b32 v58, 0
    v_mov_b32 v59, 0
    v_mov_b32 v60, 0
    v_mov_b32 v61, 0
    v_mov_b32 v62, 0
    v_mov_b32 v63, 0
    s_waitcnt vmcnt(8)
    s_waitcnt lgkmcnt(0)
    s_barrier
    ds_read_b64_tr_b16 v[24:25], v18
    ds_read_b64_tr_b16 v[26:27], v19
    ds_read_b128 v[64:67], v12 offset:0
    ds_read_b128 v[68:71], v14 offset:0
    ds_read_b64_tr_b16 v[72:73], v16 offset:0
    ds_read_b64_tr_b16 v[74:75], v16 offset:8192
    ds_read_b64_tr_b16 v[76:77], v17 offset:0
    ds_read_b64_tr_b16 v[78:79], v17 offset:8192
    ds_read_b64_tr_b16 v[80:81], v16 offset:256
    ds_read_b64_tr_b16 v[82:83], v16 offset:8448
    ds_read_b64_tr_b16 v[84:85], v17 offset:256
    ds_read_b64_tr_b16 v[86:87], v17 offset:8448
    s_waitcnt lgkmcnt(10)
    buffer_store_dwordx4 v[24:27], v20, s[24:27], 0 offen sc1
    ds_read_b128 v[88:91], v13 offset:0
    ds_read_b128 v[92:95], v15 offset:0
    ds_read_b64_tr_b16 v[96:97], v16 offset:16384
    ds_read_b64_tr_b16 v[98:99], v16 offset:24576
    ds_read_b64_tr_b16 v[100:101], v17 offset:16384
    ds_read_b64_tr_b16 v[102:103], v17 offset:24576
    ds_read_b64_tr_b16 v[104:105], v16 offset:16640
    ds_read_b64_tr_b16 v[106:107], v16 offset:24832
    ds_read_b64_tr_b16 v[108:109], v17 offset:16640
    ds_read_b64_tr_b16 v[110:111], v17 offset:24832
    v_and_b32 v21, 7, v1
    v_lshlrev_b32 v21, 2, v21
    v_lshlrev_b32 v22, 2, v1
    s_waitcnt vmcnt(7)
    s_waitcnt lgkmcnt(10)
    s_barrier
    ds_read_b128 v[112:115], v12 offset:128
    ds_read_b128 v[116:119], v14 offset:128
    ds_read_b64_tr_b16 v[120:121], v16 offset:32768
    ds_read_b64_tr_b16 v[122:123], v16 offset:40960
    ds_read_b64_tr_b16 v[124:125], v17 offset:32768
    ds_read_b64_tr_b16 v[126:127], v17 offset:40960
    ds_read_b64_tr_b16 v[128:129], v16 offset:33024
    ds_read_b64_tr_b16 v[130:131], v16 offset:41216
    ds_read_b64_tr_b16 v[132:133], v17 offset:33024
    ds_read_b64_tr_b16 v[134:135], v17 offset:41216
    v_mfma_f32_16x16x32_bf16 v[48:51], v[64:67], v[80:83], v[48:51]
    v_mfma_f32_16x16x32_bf16 v[32:35], v[72:75], v[64:67], v[32:35]
    s_add_u32 m0, s34, 0
    s_add_u32 s35, s33, 688128
    buffer_load_dwordx4 v10, s[20:23], s35 offen lds
    v_mfma_f32_16x16x32_bf16 v[52:55], v[64:67], v[84:87], v[52:55]
    v_mfma_f32_16x16x32_bf16 v[36:39], v[76:79], v[64:67], v[36:39]
    s_add_u32 m0, s34, 1024
    s_add_u32 s35, s33, 688128
    buffer_load_dwordx4 v11, s[20:23], s35 offen lds
    v_mfma_f32_16x16x32_bf16 v[56:59], v[68:71], v[80:83], v[56:59]
    v_mfma_f32_16x16x32_bf16 v[40:43], v[72:75], v[68:71], v[40:43]
    v_mfma_f32_16x16x32_bf16 v[60:63], v[68:71], v[84:87], v[60:63]
    v_mfma_f32_16x16x32_bf16 v[44:47], v[76:79], v[68:71], v[44:47]
    s_waitcnt vmcnt(7)
    s_waitcnt lgkmcnt(10)
    s_barrier
    ds_read_b128 v[64:67], v13 offset:128
    ds_read_b128 v[68:71], v15 offset:128
    ds_read_b64_tr_b16 v[72:73], v16 offset:49152
    ds_read_b64_tr_b16 v[74:75], v16 offset:57344
    ds_read_b64_tr_b16 v[76:77], v17 offset:49152
    ds_read_b64_tr_b16 v[78:79], v17 offset:57344
    ds_read_b64_tr_b16 v[80:81], v16 offset:49408
    ds_read_b64_tr_b16 v[82:83], v16 offset:57600
    ds_read_b64_tr_b16 v[84:85], v17 offset:49408
    ds_read_b64_tr_b16 v[86:87], v17 offset:57600
    v_mfma_f32_16x16x32_bf16 v[48:51], v[88:91], v[104:107], v[48:51]
    v_mfma_f32_16x16x32_bf16 v[32:35], v[96:99], v[88:91], v[32:35]
    s_add_u32 m0, s34, 16384
    s_add_u32 s35, s33, 802816
    buffer_load_dwordx4 v10, s[20:23], s35 offen lds
    v_mfma_f32_16x16x32_bf16 v[52:55], v[88:91], v[108:111], v[52:55]
    v_mfma_f32_16x16x32_bf16 v[36:39], v[100:103], v[88:91], v[36:39]
    s_add_u32 m0, s34, 17408
    s_add_u32 s35, s33, 802816
    buffer_load_dwordx4 v11, s[20:23], s35 offen lds
    v_mfma_f32_16x16x32_bf16 v[56:59], v[92:95], v[104:107], v[56:59]
    v_mfma_f32_16x16x32_bf16 v[40:43], v[96:99], v[92:95], v[40:43]
    v_mfma_f32_16x16x32_bf16 v[60:63], v[92:95], v[108:111], v[60:63]
    v_mfma_f32_16x16x32_bf16 v[44:47], v[100:103], v[92:95], v[44:47]
    s_waitcnt vmcnt(7)
    s_waitcnt lgkmcnt(10)
    s_barrier
    ds_read_b128 v[88:91], v12 offset:256
    ds_read_b128 v[92:95], v14 offset:256
    ds_read_b64_tr_b16 v[96:97], v29 offset:0
    ds_read_b64_tr_b16 v[98:99], v29 offset:8192
    ds_read_b64_tr_b16 v[100:101], v30 offset:0
    ds_read_b64_tr_b16 v[102:103], v30 offset:8192
    ds_read_b64_tr_b16 v[104:105], v29 offset:256
    ds_read_b64_tr_b16 v[106:107], v29 offset:8448
    ds_read_b64_tr_b16 v[108:109], v30 offset:256
    ds_read_b64_tr_b16 v[110:111], v30 offset:8448
    v_mfma_f32_16x16x32_bf16 v[48:51], v[112:115], v[128:131], v[48:51]
    v_mfma_f32_16x16x32_bf16 v[32:35], v[120:123], v[112:115], v[32:35]
    s_add_u32 m0, s34, 32768
    s_add_u32 s35, s33, 917504
    buffer_load_dwordx4 v10, s[20:23], s35 offen lds
    v_mfma_f32_16x16x32_bf16 v[52:55], v[112:115], v[132:135], v[52:55]
    v_mfma_f32_16x16x32_bf16 v[36:39], v[124:127], v[112:115], v[36:39]
    s_add_u32 m0, s34, 33792
    s_add_u32 s35, s33, 917504
    buffer_load_dwordx4 v11, s[20:23], s35 offen lds
    v_mfma_f32_16x16x32_bf16 v[56:59], v[116:119], v[128:131], v[56:59]
    v_mfma_f32_16x16x32_bf16 v[40:43], v[120:123], v[116:119], v[40:43]
    v_mfma_f32_16x16x32_bf16 v[60:63], v[116:119], v[132:135], v[60:63]
    v_mfma_f32_16x16x32_bf16 v[44:47], v[124:127], v[116:119], v[44:47]
    s_waitcnt vmcnt(7)
    s_waitcnt lgkmcnt(10)
    s_barrier
    ds_read_b128 v[112:115], v13 offset:256
    ds_read_b128 v[116:119], v15 offset:256
    ds_read_b64_tr_b16 v[120:121], v29 offset:16384
    ds_read_b64_tr_b16 v[122:123], v29 offset:24576
    ds_read_b64_tr_b16 v[124:125], v30 offset:16384
    ds_read_b64_tr_b16 v[126:127], v30 offset:24576
    ds_read_b64_tr_b16 v[128:129], v29 offset:16640
    ds_read_b64_tr_b16 v[130:131], v29 offset:24832
    ds_read_b64_tr_b16 v[132:133], v30 offset:16640
    ds_read_b64_tr_b16 v[134:135], v30 offset:24832
    s_lshl_b32 s38, s64, 9
    s_lshl_b32 s39, s65, 7
    s_add_u32 s38, s38, s39
    v_lshlrev_b32 v6, 1, v1
    v_add_u32 v6, s38, v6
    s_lshl_b32 s38, s64, 1
    v_mov_b32 v7, s38
    global_load_ushort v152, v6, s[48:49]
    global_load_ushort v153, v6, s[50:51]
    global_load_ushort v154, v6, s[52:53]
    global_load_ushort v155, v6, s[54:55]
    global_load_ushort v156, v7, s[56:57]
    global_load_ushort v157, v7, s[58:59]
    v_mfma_f32_16x16x32_bf16 v[48:51], v[64:67], v[80:83], v[48:51]
    v_mfma_f32_16x16x32_bf16 v[32:35], v[72:75], v[64:67], v[32:35]
    s_add_u32 m0, s34, 49152
    s_add_u32 s35, s33, 1032192
    buffer_load_dwordx4 v10, s[20:23], s35 offen lds
    v_mfma_f32_16x16x32_bf16 v[52:55], v[64:67], v[84:87], v[52:55]
    v_mfma_f32_16x16x32_bf16 v[36:39], v[76:79], v[64:67], v[36:39]
    s_add_u32 m0, s34, 50176
    s_add_u32 s35, s33, 1032192
    buffer_load_dwordx4 v11, s[20:23], s35 offen lds
    v_mfma_f32_16x16x32_bf16 v[56:59], v[68:71], v[80:83], v[56:59]
    v_mfma_f32_16x16x32_bf16 v[40:43], v[72:75], v[68:71], v[40:43]
    v_mfma_f32_16x16x32_bf16 v[60:63], v[68:71], v[84:87], v[60:63]
    v_mfma_f32_16x16x32_bf16 v[44:47], v[76:79], v[68:71], v[44:47]
    s_waitcnt vmcnt(12)
    s_waitcnt lgkmcnt(10)
    s_barrier
    ds_read_b128 v[64:67], v12 offset:384
    ds_read_b128 v[68:71], v14 offset:384
    ds_read_b64_tr_b16 v[72:73], v16 offset:0
    ds_read_b64_tr_b16 v[74:75], v16 offset:8192
    ds_read_b64_tr_b16 v[76:77], v17 offset:0
    ds_read_b64_tr_b16 v[78:79], v17 offset:8192
    ds_read_b64_tr_b16 v[80:81], v16 offset:256
    ds_read_b64_tr_b16 v[82:83], v16 offset:8448
    ds_read_b64_tr_b16 v[84:85], v17 offset:256
    ds_read_b64_tr_b16 v[86:87], v17 offset:8448
    s_cmp_lg_u32 s3, 0
    s_cbranch_scc1 gf_kernel_np1
    global_load_dword v28, v21, s[8:9] sc1
    s_branch gf_kernel_np1b
gf_kernel_np1:
    global_load_dword v28, v21, s[58:59]
gf_kernel_np1b:
    v_mfma_f32_16x16x32_bf16 v[48:51], v[88:91], v[104:107], v[48:51]
    v_mfma_f32_16x16x32_bf16 v[32:35], v[96:99], v[88:91], v[32:35]
    s_add_u32 m0, s34, 65536
    s_add_u32 s35, s33, 1146880
    buffer_load_dwordx4 v10, s[20:23], s35 offen lds
    v_mfma_f32_16x16x32_bf16 v[52:55], v[88:91], v[108:111], v[52:55]
    v_mfma_f32_16x16x32_bf16 v[36:39], v[100:103], v[88:91], v[36:39]
    s_add_u32 m0, s34, 66560
    s_add_u32 s35, s33, 1146880
    buffer_load_dwordx4 v11, s[20:23], s35 offen lds
    v_mfma_f32_16x16x32_bf16 v[56:59], v[92:95], v[104:107], v[56:59]
    v_mfma_f32_16x16x32_bf16 v[40:43], v[96:99], v[92:95], v[40:43]
    v_mfma_f32_16x16x32_bf16 v[60:63], v[92:95], v[108:111], v[60:63]
    v_mfma_f32_16x16x32_bf16 v[44:47], v[100:103], v[92:95], v[44:47]
    s_waitcnt vmcnt(13)
    s_waitcnt lgkmcnt(10)
    s_barrier
    ds_read_b128 v[88:91], v13 offset:384
    ds_read_b128 v[92:95], v15 offset:384
    ds_read_b64_tr_b16 v[96:97], v16 offset:16384
    ds_read_b64_tr_b16 v[98:99], v16 offset:24576
    ds_read_b64_tr_b16 v[100:101], v17 offset:16384
    ds_read_b64_tr_b16 v[102:103], v17 offset:24576
    ds_read_b64_tr_b16 v[104:105], v16 offset:16640
    ds_read_b64_tr_b16 v[106:107], v16 offset:24832
    ds_read_b64_tr_b16 v[108:109], v17 offset:16640
    ds_read_b64_tr_b16 v[110:111], v17 offset:24832
    v_mfma_f32_16x16x32_bf16 v[48:51], v[112:115], v[128:131], v[48:51]
    v_mfma_f32_16x16x32_bf16 v[32:35], v[120:123], v[112:115], v[32:35]
    s_add_u32 m0, s34, 81920
    s_add_u32 s35, s33, 1261568
    buffer_load_dwordx4 v10, s[20:23], s35 offen lds
    v_mfma_f32_16x16x32_bf16 v[52:55], v[112:115], v[132:135], v[52:55]
    v_mfma_f32_16x16x32_bf16 v[36:39], v[124:127], v[112:115], v[36:39]
    s_add_u32 m0, s34, 82944
    s_add_u32 s35, s33, 1261568
    buffer_load_dwordx4 v11, s[20:23], s35 offen lds
    v_mfma_f32_16x16x32_bf16 v[56:59], v[116:119], v[128:131], v[56:59]
    v_mfma_f32_16x16x32_bf16 v[40:43], v[120:123], v[116:119], v[40:43]
    v_mfma_f32_16x16x32_bf16 v[60:63], v[116:119], v[132:135], v[60:63]
    v_mfma_f32_16x16x32_bf16 v[44:47], v[124:127], v[116:119], v[44:47]
    s_waitcnt vmcnt(13)
    s_waitcnt lgkmcnt(10)
    s_barrier
    ds_read_b128 v[112:115], v12 offset:512
    ds_read_b128 v[116:119], v14 offset:512
    ds_read_b64_tr_b16 v[120:121], v16 offset:32768
    ds_read_b64_tr_b16 v[122:123], v16 offset:40960
    ds_read_b64_tr_b16 v[124:125], v17 offset:32768
    ds_read_b64_tr_b16 v[126:127], v17 offset:40960
    ds_read_b64_tr_b16 v[128:129], v16 offset:33024
    ds_read_b64_tr_b16 v[130:131], v16 offset:41216
    ds_read_b64_tr_b16 v[132:133], v17 offset:33024
    ds_read_b64_tr_b16 v[134:135], v17 offset:41216
    v_mfma_f32_16x16x32_bf16 v[48:51], v[64:67], v[80:83], v[48:51]
    v_mfma_f32_16x16x32_bf16 v[32:35], v[72:75], v[64:67], v[32:35]
    s_add_u32 m0, s34, 0
    s_add_u32 s35, s33, 1376256
    buffer_load_dwordx4 v10, s[20:23], s35 offen lds
    v_mfma_f32_16x16x32_bf16 v[52:55], v[64:67], v[84:87], v[52:55]
    v_mfma_f32_16x16x32_bf16 v[36:39], v[76:79], v[64:67], v[36:39]
    s_add_u32 m0, s34, 1024
    s_add_u32 s35, s33, 1376256
    buffer_load_dwordx4 v11, s[20:23], s35 offen lds
    v_mfma_f32_16x16x32_bf16 v[56:59], v[68:71], v[80:83], v[56:59]
    v_mfma_f32_16x16x32_bf16 v[40:43], v[72:75], v[68:71], v[40:43]
    v_mfma_f32_16x16x32_bf16 v[60:63], v[68:71], v[84:87], v[60:63]
    v_mfma_f32_16x16x32_bf16 v[44:47], v[76:79], v[68:71], v[44:47]
    s_waitcnt vmcnt(7)
    s_waitcnt lgkmcnt(10)
    s_barrier
    ds_read_b128 v[64:67], v13 offset:512
    ds_read_b128 v[68:71], v15 offset:512
    ds_read_b64_tr_b16 v[72:73], v16 offset:49152
    ds_read_b64_tr_b16 v[74:75], v16 offset:57344
    ds_read_b64_tr_b16 v[76:77], v17 offset:49152
    ds_read_b64_tr_b16 v[78:79], v17 offset:57344
    ds_read_b64_tr_b16 v[80:81], v16 offset:49408
    ds_read_b64_tr_b16 v[82:83], v16 offset:57600
    ds_read_b64_tr_b16 v[84:85], v17 offset:49408
    ds_read_b64_tr_b16 v[86:87], v17 offset:57600
    v_mfma_f32_16x16x32_bf16 v[48:51], v[88:91], v[104:107], v[48:51]
    v_mfma_f32_16x16x32_bf16 v[32:35], v[96:99], v[88:91], v[32:35]
    s_add_u32 m0, s34, 16384
    s_add_u32 s35, s33, 1490944
    buffer_load_dwordx4 v10, s[20:23], s35 offen lds
    v_mfma_f32_16x16x32_bf16 v[52:55], v[88:91], v[108:111], v[52:55]
    v_mfma_f32_16x16x32_bf16 v[36:39], v[100:103], v[88:91], v[36:39]
    s_add_u32 m0, s34, 17408
    s_add_u32 s35, s33, 1490944
    buffer_load_dwordx4 v11, s[20:23], s35 offen lds
    v_mfma_f32_16x16x32_bf16 v[56:59], v[92:95], v[104:107], v[56:59]
    v_mfma_f32_16x16x32_bf16 v[40:43], v[96:99], v[92:95], v[40:43]
    v_mfma_f32_16x16x32_bf16 v[60:63], v[92:95], v[108:111], v[60:63]
    v_mfma_f32_16x16x32_bf16 v[44:47], v[100:103], v[92:95], v[44:47]
    s_waitcnt vmcnt(6)
    s_cmp_lg_u32 s3, 0
    s_cbranch_scc1 gf_kernel_np2
    s_mov_b32 s42, 0
ck_1:
    v_cmp_ne_u32 vcc, 0x01010101, v28
    s_add_u32 s42, s42, 1
    s_cmp_gt_u32 s42, 30000
    s_cbranch_scc1 ckd_2
    s_cmp_eq_u64 vcc, 0
    s_cbranch_scc1 ckd_2
    s_sleep 2
    global_load_dword v28, v21, s[8:9] sc1
    s_waitcnt vmcnt(0)
    s_branch ck_1
ckd_2:
gf_kernel_np2:
    s_waitcnt lgkmcnt(10)
    s_barrier
    ds_read_b128 v[88:91], v12 offset:640
    ds_read_b128 v[92:95], v14 offset:640
    ds_read_b64_tr_b16 v[96:97], v29 offset:0
    ds_read_b64_tr_b16 v[98:99], v29 offset:8192
    ds_read_b64_tr_b16 v[100:101], v30 offset:0
    ds_read_b64_tr_b16 v[102:103], v30 offset:8192
    ds_read_b64_tr_b16 v[104:105], v29 offset:256
    ds_read_b64_tr_b16 v[106:107], v29 offset:8448
    ds_read_b64_tr_b16 v[108:109], v30 offset:256
    ds_read_b64_tr_b16 v[110:111], v30 offset:8448
    v_mov_b32 v6, s43
    v_mov_b32 v7, 1
    s_mov_b64 exec, 1
    buffer_store_dword v7, v6, s[24:27], 0 offen sc1
    s_mov_b64 exec, -1
    v_mfma_f32_16x16x32_bf16 v[48:51], v[112:115], v[128:131], v[48:51]
    v_mfma_f32_16x16x32_bf16 v[32:35], v[120:123], v[112:115], v[32:35]
    v_mfma_f32_16x16x32_bf16 v[52:55], v[112:115], v[132:135], v[52:55]
    v_mfma_f32_16x16x32_bf16 v[36:39], v[124:127], v[112:115], v[36:39]
    v_mfma_f32_16x16x32_bf16 v[56:59], v[116:119], v[128:131], v[56:59]
    v_mfma_f32_16x16x32_bf16 v[40:43], v[120:123], v[116:119], v[40:43]
    v_mfma_f32_16x16x32_bf16 v[60:63], v[116:119], v[132:135], v[60:63]
    v_mfma_f32_16x16x32_bf16 v[44:47], v[124:127], v[116:119], v[44:47]
    s_waitcnt vmcnt(5)
    s_waitcnt lgkmcnt(10)
    s_barrier
    ds_read_b128 v[112:115], v13 offset:640
    ds_read_b128 v[116:119], v15 offset:640
    ds_read_b64_tr_b16 v[120:121], v29 offset:16384
    ds_read_b64_tr_b16 v[122:123], v29 offset:24576
    ds_read_b64_tr_b16 v[124:125], v30 offset:16384
    ds_read_b64_tr_b16 v[126:127], v30 offset:24576
    ds_read_b64_tr_b16 v[128:129], v29 offset:16640
    ds_read_b64_tr_b16 v[130:131], v29 offset:24832
    ds_read_b64_tr_b16 v[132:133], v30 offset:16640
    ds_read_b64_tr_b16 v[134:135], v30 offset:24832
    v_mfma_f32_16x16x32_bf16 v[48:51], v[64:67], v[80:83], v[48:51]
    v_mfma_f32_16x16x32_bf16 v[32:35], v[72:75], v[64:67], v[32:35]
    v_mfma_f32_16x16x32_bf16 v[52:55], v[64:67], v[84:87], v[52:55]
    v_mfma_f32_16x16x32_bf16 v[36:39], v[76:79], v[64:67], v[36:39]
    v_mfma_f32_16x16x32_bf16 v[56:59], v[68:71], v[80:83], v[56:59]
    v_mfma_f32_16x16x32_bf16 v[40:43], v[72:75], v[68:71], v[40:43]
    v_mfma_f32_16x16x32_bf16 v[60:63], v[68:71], v[84:87], v[60:63]
    v_mfma_f32_16x16x32_bf16 v[44:47], v[76:79], v[68:71], v[44:47]
    s_waitcnt vmcnt(3)
    s_waitcnt lgkmcnt(10)
    s_barrier
    ds_read_b128 v[64:67], v12 offset:768
    ds_read_b128 v[68:71], v14 offset:768
    ds_read_b64_tr_b16 v[72:73], v16 offset:0
    ds_read_b64_tr_b16 v[74:75], v16 offset:8192
    ds_read_b64_tr_b16 v[76:77], v17 offset:0
    ds_read_b64_tr_b16 v[78:79], v17 offset:8192
    ds_read_b64_tr_b16 v[80:81], v16 offset:256
    ds_read_b64_tr_b16 v[82:83], v16 offset:8448
    ds_read_b64_tr_b16 v[84:85], v17 offset:256
    ds_read_b64_tr_b16 v[86:87], v17 offset:8448
    v_mfma_f32_16x16x32_bf16 v[48:51], v[88:91], v[104:107], v[48:51]
    v_mfma_f32_16x16x32_bf16 v[32:35], v[96:99], v[88:91], v[32:35]
    v_mfma_f32_16x16x32_bf16 v[52:55], v[88:91], v[108:111], v[52:55]
    v_mfma_f32_16x16x32_bf16 v[36:39], v[100:103], v[88:91], v[36:39]
    v_mfma_f32_16x16x32_bf16 v[56:59], v[92:95], v[104:107], v[56:59]
    v_mfma_f32_16x16x32_bf16 v[40:43], v[96:99], v[92:95], v[40:43]
    v_mfma_f32_16x16x32_bf16 v[60:63], v[92:95], v[108:111], v[60:63]
    v_mfma_f32_16x16x32_bf16 v[44:47], v[100:103], v[92:95], v[44:47]
    s_waitcnt vmcnt(1)
    s_waitcnt lgkmcnt(10)
    s_barrier
    ds_read_b128 v[88:91], v13 offset:768
    ds_read_b128 v[92:95], v15 offset:768
    ds_read_b64_tr_b16 v[96:97], v16 offset:16384
    ds_read_b64_tr_b16 v[98:99], v16 offset:24576
    ds_read_b64_tr_b16 v[100:101], v17 offset:16384
    ds_read_b64_tr_b16 v[102:103], v17 offset:24576
    ds_read_b64_tr_b16 v[104:105], v16 offset:16640
    ds_read_b64_tr_b16 v[106:107], v16 offset:24832
    ds_read_b64_tr_b16 v[108:109], v17 offset:16640
    ds_read_b64_tr_b16 v[110:111], v17 offset:24832
    v_mfma_f32_16x16x32_bf16 v[48:51], v[112:115], v[128:131], v[48:51]
    v_mfma_f32_16x16x32_bf16 v[32:35], v[120:123], v[112:115], v[32:35]
    v_mfma_f32_16x16x32_bf16 v[52:55], v[112:115], v[132:135], v[52:55]
    v_mfma_f32_16x16x32_bf16 v[36:39], v[124:127], v[112:115], v[36:39]
    v_mfma_f32_16x16x32_bf16 v[56:59], v[116:119], v[128:131], v[56:59]
    v_mfma_f32_16x16x32_bf16 v[40:43], v[120:123], v[116:119], v[40:43]
    v_mfma_f32_16x16x32_bf16 v[60:63], v[116:119], v[132:135], v[60:63]
    v_mfma_f32_16x16x32_bf16 v[44:47], v[124:127], v[116:119], v[44:47]
    s_waitcnt lgkmcnt(10)
    s_lshl_b32 s39, s30, 2
    s_lshl_b32 s38, s36, 1
    s_add_u32 s39, s39, s38
    s_mul_i32 s39, s39, 28
    s_lshl_b32 s38, s31, 2
    s_add_u32 s38, s38, s37
    s_add_u32 s38, s39, s38
    s_lshl_b32 s38, s38, 10
    s_add_u32 s38, s38, 10485760
    s_add_u32 s39, s38, 28672
    v_lshlrev_b32 v7, 4, v1
    v_mov_b32 v160, -1
    v_mov_b32 v161, -1
    v_mov_b32 v162, -1
    v_mov_b32 v163, -1
    buffer_store_dwordx4 v[160:163], v7, s[24:27], s38 offen sc1
    buffer_store_dwordx4 v[160:163], v7, s[24:27], s39 offen sc1
    v_mfma_f32_16x16x32_bf16 v[48:51], v[64:67], v[80:83], v[48:51]
    v_mfma_f32_16x16x32_bf16 v[32:35], v[72:75], v[64:67], v[32:35]
    v_mfma_f32_16x16x32_bf16 v[52:55], v[64:67], v[84:87], v[52:55]
    v_mfma_f32_16x16x32_bf16 v[36:39], v[76:79], v[64:67], v[36:39]
    v_mfma_f32_16x16x32_bf16 v[56:59], v[68:71], v[80:83], v[56:59]
    v_mfma_f32_16x16x32_bf16 v[40:43], v[72:75], v[68:71], v[40:43]
    v_mfma_f32_16x16x32_bf16 v[60:63], v[68:71], v[84:87], v[60:63]
    v_mfma_f32_16x16x32_bf16 v[44:47], v[76:79], v[68:71], v[44:47]
    s_waitcnt lgkmcnt(0)
    v_mfma_f32_16x16x32_bf16 v[48:51], v[88:91], v[104:107], v[48:51]
    v_mfma_f32_16x16x32_bf16 v[32:35], v[96:99], v[88:91], v[32:35]
    v_mfma_f32_16x16x32_bf16 v[52:55], v[88:91], v[108:111], v[52:55]
    v_mfma_f32_16x16x32_bf16 v[36:39], v[100:103], v[88:91], v[36:39]
    v_mfma_f32_16x16x32_bf16 v[56:59], v[92:95], v[104:107], v[56:59]
    v_mfma_f32_16x16x32_bf16 v[40:43], v[96:99], v[92:95], v[40:43]
    v_mfma_f32_16x16x32_bf16 v[60:63], v[92:95], v[108:111], v[60:63]
    v_mfma_f32_16x16x32_bf16 v[44:47], v[100:103], v[92:95], v[44:47]
    buffer_load_dword v28, v22, s[24:27], s47 offen sc1
    v_mov_b32 v31, 0xbdd2d3e8
    s_nop 7
    v_cvt_pk_bf16_f32 v80, v48, v49
    v_cvt_pk_bf16_f32 v81, v50, v51
    v_cvt_pk_bf16_f32 v82, v52, v53
    v_cvt_pk_bf16_f32 v83, v54, v55
    v_cvt_pk_bf16_f32 v84, v56, v57
    v_cvt_pk_bf16_f32 v85, v58, v59
    v_cvt_pk_bf16_f32 v86, v60, v61
    v_cvt_pk_bf16_f32 v87, v62, v63
    v_lshlrev_b32 v48, 16, v80
    v_and_b32 v49, 0xffff0000, v80
    v_lshlrev_b32 v50, 16, v81
    v_and_b32 v51, 0xffff0000, v81
    v_lshlrev_b32 v52, 16, v82
    v_and_b32 v53, 0xffff0000, v82
    v_lshlrev_b32 v54, 16, v83
    v_and_b32 v55, 0xffff0000, v83
    v_lshlrev_b32 v56, 16, v84
    v_and_b32 v57, 0xffff0000, v84
    v_lshlrev_b32 v58, 16, v85
    v_and_b32 v59, 0xffff0000, v85
    v_lshlrev_b32 v60, 16, v86
    v_and_b32 v61, 0xffff0000, v86
    v_lshlrev_b32 v62, 16, v87
    v_and_b32 v63, 0xffff0000, v87
    v_mul_f32 v64, v48, v48
    v_mul_f32 v65, v49, v49
    v_mul_f32 v66, v50, v50
    v_mul_f32 v67, v51, v51
    v_mul_f32 v68, v52, v52
    v_mul_f32 v69, v53, v53
    v_mul_f32 v70, v54, v54
    v_mul_f32 v71, v55, v55
    v_mul_f32 v72, v56, v56
    v_mul_f32 v73, v57, v57
    v_mul_f32 v74, v58, v58
    v_mul_f32 v75, v59, v59
    v_mul_f32 v76, v60, v60
    v_mul_f32 v77, v61, v61
    v_mul_f32 v78, v62, v62
    v_mul_f32 v79, v63, v63
    v_fmaak_f32 v64, v64, v31, 0xc0135761
    v_fmaak_f32 v65, v65, v31, 0xc0135761
    v_fmaak_f32 v66, v66, v31, 0xc0135761
    v_fmaak_f32 v67, v67, v31, 0xc0135761
    v_fmaak_f32 v68, v68, v31, 0xc0135761
    v_fmaak_f32 v69, v69, v31, 0xc0135761
    v_fmaak_f32 v70, v70, v31, 0xc0135761
    v_fmaak_f32 v71, v71, v31, 0xc0135761
    v_fmaak_f32 v72, v72, v31, 0xc0135761
    v_fmaak_f32 v73, v73, v31, 0xc0135761
    v_fmaak_f32 v74, v74, v31, 0xc0135761
    v_fmaak_f32 v75, v75, v31, 0xc0135761
    v_fmaak_f32 v76, v76, v31, 0xc0135761
    v_fmaak_f32 v77, v77, v31, 0xc0135761
    v_fmaak_f32 v78, v78, v31, 0xc0135761
    v_fmaak_f32 v79, v79, v31, 0xc0135761
    v_mul_f32 v64, v64, v48
    v_mul_f32 v65, v65, v49
    v_mul_f32 v66, v66, v50
    v_mul_f32 v67, v67, v51
    v_mul_f32 v68, v68, v52
    v_mul_f32 v69, v69, v53
    v_mul_f32 v70, v70, v54
    v_mul_f32 v71, v71, v55
    v_mul_f32 v72, v72, v56
    v_mul_f32 v73, v73, v57
    v_mul_f32 v74, v74, v58
    v_mul_f32 v75, v75, v59
    v_mul_f32 v76, v76, v60
    v_mul_f32 v77, v77, v61
    v_mul_f32 v78, v78, v62
    v_mul_f32 v79, v79, v63
    v_exp_f32 v64, v64
    v_exp_f32 v65, v65
    v_exp_f32 v66, v66
    v_exp_f32 v67, v67
    v_exp_f32 v68, v68
    v_exp_f32 v69, v69
    v_exp_f32 v70, v70
    v_exp_f32 v71, v71
    v_exp_f32 v72, v72
    v_exp_f32 v73, v73
    v_exp_f32 v74, v74
    v_exp_f32 v75, v75
    v_exp_f32 v76, v76
    v_exp_f32 v77, v77
    v_exp_f32 v78, v78
    v_exp_f32 v79, v79
    v_add_f32 v64, 1.0, v64
    v_add_f32 v65, 1.0, v65
    v_add_f32 v66, 1.0, v66
    v_add_f32 v67, 1.0, v67
    v_add_f32 v68, 1.0, v68
    v_add_f32 v69, 1.0, v69
    v_add_f32 v70, 1.0, v70
    v_add_f32 v71, 1.0, v71
    v_add_f32 v72, 1.0, v72
    v_add_f32 v73, 1.0, v73
    v_add_f32 v74, 1.0, v74
    v_add_f32 v75, 1.0, v75
    v_add_f32 v76, 1.0, v76
    v_add_f32 v77, 1.0, v77
    v_add_f32 v78, 1.0, v78
    v_add_f32 v79, 1.0, v79
    v_rcp_f32 v64, v64
    v_rcp_f32 v65, v65
    v_rcp_f32 v66, v66
    v_rcp_f32 v67, v67
    v_rcp_f32 v68, v68
    v_rcp_f32 v69, v69
    v_rcp_f32 v70, v70
    v_rcp_f32 v71, v71
    v_rcp_f32 v72, v72
    v_rcp_f32 v73, v73
    v_rcp_f32 v74, v74
    v_rcp_f32 v75, v75
    v_rcp_f32 v76, v76
    v_rcp_f32 v77, v77
    v_rcp_f32 v78, v78
    v_rcp_f32 v79, v79
    v_mul_f32 v48, v48, v64
    v_mul_f32 v49, v49, v65
    v_mul_f32 v50, v50, v66
    v_mul_f32 v51, v51, v67
    v_mul_f32 v52, v52, v68
    v_mul_f32 v53, v53, v69
    v_mul_f32 v54, v54, v70
    v_mul_f32 v55, v55, v71
    v_mul_f32 v56, v56, v72
    v_mul_f32 v57, v57, v73
    v_mul_f32 v58, v58, v74
    v_mul_f32 v59, v59, v75
    v_mul_f32 v60, v60, v76
    v_mul_f32 v61, v61, v77
    v_mul_f32 v62, v62, v78
    v_mul_f32 v63, v63, v79
    v_cvt_pk_bf16_f32 v80, v48, v49
    v_cvt_pk_bf16_f32 v81, v50, v51
    v_cvt_pk_bf16_f32 v82, v52, v53
    v_cvt_pk_bf16_f32 v83, v54, v55
    v_cvt_pk_bf16_f32 v84, v56, v57
    v_cvt_pk_bf16_f32 v85, v58, v59
    v_cvt_pk_bf16_f32 v86, v60, v61
    v_cvt_pk_bf16_f32 v87, v62, v63
    v_lshlrev_b32 v48, 16, v80
    v_and_b32 v49, 0xffff0000, v80
    v_lshlrev_b32 v50, 16, v81
    v_and_b32 v51, 0xffff0000, v81
    v_lshlrev_b32 v52, 16, v82
    v_and_b32 v53, 0xffff0000, v82
    v_lshlrev_b32 v54, 16, v83
    v_and_b32 v55, 0xffff0000, v83
    v_lshlrev_b32 v56, 16, v84
    v_and_b32 v57, 0xffff0000, v84
    v_lshlrev_b32 v58, 16, v85
    v_and_b32 v59, 0xffff0000, v85
    v_lshlrev_b32 v60, 16, v86
    v_and_b32 v61, 0xffff0000, v86
    v_lshlrev_b32 v62, 16, v87
    v_and_b32 v63, 0xffff0000, v87
    v_add_f32 v96, v48, v52
    v_mul_f32 v104, v48, v48
    v_fmac_f32 v104, v52, v52
    v_add_f32 v97, v49, v53
    v_mul_f32 v105, v49, v49
    v_fmac_f32 v105, v53, v53
    v_add_f32 v98, v50, v54
    v_mul_f32 v106, v50, v50
    v_fmac_f32 v106, v54, v54
    v_add_f32 v99, v51, v55
    v_mul_f32 v107, v51, v51
    v_fmac_f32 v107, v55, v55
    v_add_f32 v100, v56, v60
    v_mul_f32 v108, v56, v56
    v_fmac_f32 v108, v60, v60
    v_add_f32 v101, v57, v61
    v_mul_f32 v109, v57, v57
    v_fmac_f32 v109, v61, v61
    v_add_f32 v102, v58, v62
    v_mul_f32 v110, v58, v58
    v_fmac_f32 v110, v62, v62
    v_add_f32 v103, v59, v63
    v_mul_f32 v111, v59, v59
    v_fmac_f32 v111, v63, v63
    s_lshl_b32 s38, s37, 9
    s_lshl_b32 s39, s36, 8
    s_add_u32 s38, s38, s39
    s_add_u32 s38, s38, 156672
    v_lshlrev_b32 v6, 5, v4
    v_add_u32 v6, s38, v6
    v_add_f32_dpp v96, v96, v96 row_ror:8 row_mask:0xf bank_mask:0x3
    v_add_f32_dpp v97, v97, v97 row_ror:8 row_mask:0xf bank_mask:0x3
    v_add_f32_dpp v98, v98, v98 row_ror:8 row_mask:0xf bank_mask:0x3
    v_add_f32_dpp v99, v99, v99 row_ror:8 row_mask:0xf bank_mask:0x3
    v_add_f32_dpp v100, v100, v100 row_ror:8 row_mask:0xf bank_mask:0x3
    v_add_f32_dpp v101, v101, v101 row_ror:8 row_mask:0xf bank_mask:0x3
    v_add_f32_dpp v102, v102, v102 row_ror:8 row_mask:0xf bank_mask:0x3
    v_add_f32_dpp v103, v103, v103 row_ror:8 row_mask:0xf bank_mask:0x3
    v_add_f32_dpp v96, v104, v104 row_ror:8 row_mask:0xf bank_mask:0xc
    v_add_f32_dpp v97, v105, v105 row_ror:8 row_mask:0xf bank_mask:0xc
    v_add_f32_dpp v98, v106, v106 row_ror:8 row_mask:0xf bank_mask:0xc
    v_add_f32_dpp v99, v107, v107 row_ror:8 row_mask:0xf bank_mask:0xc
    v_add_f32_dpp v100, v108, v108 row_ror:8 row_mask:0xf bank_mask:0xc
    v_add_f32_dpp v101, v109, v109 row_ror:8 row_mask:0xf bank_mask:0xc
    v_add_f32_dpp v102, v110, v110 row_ror:8 row_mask:0xf bank_mask:0xc
    v_add_f32_dpp v103, v111, v111 row_ror:8 row_mask:0xf bank_mask:0xc
    v_bfe_u32 v7, v3, 2, 1
    v_lshl_add_u32 v6, v7, 7, v6
    v_lshrrev_b32 v7, 3, v3
    v_lshl_add_u32 v6, v7, 2, v6
    v_and_b32 v7, 3, v3
    v_add_f32_dpp v96, v96, v96 row_ror:12 row_mask:0xf bank_mask:0x5
    v_add_f32_dpp v97, v97, v97 row_ror:12 row_mask:0xf bank_mask:0x5
    v_add_f32_dpp v98, v98, v98 row_ror:12 row_mask:0xf bank_mask:0x5
    v_add_f32_dpp v99, v99, v99 row_ror:12 row_mask:0xf bank_mask:0x5
    v_add_f32_dpp v96, v100, v100 row_ror:4 row_mask:0xf bank_mask:0xa
    v_add_f32_dpp v97, v101, v101 row_ror:4 row_mask:0xf bank_mask:0xa
    v_add_f32_dpp v98, v102, v102 row_ror:4 row_mask:0xf bank_mask:0xa
    v_add_f32_dpp v99, v103, v103 row_ror:4 row_mask:0xf bank_mask:0xa
    v_add_f32_dpp v96, v96, v96 quad_perm:[1,0,3,2] row_mask:0xf bank_mask:0xf
    v_add_f32_dpp v97, v97, v97 quad_perm:[1,0,3,2] row_mask:0xf bank_mask:0xf
    v_add_f32_dpp v98, v98, v98 quad_perm:[1,0,3,2] row_mask:0xf bank_mask:0xf
    v_add_f32_dpp v99, v99, v99 quad_perm:[1,0,3,2] row_mask:0xf bank_mask:0xf
    v_add_f32_dpp v96, v96, v96 quad_perm:[2,3,0,1] row_mask:0xf bank_mask:0xf
    v_add_f32_dpp v97, v97, v97 quad_perm:[2,3,0,1] row_mask:0xf bank_mask:0xf
    v_add_f32_dpp v98, v98, v98 quad_perm:[2,3,0,1] row_mask:0xf bank_mask:0xf
    v_add_f32_dpp v99, v99, v99 quad_perm:[2,3,0,1] row_mask:0xf bank_mask:0xf
    v_cmp_eq_u32 vcc, 0, v7
    s_and_saveexec_b64 s[40:41], vcc
    ds_write2_b32 v6, v96, v97 offset0:0 offset1:2
    ds_write2_b32 v6, v98, v99 offset0:4 offset1:6
    s_mov_b64 exec, s[40:41]
    s_waitcnt vmcnt(0) lgkmcnt(0)
    s_barrier
    s_cmp_lg_u32 s3, 0
    s_cbranch_scc1 gf_kernel_nopub
    v_lshlrev_b32 v6, 3, v1
    v_add_u32 v7, 156672, v6
    ds_read_b64 v[96:97], v7 offset:0
    ds_read_b64 v[98:99], v7 offset:512
    ds_read_b64 v[100:101], v7 offset:1024
    ds_read_b64 v[102:103], v7 offset:1536
    s_lshl_b32 s39, s31, 9
    s_add_u32 s38, s99, s39
    s_waitcnt lgkmcnt(0)
    v_pk_add_f32 v[96:97], v[96:97], v[98:99]
    v_pk_add_f32 v[100:101], v[100:101], v[102:103]
    v_pk_add_f32 v[96:97], v[96:97], v[100:101]
    buffer_store_dwordx2 v[96:97], v6, s[24:27], s38 offen sc1
gf_kernel_nopub:
    s_mov_b32 s42, 0
ck_3:
    v_cmp_eq_u32 vcc, 0, v28
    s_add_u32 s42, s42, 1
    s_cmp_gt_u32 s42, 30000
    s_cbranch_scc1 ckd_4
    s_cmp_eq_u64 vcc, 0
    s_cbranch_scc1 ckd_4
    s_sleep 2
    buffer_load_dword v28, v22, s[24:27], s47 offen sc1
    s_waitcnt vmcnt(0)
    s_branch ck_3
ckd_4:
    s_lshl_b32 s33, s64, 12
    s_add_u32 s68, s10, s33
    s_addc_u32 s69, s11, 0
    s_mov_b32 s70, 4096
    s_mov_b32 s71, 0x20000
    s_cmp_eq_u32 s65, 0
    s_cselect_b32 s33, 0, 4294966752
    v_lshlrev_b32 v7, 6, v1
    v_add_u32 v7, s33, v7
    v_add_u32 v11, 0, v7
    v_add_u32 v12, 16, v7
    v_add_u32 v13, 32, v7
    v_add_u32 v14, 48, v7
    v_add_u32 v15, 64, v7
    v_add_u32 v16, 80, v7
    v_add_u32 v17, 96, v7
    v_lshlrev_b32 v2, 5, v3
    v_lshl_add_u32 v2, v4, 3, v2
    s_lshl_b32 s33, s65, 10
    v_add_u32 v2, s33, v2
    buffer_load_dwordx4 v[216:219], v11, s[68:71], 0 offen
    buffer_load_dwordx4 v[220:223], v12, s[68:71], 0 offen
    buffer_load_dwordx4 v[224:227], v13, s[68:71], 0 offen
    buffer_load_dwordx4 v[228:231], v14, s[68:71], 0 offen
    buffer_load_dwordx4 v[232:235], v15, s[68:71], 0 offen
    buffer_load_dwordx4 v[236:239], v16, s[68:71], 0 offen
    buffer_load_dwordx4 v[240:243], v17, s[68:71], 0 offen
    buffer_load_dwordx2 v[252:253], v2, s[68:71], 0 offen offset:0
    buffer_load_dwordx2 v[254:255], v2, s[68:71], 0 offen offset:512
    v_cvt_pk_bf16_f32 v136, v32, v33
    v_cvt_pk_bf16_f32 v137, v34, v35
    v_cvt_pk_bf16_f32 v138, v36, v37
    v_cvt_pk_bf16_f32 v139, v38, v39
    v_cvt_pk_bf16_f32 v140, v40, v41
    v_cvt_pk_bf16_f32 v141, v42, v43
    v_cvt_pk_bf16_f32 v142, v44, v45
    v_cvt_pk_bf16_f32 v143, v46, v47
    s_mov_b32 s20, s14
    s_mov_b32 s21, s15
    s_mov_b32 s22, 8388608
    s_mov_b32 s23, 0x20000
    v_lshrrev_b32 v6, 3, v1
    s_lshl_b32 s32, s3, 3
    v_add_u32 v6, s32, v6
    v_and_b32 v7, 7, v1
    v_bfe_u32 v8, v6, 1, 3
    v_xor_b32 v8, v8, v7
    v_lshlrev_b32 v6, 12, v6
    v_lshl_add_u32 v18, v8, 4, v6
    s_lshl_b32 s67, s30, 18
    s_lshl_b32 s75, s3, 10
    s_add_u32 s75, s75, 58368
    s_mul_i32 s66, s3, 15504
    v_lshl_add_u32 v8, v1, 2, s66
    v_mul_u32_u24 v9, 272, v3
    v_lshl_add_u32 v9, v4, 4, v9
    v_add_u32 v9, s66, v9
    v_lshlrev_b32 v152, 16, v152
    v_lshlrev_b32 v153, 16, v153
    v_lshlrev_b32 v154, 16, v154
    v_lshlrev_b32 v155, 16, v155
    v_lshlrev_b32 v156, 16, v156
    v_lshlrev_b32 v157, 16, v157
    v_mul_f32 v156, 0x3fb8aa3b, v156
    v_exp_f32 v156, v156
    v_mul_f32 v152, 0x3fb8aa3b, v152
    v_exp_f32 v152, v152
    v_max_f32_e64 v20, |v154|, |v155|
    v_cvt_pk_bf16_f32 v156, v156, v156
    v_lshlrev_b32 v156, 16, v156
    v_cvt_pk_bf16_f32 v152, v152, v152
    v_lshlrev_b32 v152, 16, v152
    s_nop 1
    v_max_f32_dpp v20, v20, v20 row_ror:1 row_mask:0xf bank_mask:0xf
    s_nop 1
    v_max_f32_dpp v20, v20, v20 row_ror:2 row_mask:0xf bank_mask:0xf
    s_nop 1
    v_max_f32_dpp v20, v20, v20 row_ror:4 row_mask:0xf bank_mask:0xf
    s_nop 1
    v_max_f32_dpp v20, v20, v20 row_ror:8 row_mask:0xf bank_mask:0xf
    s_nop 1
    v_readlane_b32 s34, v20, 0
    v_readlane_b32 s35, v20, 16
    v_readlane_b32 s38, v20, 32
    v_readlane_b32 s39, v20, 48
    v_readfirstlane_b32 s72, v156
    v_readfirstlane_b32 s73, v157
    s_max_u32 s34, s34, s35
    s_max_u32 s38, s38, s39
    s_max_u32 s34, s34, s38
    s_max_u32 s34, s34, 0x0da24260
    v_rcp_f32 v21, s34
    v_mul_f32 v152, v152, v156
    v_mul_f32 v153, v153, v156
    v_mul_f32 v152, 0xbfb8aa3b, v152
    v_mul_f32 v153, 0x3e22f983, v153
    v_mul_f32 v154, v154, v21
    v_mul_f32 v155, v155, v21
    v_mul_f32 v178, 0x3f800000, v152
    v_mul_f32 v179, 0x3f800000, v153
    v_exp_f32 v178, v178
    v_fract_f32 v179, v179
    v_cos_f32 v172, v179
    v_sin_f32 v173, v179
    s_nop 0
    v_mul_f32 v172, v172, v178
    v_mul_f32 v173, v173, v178
    v_mul_f32 v178, 0x41000000, v152
    v_mul_f32 v179, 0x41000000, v153
    v_exp_f32 v178, v178
    v_fract_f32 v179, v179
    v_cos_f32 v174, v179
    v_sin_f32 v175, v179
    s_nop 0
    v_mul_f32 v174, v174, v178
    v_mul_f32 v175, v175, v178
    v_mul_f32 v178, 0x43000000, v152
    v_mul_f32 v179, 0x43000000, v153
    v_exp_f32 v178, v178
    v_fract_f32 v179, v179
    v_cos_f32 v176, v179
    v_sin_f32 v177, v179
    s_nop 0
    v_mul_f32 v176, v176, v178
    v_mul_f32 v177, v177, v178
    v_mov_b32 v212, 0x3c00
    ds_write_b32 v8, v212 offset:11152
    v_lshlrev_b32 v10, 3, v1
    v_cvt_pk_f16_f32 v204, v154, v155
    ds_write_b32 v8, v204 offset:0
    v_pk_mul_f32 v[198:199], v[154:155], v[172:173] op_sel:[0,0] op_sel_hi:[0,1]
    v_cvt_pk_f16_f32 v205, v174, -v175
    ds_write_b32 v8, v205 offset:11424
    v_pk_fma_f32 v[182:183], v[154:155], v[172:173], v[198:199] op_sel:[1,1,0] op_sel_hi:[1,0,1] neg_lo:[1,0,0]
    v_pk_mul_f32 v[198:199], v[182:183], v[172:173] op_sel:[0,0] op_sel_hi:[0,1]
    v_cvt_pk_f16_f32 v206, v182, v183
    ds_write_b32 v8, v206 offset:272
    v_pk_fma_f32 v[184:185], v[182:183], v[172:173], v[198:199] op_sel:[1,1,0] op_sel_hi:[1,0,1] neg_lo:[1,0,0]
    v_pk_mul_f32 v[200:201], v[174:175], v[174:175] op_sel:[0,0] op_sel_hi:[0,1]
    v_cvt_pk_f16_f32 v207, v184, v185
    ds_write_b32 v8, v207 offset:544
    v_pk_fma_f32 v[196:197], v[174:175], v[174:175], v[200:201] op_sel:[1,1,0] op_sel_hi:[1,0,1] neg_lo:[1,0,0]
    v_pk_mul_f32 v[198:199], v[184:185], v[172:173] op_sel:[0,0] op_sel_hi:[0,1]
    v_cvt_pk_f16_f32 v208, v196, -v197
    ds_write_b32 v8, v208 offset:11696
    v_pk_fma_f32 v[186:187], v[184:185], v[172:173], v[198:199] op_sel:[1,1,0] op_sel_hi:[1,0,1] neg_lo:[1,0,0]
    v_pk_mul_f32 v[198:199], v[186:187], v[172:173] op_sel:[0,0] op_sel_hi:[0,1]
    v_cvt_pk_f16_f32 v209, v186, v187
    ds_write_b32 v8, v209 offset:816
    v_pk_fma_f32 v[188:189], v[186:187], v[172:173], v[198:199] op_sel:[1,1,0] op_sel_hi:[1,0,1] neg_lo:[1,0,0]
    v_pk_mul_f32 v[200:201], v[196:197], v[174:175] op_sel:[0,0] op_sel_hi:[0,1]
    v_cvt_pk_f16_f32 v210, v188, v189
    ds_write_b32 v8, v210 offset:1088
    v_pk_fma_f32 v[196:197], v[196:197], v[174:175], v[200:201] op_sel:[1,1,0] op_sel_hi:[1,0,1] neg_lo:[1,0,0]
    v_pk_mul_f32 v[198:199], v[188:189], v[172:173] op_sel:[0,0] op_sel_hi:[0,1]
    v_cvt_pk_f16_f32 v211, v196, -v197
    ds_write_b32 v8, v211 offset:11968
    v_pk_fma_f32 v[190:191], v[188:189], v[172:173], v[198:199] op_sel:[1,1,0] op_sel_hi:[1,0,1] neg_lo:[1,0,0]
    v_pk_mul_f32 v[198:199], v[190:191], v[172:173] op_sel:[0,0] op_sel_hi:[0,1]
    v_cvt_pk_f16_f32 v204, v190, v191
    ds_write_b32 v8, v204 offset:1360
    v_pk_fma_f32 v[192:193], v[190:191], v[172:173], v[198:199] op_sel:[1,1,0] op_sel_hi:[1,0,1] neg_lo:[1,0,0]
    v_pk_mul_f32 v[200:201], v[196:197], v[174:175] op_sel:[0,0] op_sel_hi:[0,1]
    v_cvt_pk_f16_f32 v205, v192, v193
    ds_write_b32 v8, v205 offset:1632
    v_pk_fma_f32 v[196:197], v[196:197], v[174:175], v[200:201] op_sel:[1,1,0] op_sel_hi:[1,0,1] neg_lo:[1,0,0]
    v_pk_mul_f32 v[198:199], v[192:193], v[172:173] op_sel:[0,0] op_sel_hi:[0,1]
    v_cvt_pk_f16_f32 v206, v196, -v197
    ds_write_b32 v8, v206 offset:12240
    v_pk_fma_f32 v[194:195], v[192:193], v[172:173], v[198:199] op_sel:[1,1,0] op_sel_hi:[1,0,1] neg_lo:[1,0,0]
    v_pk_mul_f32 v[198:199], v[154:155], v[176:177] op_sel:[0,0] op_sel_hi:[0,1]
    v_cvt_pk_f16_f32 v207, v194, v195
    ds_write_b32 v8, v207 offset:1904
    v_pk_fma_f32 v[180:181], v[154:155], v[176:177], v[198:199] op_sel:[1,1,0] op_sel_hi:[1,0,1] neg_lo:[1,0,0]
    v_pk_mul_f32 v[198:199], v[182:183], v[176:177] op_sel:[0,0] op_sel_hi:[0,1]
    v_cvt_pk_f16_f32 v208, v180, v181
    ds_write_b32 v8, v208 offset:2176
    v_pk_fma_f32 v[182:183], v[182:183], v[176:177], v[198:199] op_sel:[1,1,0] op_sel_hi:[1,0,1] neg_lo:[1,0,0]
    v_pk_mul_f32 v[198:199], v[184:185], v[176:177] op_sel:[0,0] op_sel_hi:[0,1]
    v_cvt_pk_f16_f32 v209, v182, v183
    ds_write_b32 v8, v209 offset:2448
    v_pk_fma_f32 v[184:185], v[184:185], v[176:177], v[198:199] op_sel:[1,1,0] op_sel_hi:[1,0,1] neg_lo:[1,0,0]
    v_pk_mul_f32 v[198:199], v[186:187], v[176:177] op_sel:[0,0] op_sel_hi:[0,1]
    v_cvt_pk_f16_f32 v210, v184, v185
    ds_write_b32 v8, v210 offset:2720
    v_pk_fma_f32 v[186:187], v[186:187], v[176:177], v[198:199] op_sel:[1,1,0] op_sel_hi:[1,0,1] neg_lo:[1,0,0]
    v_pk_mul_f32 v[198:199], v[188:189], v[176:177] op_sel:[0,0] op_sel_hi:[0,1]
    v_cvt_pk_f16_f32 v211, v186, v187
    ds_write_b32 v8, v211 offset:2992
    v_pk_fma_f32 v[188:189], v[188:189], v[176:177], v[198:199] op_sel:[1,1,0] op_sel_hi:[1,0,1] neg_lo:[1,0,0]
    v_pk_mul_f32 v[198:199], v[190:191], v[176:177] op_sel:[0,0] op_sel_hi:[0,1]
    v_cvt_pk_f16_f32 v204, v188, v189
    ds_write_b32 v8, v204 offset:3264
    v_pk_fma_f32 v[190:191], v[190:191], v[176:177], v[198:199] op_sel:[1,1,0] op_sel_hi:[1,0,1] neg_lo:[1,0,0]
    v_pk_mul_f32 v[198:199], v[192:193], v[176:177] op_sel:[0,0] op_sel_hi:[0,1]
    v_cvt_pk_f16_f32 v205, v190, v191
    ds_write_b32 v8, v205 offset:3536
    v_pk_fma_f32 v[192:193], v[192:193], v[176:177], v[198:199] op_sel:[1,1,0] op_sel_hi:[1,0,1] neg_lo:[1,0,0]
    v_pk_mul_f32 v[198:199], v[194:195], v[176:177] op_sel:[0,0] op_sel_hi:[0,1]
    v_cvt_pk_f16_f32 v206, v192, v193
    ds_write_b32 v8, v206 offset:3808
    v_pk_fma_f32 v[194:195], v[194:195], v[176:177], v[198:199] op_sel:[1,1,0] op_sel_hi:[1,0,1] neg_lo:[1,0,0]
    v_pk_mul_f32 v[198:199], v[180:181], v[176:177] op_sel:[0,0] op_sel_hi:[0,1]
    v_cvt_pk_f16_f32 v207, v194, v195
    ds_write_b32 v8, v207 offset:4080
    v_pk_fma_f32 v[180:181], v[180:181], v[176:177], v[198:199] op_sel:[1,1,0] op_sel_hi:[1,0,1] neg_lo:[1,0,0]
    v_pk_mul_f32 v[198:199], v[184:185], v[176:177] op_sel:[0,0] op_sel_hi:[0,1]
    v_cvt_pk_f16_f32 v208, v180, v181
    ds_write_b32 v8, v208 offset:4352
    v_pk_fma_f32 v[184:185], v[184:185], v[176:177], v[198:199] op_sel:[1,1,0] op_sel_hi:[1,0,1] neg_lo:[1,0,0]
    v_pk_mul_f32 v[198:199], v[188:189], v[176:177] op_sel:[0,0] op_sel_hi:[0,1]
    v_cvt_pk_f16_f32 v209, v184, v185
    ds_write_b32 v8, v209 offset:4624
    v_pk_fma_f32 v[188:189], v[188:189], v[176:177], v[198:199] op_sel:[1,1,0] op_sel_hi:[1,0,1] neg_lo:[1,0,0]
    v_pk_mul_f32 v[198:199], v[192:193], v[176:177] op_sel:[0,0] op_sel_hi:[0,1]
    v_cvt_pk_f16_f32 v210, v188, v189
    ds_write_b32 v8, v210 offset:4896
    v_pk_fma_f32 v[192:193], v[192:193], v[176:177], v[198:199] op_sel:[1,1,0] op_sel_hi:[1,0,1] neg_lo:[1,0,0]
    v_pk_mul_f32 v[198:199], v[180:181], v[176:177] op_sel:[0,0] op_sel_hi:[0,1]
    v_cvt_pk_f16_f32 v211, v192, v193
    ds_write_b32 v8, v211 offset:5168
    v_pk_fma_f32 v[180:181], v[180:181], v[176:177], v[198:199] op_sel:[1,1,0] op_sel_hi:[1,0,1] neg_lo:[1,0,0]
    v_pk_mul_f32 v[198:199], v[184:185], v[176:177] op_sel:[0,0] op_sel_hi:[0,1]
    v_cvt_pk_f16_f32 v204, v180, v181
    ds_write_b32 v8, v204 offset:5440
    v_pk_fma_f32 v[184:185], v[184:185], v[176:177], v[198:199] op_sel:[1,1,0] op_sel_hi:[1,0,1] neg_lo:[1,0,0]
    v_pk_mul_f32 v[198:199], v[188:189], v[176:177] op_sel:[0,0] op_sel_hi:[0,1]
    v_cvt_pk_f16_f32 v205, v184, v185
    ds_write_b32 v8, v205 offset:5712
    v_pk_fma_f32 v[188:189], v[188:189], v[176:177], v[198:199] op_sel:[1,1,0] op_sel_hi:[1,0,1] neg_lo:[1,0,0]
    v_pk_mul_f32 v[198:199], v[192:193], v[176:177] op_sel:[0,0] op_sel_hi:[0,1]
    v_cvt_pk_f16_f32 v206, v188, v189
    ds_write_b32 v8, v206 offset:5984
    v_pk_fma_f32 v[192:193], v[192:193], v[176:177], v[198:199] op_sel:[1,1,0] op_sel_hi:[1,0,1] neg_lo:[1,0,0]
    v_pk_mul_f32 v[198:199], v[180:181], v[176:177] op_sel:[0,0] op_sel_hi:[0,1]
    v_cvt_pk_f16_f32 v207, v192, v193
    ds_write_b32 v8, v207 offset:6256
    v_pk_fma_f32 v[180:181], v[180:181], v[176:177], v[198:199] op_sel:[1,1,0] op_sel_hi:[1,0,1] neg_lo:[1,0,0]
    v_pk_mul_f32 v[200:201], v[196:197], v[174:175] op_sel:[0,0] op_sel_hi:[0,1]
    v_cvt_pk_f16_f32 v208, v180, v181
    ds_write_b32 v8, v208 offset:6528
    v_pk_fma_f32 v[196:197], v[196:197], v[174:175], v[200:201] op_sel:[1,1,0] op_sel_hi:[1,0,1] neg_lo:[1,0,0]
    s_cmp_lg_u32 s3, 0
    s_cbranch_scc1 gf_kernel_nsl
    buffer_load_dwordx2 v[32:33], v10, s[24:27], s99 offen offset:0 sc1
    buffer_load_dwordx2 v[34:35], v10, s[24:27], s99 offen offset:512 sc1
    buffer_load_dwordx2 v[36:37], v10, s[24:27], s99 offen offset:1024 sc1
    buffer_load_dwordx2 v[38:39], v10, s[24:27], s99 offen offset:1536 sc1
    buffer_load_dwordx2 v[40:41], v10, s[24:27], s99 offen offset:2048 sc1
    buffer_load_dwordx2 v[42:43], v10, s[24:27], s99 offen offset:2560 sc1
    buffer_load_dwordx2 v[44:45], v10, s[24:27], s99 offen offset:3072 sc1
gf_kernel_nsl:
    v_pk_mul_f32 v[198:199], v[188:189], v[176:177] op_sel:[0,0] op_sel_hi:[0,1]
    v_cvt_pk_f16_f32 v209, v196, -v197
    ds_write_b32 v8, v209 offset:12512
    v_pk_fma_f32 v[188:189], v[188:189], v[176:177], v[198:199] op_sel:[1,1,0] op_sel_hi:[1,0,1] neg_lo:[1,0,0]
    v_pk_mul_f32 v[200:201], v[196:197], v[174:175] op_sel:[0,0] op_sel_hi:[0,1]
    v_cvt_pk_f16_f32 v210, v188, v189
    ds_write_b32 v8, v210 offset:6800
    v_pk_fma_f32 v[196:197], v[196:197], v[174:175], v[200:201] op_sel:[1,1,0] op_sel_hi:[1,0,1] neg_lo:[1,0,0]
    v_pk_mul_f32 v[198:199], v[180:181], v[176:177] op_sel:[0,0] op_sel_hi:[0,1]
    v_cvt_pk_f16_f32 v211, v196, -v197
    ds_write_b32 v8, v211 offset:12784
    v_pk_fma_f32 v[180:181], v[180:181], v[176:177], v[198:199] op_sel:[1,1,0] op_sel_hi:[1,0,1] neg_lo:[1,0,0]
    v_pk_mul_f32 v[200:201], v[196:197], v[174:175] op_sel:[0,0] op_sel_hi:[0,1]
    v_cvt_pk_f16_f32 v204, v180, v181
    ds_write_b32 v8, v204 offset:7072
    v_pk_fma_f32 v[196:197], v[196:197], v[174:175], v[200:201] op_sel:[1,1,0] op_sel_hi:[1,0,1] neg_lo:[1,0,0]
    v_pk_mul_f32 v[198:199], v[188:189], v[176:177] op_sel:[0,0] op_sel_hi:[0,1]
    v_cvt_pk_f16_f32 v205, v196, -v197
    ds_write_b32 v8, v205 offset:13056
    v_pk_fma_f32 v[188:189], v[188:189], v[176:177], v[198:199] op_sel:[1,1,0] op_sel_hi:[1,0,1] neg_lo:[1,0,0]
    v_pk_mul_f32 v[200:201], v[196:197], v[174:175] op_sel:[0,0] op_sel_hi:[0,1]
    v_cvt_pk_f16_f32 v206, v188, v189
    ds_write_b32 v8, v206 offset:7344
    v_pk_fma_f32 v[196:197], v[196:197], v[174:175], v[200:201] op_sel:[1,1,0] op_sel_hi:[1,0,1] neg_lo:[1,0,0]
    v_pk_mul_f32 v[198:199], v[180:181], v[176:177] op_sel:[0,0] op_sel_hi:[0,1]
    v_cvt_pk_f16_f32 v207, v196, -v197
    ds_write_b32 v8, v207 offset:13328
    v_pk_fma_f32 v[180:181], v[180:181], v[176:177], v[198:199] op_sel:[1,1,0] op_sel_hi:[1,0,1] neg_lo:[1,0,0]
    v_pk_mul_f32 v[200:201], v[196:197], v[174:175] op_sel:[0,0] op_sel_hi:[0,1]
    v_cvt_pk_f16_f32 v208, v180, v181
    ds_write_b32 v8, v208 offset:7616
    v_pk_fma_f32 v[196:197], v[196:197], v[174:175], v[200:201] op_sel:[1,1,0] op_sel_hi:[1,0,1] neg_lo:[1,0,0]
    v_pk_mul_f32 v[198:199], v[188:189], v[176:177] op_sel:[0,0] op_sel_hi:[0,1]
    v_cvt_pk_f16_f32 v209, v196, -v197
    ds_write_b32 v8, v209 offset:13600
    v_pk_fma_f32 v[188:189], v[188:189], v[176:177], v[198:199] op_sel:[1,1,0] op_sel_hi:[1,0,1] neg_lo:[1,0,0]
    v_pk_mul_f32 v[200:201], v[196:197], v[174:175] op_sel:[0,0] op_sel_hi:[0,1]
    v_cvt_pk_f16_f32 v210, v188, v189
    ds_write_b32 v8, v210 offset:7888
    v_pk_fma_f32 v[196:197], v[196:197], v[174:175], v[200:201] op_sel:[1,1,0] op_sel_hi:[1,0,1] neg_lo:[1,0,0]
    v_pk_mul_f32 v[198:199], v[180:181], v[176:177] op_sel:[0,0] op_sel_hi:[0,1]
    v_cvt_pk_f16_f32 v211, v196, -v197
    ds_write_b32 v8, v211 offset:13872
    v_pk_fma_f32 v[180:181], v[180:181], v[176:177], v[198:199] op_sel:[1,1,0] op_sel_hi:[1,0,1] neg_lo:[1,0,0]
    v_pk_mul_f32 v[200:201], v[196:197], v[174:175] op_sel:[0,0] op_sel_hi:[0,1]
    v_cvt_pk_f16_f32 v204, v180, v181
    ds_write_b32 v8, v204 offset:8160
    v_pk_fma_f32 v[196:197], v[196:197], v[174:175], v[200:201] op_sel:[1,1,0] op_sel_hi:[1,0,1] neg_lo:[1,0,0]
    v_pk_mul_f32 v[198:199], v[188:189], v[176:177] op_sel:[0,0] op_sel_hi:[0,1]
    v_cvt_pk_f16_f32 v205, v196, -v197
    ds_write_b32 v8, v205 offset:14144
    v_pk_fma_f32 v[188:189], v[188:189], v[176:177], v[198:199] op_sel:[1,1,0] op_sel_hi:[1,0,1] neg_lo:[1,0,0]
    v_pk_mul_f32 v[200:201], v[196:197], v[174:175] op_sel:[0,0] op_sel_hi:[0,1]
    v_cvt_pk_f16_f32 v206, v188, v189
    ds_write_b32 v8, v206 offset:8432
    v_pk_fma_f32 v[196:197], v[196:197], v[174:175], v[200:201] op_sel:[1,1,0] op_sel_hi:[1,0,1] neg_lo:[1,0,0]
    v_pk_mul_f32 v[198:199], v[180:181], v[176:177] op_sel:[0,0] op_sel_hi:[0,1]
    v_cvt_pk_f16_f32 v207, v196, -v197
    ds_write_b32 v8, v207 offset:14416
    v_pk_fma_f32 v[180:181], v[180:181], v[176:177], v[198:199] op_sel:[1,1,0] op_sel_hi:[1,0,1] neg_lo:[1,0,0]
    v_pk_mul_f32 v[200:201], v[196:197], v[174:175] op_sel:[0,0] op_sel_hi:[0,1]
    v_cvt_pk_f16_f32 v208, v180, v181
    ds_write_b32 v8, v208 offset:8704
    v_pk_fma_f32 v[196:197], v[196:197], v[174:175], v[200:201] op_sel:[1,1,0] op_sel_hi:[1,0,1] neg_lo:[1,0,0]
    v_pk_mul_f32 v[198:199], v[180:181], v[176:177] op_sel:[0,0] op_sel_hi:[0,1]
    v_cvt_pk_f16_f32 v209, v196, -v197
    ds_write_b32 v8, v209 offset:14688
    v_pk_fma_f32 v[180:181], v[180:181], v[176:177], v[198:199] op_sel:[1,1,0] op_sel_hi:[1,0,1] neg_lo:[1,0,0]
    v_pk_mul_f32 v[200:201], v[196:197], v[174:175] op_sel:[0,0] op_sel_hi:[0,1]
    v_cvt_pk_f16_f32 v210, v180, v181
    ds_write_b32 v8, v210 offset:8976
    v_pk_fma_f32 v[196:197], v[196:197], v[174:175], v[200:201] op_sel:[1,1,0] op_sel_hi:[1,0,1] neg_lo:[1,0,0]
    v_pk_mul_f32 v[198:199], v[180:181], v[176:177] op_sel:[0,0] op_sel_hi:[0,1]
    v_cvt_pk_f16_f32 v211, v196, -v197
    ds_write_b32 v8, v211 offset:14960
    v_pk_fma_f32 v[180:181], v[180:181], v[176:177], v[198:199] op_sel:[1,1,0] op_sel_hi:[1,0,1] neg_lo:[1,0,0]
    v_pk_mul_f32 v[200:201], v[196:197], v[174:175] op_sel:[0,0] op_sel_hi:[0,1]
    v_cvt_pk_f16_f32 v204, v180, v181
    ds_write_b32 v8, v204 offset:9248
    v_pk_fma_f32 v[196:197], v[196:197], v[174:175], v[200:201] op_sel:[1,1,0] op_sel_hi:[1,0,1] neg_lo:[1,0,0]
    v_pk_mul_f32 v[198:199], v[180:181], v[176:177] op_sel:[0,0] op_sel_hi:[0,1]
    v_cvt_pk_f16_f32 v205, v196, -v197
    ds_write_b32 v8, v205 offset:15232
    v_pk_fma_f32 v[180:181], v[180:181], v[176:177], v[198:199] op_sel:[1,1,0] op_sel_hi:[1,0,1] neg_lo:[1,0,0]
    v_pk_mul_f32 v[198:199], v[180:181], v[176:177] op_sel:[0,0] op_sel_hi:[0,1]
    v_cvt_pk_f16_f32 v206, v180, v181
    ds_write_b32 v8, v206 offset:9520
    v_pk_fma_f32 v[180:181], v[180:181], v[176:177], v[198:199] op_sel:[1,1,0] op_sel_hi:[1,0,1] neg_lo:[1,0,0]
    v_pk_mul_f32 v[198:199], v[180:181], v[176:177] op_sel:[0,0] op_sel_hi:[0,1]
    v_cvt_pk_f16_f32 v207, v180, v181
    ds_write_b32 v8, v207 offset:9792
    v_pk_fma_f32 v[180:181], v[180:181], v[176:177], v[198:199] op_sel:[1,1,0] op_sel_hi:[1,0,1] neg_lo:[1,0,0]
    v_pk_mul_f32 v[198:199], v[180:181], v[176:177] op_sel:[0,0] op_sel_hi:[0,1]
    v_cvt_pk_f16_f32 v208, v180, v181
    ds_write_b32 v8, v208 offset:10064
    v_pk_fma_f32 v[180:181], v[180:181], v[176:177], v[198:199] op_sel:[1,1,0] op_sel_hi:[1,0,1] neg_lo:[1,0,0]
    v_pk_mul_f32 v[198:199], v[180:181], v[176:177] op_sel:[0,0] op_sel_hi:[0,1]
    v_cvt_pk_f16_f32 v209, v180, v181
    ds_write_b32 v8, v209 offset:10336
    v_pk_fma_f32 v[180:181], v[180:181], v[176:177], v[198:199] op_sel:[1,1,0] op_sel_hi:[1,0,1] neg_lo:[1,0,0]
    v_pk_mul_f32 v[198:199], v[180:181], v[176:177] op_sel:[0,0] op_sel_hi:[0,1]
    v_cvt_pk_f16_f32 v210, v180, v181
    ds_write_b32 v8, v210 offset:10608
    v_pk_fma_f32 v[180:181], v[180:181], v[176:177], v[198:199] op_sel:[1,1,0] op_sel_hi:[1,0,1] neg_lo:[1,0,0]
    v_cvt_pk_f16_f32 v211, v180, v181
    ds_write_b32 v8, v211 offset:10880
    s_waitcnt lgkmcnt(0)
    ds_read_b128 v[76:79], v9 offset:11152
    ds_read_b128 v[64:67], v9 offset:0
    ds_read_b128 v[68:71], v9 offset:4352
    ds_read_b128 v[72:75], v9 offset:8704
    ds_read_b128 v[92:95], v9 offset:11216
    ds_read_b128 v[80:83], v9 offset:64
    ds_read_b128 v[84:87], v9 offset:4416
    ds_read_b128 v[88:91], v9 offset:8768
    ds_read_b128 v[108:111], v9 offset:11280
    ds_read_b128 v[96:99], v9 offset:128
    ds_read_b128 v[100:103], v9 offset:4480
    ds_read_b128 v[104:107], v9 offset:8832
    ds_read_b128 v[124:127], v9 offset:11344
    ds_read_b128 v[112:115], v9 offset:192
    ds_read_b128 v[116:119], v9 offset:4544
    ds_read_b128 v[120:123], v9 offset:8896
    s_waitcnt lgkmcnt(12)
    v_mfma_f32_16x16x32_f16 v[160:163], v[64:67], v[76:79], 0
    v_mfma_f32_16x16x32_f16 v[164:167], v[68:71], v[76:79], 0
    v_mfma_f32_16x16x32_f16 v[168:171], v[72:75], v[76:79], 0
    s_waitcnt lgkmcnt(8)
    v_mfma_f32_16x16x32_f16 v[160:163], v[80:83], v[92:95], v[160:163]
    v_mfma_f32_16x16x32_f16 v[164:167], v[84:87], v[92:95], v[164:167]
    v_mfma_f32_16x16x32_f16 v[168:171], v[88:91], v[92:95], v[168:171]
    s_waitcnt lgkmcnt(4)
    v_mfma_f32_16x16x32_f16 v[160:163], v[96:99], v[108:111], v[160:163]
    v_mfma_f32_16x16x32_f16 v[164:167], v[100:103], v[108:111], v[164:167]
    v_mfma_f32_16x16x32_f16 v[168:171], v[104:107], v[108:111], v[168:171]
    s_waitcnt lgkmcnt(0)
    v_mfma_f32_16x16x32_f16 v[160:163], v[112:115], v[124:127], v[160:163]
    v_mfma_f32_16x16x32_f16 v[164:167], v[116:119], v[124:127], v[164:167]
    v_mfma_f32_16x16x32_f16 v[168:171], v[120:123], v[124:127], v[168:171]
    v_lshl_add_u32 v8, v1, 4, s66
    v_mov_b32 v22, s34
    v_mov_b32 v23, s66
    s_nop 7
    v_mul_f32 v160, s34, v160
    v_mul_f32 v161, s34, v161
    v_mul_f32 v162, s34, v162
    v_mul_f32 v163, s34, v163
    v_mul_f32 v164, s34, v164
    v_mul_f32 v165, s34, v165
    v_mul_f32 v166, s34, v166
    v_mul_f32 v167, s34, v167
    v_mul_f32 v168, s34, v168
    v_mul_f32 v169, s34, v169
    v_mul_f32 v170, s34, v170
    v_mul_f32 v171, s34, v171
    ds_write_b128 v8, v[160:163] offset:0
    ds_write_b128 v8, v[164:167] offset:1024
    ds_write_b128 v8, v[168:171] offset:2048
    ds_write_b32 v23, v22 offset:3072
    s_cmp_lg_u32 s3, 0
    s_cbranch_scc1 gf_kernel_nopoll
    s_mov_b32 s42, 0
gf_kernel_sp:
    s_waitcnt vmcnt(0)
    v_max3_u32 v6, v32, v33, v34
    v_max3_u32 v6, v6, v35, v36
    v_max3_u32 v6, v6, v37, v38
    v_max3_u32 v6, v6, v39, v40
    v_max3_u32 v6, v6, v41, v42
    v_max3_u32 v6, v6, v43, v44
    v_max_u32 v6, v6, v45
    v_cmp_eq_u32 vcc, -1, v6
    s_add_u32 s42, s42, 1
    s_cmp_gt_u32 s42, 30000
    s_cbranch_scc1 gf_kernel_spd
    s_cmp_eq_u64 vcc, 0
    s_cbranch_scc1 gf_kernel_spd
    s_sleep 6
    buffer_load_dwordx2 v[32:33], v10, s[24:27], s99 offen offset:0 sc1
    buffer_load_dwordx2 v[34:35], v10, s[24:27], s99 offen offset:512 sc1
    buffer_load_dwordx2 v[36:37], v10, s[24:27], s99 offen offset:1024 sc1
    buffer_load_dwordx2 v[38:39], v10, s[24:27], s99 offen offset:1536 sc1
    buffer_load_dwordx2 v[40:41], v10, s[24:27], s99 offen offset:2048 sc1
    buffer_load_dwordx2 v[42:43], v10, s[24:27], s99 offen offset:2560 sc1
    buffer_load_dwordx2 v[44:45], v10, s[24:27], s99 offen offset:3072 sc1
    s_branch gf_kernel_sp
gf_kernel_spd:
    v_pk_add_f32 v[96:97], v[32:33], v[34:35]
    v_mov_b32 v6, v10
    v_pk_add_f32 v[96:97], v[96:97], v[36:37]
    v_pk_add_f32 v[96:97], v[96:97], v[38:39]
    v_pk_add_f32 v[96:97], v[96:97], v[40:41]
    v_pk_add_f32 v[96:97], v[96:97], v[42:43]
    v_pk_add_f32 v[96:97], v[96:97], v[44:45]
    v_mul_f32 v96, 0x3a924925, v96
    v_mul_f32 v97, 0x3a924925, v97
    v_fma_f32 v97, -v96, v96, v97
    v_max_f32 v97, 0, v97
    v_cvt_pk_bf16_f32 v97, v97, v97
    v_lshlrev_b32 v97, 16, v97
    v_add_f32 v97, 0x3727c5ac, v97
    v_cvt_pk_bf16_f32 v97, v97, v97
    v_lshlrev_b32 v97, 16, v97
    v_sqrt_f32 v97, v97
    s_nop 0
    v_cvt_pk_bf16_f32 v97, v97, v97
    v_lshlrev_b32 v97, 16, v97
    v_rcp_f32 v98, v97
    v_cvt_pk_bf16_f32 v96, v96, v96
    v_lshlrev_b32 v96, 16, v96
    v_fma_f32 v99, -v97, v98, 1.0
    v_fma_f32 v97, v99, v98, v98
    v_add_u32 v6, 158720, v6
    ds_write_b64 v6, v[96:97]
gf_kernel_nopoll:
    s_waitcnt lgkmcnt(0)
    s_barrier
    s_lshl_b32 s38, s36, 8
    s_add_u32 s38, s38, 158720
    v_lshlrev_b32 v6, 5, v4
    v_add_u32 v6, s38, v6
    ds_read_b128 v[96:99], v6 offset:0
    ds_read_b128 v[100:103], v6 offset:16
    ds_read_b128 v[104:107], v6 offset:128
    ds_read_b128 v[108:111], v6 offset:144
    s_waitcnt lgkmcnt(0)
    v_sub_f32 v48, v48, v96
    v_sub_f32 v49, v49, v98
    v_sub_f32 v50, v50, v100
    v_sub_f32 v51, v51, v102
    v_cvt_pk_bf16_f32 v80, v48, v49
    v_cvt_pk_bf16_f32 v81, v50, v51
    v_lshlrev_b32 v48, 16, v80
    v_and_b32 v49, 0xffff0000, v80
    v_lshlrev_b32 v50, 16, v81
    v_and_b32 v51, 0xffff0000, v81
    v_mul_f32 v48, v48, v97
    v_mul_f32 v49, v49, v99
    v_mul_f32 v50, v50, v101
    v_mul_f32 v51, v51, v103
    v_cvt_pk_bf16_f32 v64, v48, v49
    v_cvt_pk_bf16_f32 v65, v50, v51
    v_sub_f32 v52, v52, v96
    v_sub_f32 v53, v53, v98
    v_sub_f32 v54, v54, v100
    v_sub_f32 v55, v55, v102
    v_cvt_pk_bf16_f32 v82, v52, v53
    v_cvt_pk_bf16_f32 v83, v54, v55
    v_lshlrev_b32 v52, 16, v82
    v_and_b32 v53, 0xffff0000, v82
    v_lshlrev_b32 v54, 16, v83
    v_and_b32 v55, 0xffff0000, v83
    v_mul_f32 v52, v52, v97
    v_mul_f32 v53, v53, v99
    v_mul_f32 v54, v54, v101
    v_mul_f32 v55, v55, v103
    v_cvt_pk_bf16_f32 v68, v52, v53
    v_cvt_pk_bf16_f32 v69, v54, v55
    v_sub_f32 v56, v56, v104
    v_sub_f32 v57, v57, v106
    v_sub_f32 v58, v58, v108
    v_sub_f32 v59, v59, v110
    v_cvt_pk_bf16_f32 v84, v56, v57
    v_cvt_pk_bf16_f32 v85, v58, v59
    v_lshlrev_b32 v56, 16, v84
    v_and_b32 v57, 0xffff0000, v84
    v_lshlrev_b32 v58, 16, v85
    v_and_b32 v59, 0xffff0000, v85
    v_mul_f32 v56, v56, v105
    v_mul_f32 v57, v57, v107
    v_mul_f32 v58, v58, v109
    v_mul_f32 v59, v59, v111
    v_cvt_pk_bf16_f32 v66, v56, v57
    v_cvt_pk_bf16_f32 v67, v58, v59
    v_sub_f32 v60, v60, v104
    v_sub_f32 v61, v61, v106
    v_sub_f32 v62, v62, v108
    v_sub_f32 v63, v63, v110
    v_cvt_pk_bf16_f32 v86, v60, v61
    v_cvt_pk_bf16_f32 v87, v62, v63
    v_lshlrev_b32 v60, 16, v86
    v_and_b32 v61, 0xffff0000, v86
    v_lshlrev_b32 v62, 16, v87
    v_and_b32 v63, 0xffff0000, v87
    v_mul_f32 v60, v60, v105
    v_mul_f32 v61, v61, v107
    v_mul_f32 v62, v62, v109
    v_mul_f32 v63, v63, v111
    v_cvt_pk_bf16_f32 v70, v60, v61
    v_cvt_pk_bf16_f32 v71, v62, v63
    s_nop 1
    v_permlane32_swap_b32 v64, v66
    v_permlane32_swap_b32 v65, v67
    v_permlane32_swap_b32 v68, v70
    v_permlane32_swap_b32 v69, v71
    s_nop 1
    v_permlane16_swap_b32 v64, v66
    v_permlane16_swap_b32 v65, v67
    v_permlane16_swap_b32 v68, v70
    v_permlane16_swap_b32 v69, v71
    s_lshl_b32 s35, s31, 2
    s_add_u32 s35, s35, s37
    s_lshl_b32 s38, s35, 6
    s_lshl_b32 s39, s30, 1
    s_add_u32 s38, s38, s39
    s_add_u32 s38, s38, s36
    s_lshl_b32 s38, s38, 11
    s_add_u32 s38, s38, 6291456
    v_lshlrev_b32 v5, 4, v1
    s_waitcnt vmcnt(0)
    buffer_store_dwordx4 v[64:67], v5, s[24:27], s38 offen offset:0 sc1
    buffer_store_dwordx4 v[68:71], v5, s[24:27], s38 offen offset:1024 sc1
    s_mul_i32 s66, s36, 62016
    v_add_u32 v8, s66, v5
    v_mov_b32 v9, s66
    ds_read_b128 v[32:35], v8 offset:0
    ds_read_b128 v[36:39], v8 offset:1024
    ds_read_b128 v[40:43], v8 offset:2048
    ds_read_b32 v80, v9 offset:3072
    ds_read_b128 v[44:47], v8 offset:15504
    ds_read_b128 v[48:51], v8 offset:16528
    ds_read_b128 v[52:55], v8 offset:17552
    ds_read_b32 v81, v9 offset:18576
    ds_read_b128 v[56:59], v8 offset:31008
    ds_read_b128 v[60:63], v8 offset:32032
    ds_read_b128 v[64:67], v8 offset:33056
    ds_read_b32 v82, v9 offset:34080
    ds_read_b128 v[68:71], v8 offset:46512
    ds_read_b128 v[72:75], v8 offset:47536
    ds_read_b128 v[76:79], v8 offset:48560
    ds_read_b32 v83, v9 offset:49584
    s_waitcnt lgkmcnt(0)
    v_max3_f32 v80, v80, v81, v82
    v_max_f32 v80, v80, v83
    v_rcp_f32 v81, v80
    v_pk_add_f32 v[32:33], v[32:33], v[44:45]
    v_pk_add_f32 v[56:57], v[56:57], v[68:69]
    v_pk_add_f32 v[34:35], v[34:35], v[46:47]
    v_pk_add_f32 v[58:59], v[58:59], v[70:71]
    v_pk_add_f32 v[36:37], v[36:37], v[48:49]
    v_pk_add_f32 v[60:61], v[60:61], v[72:73]
    v_pk_add_f32 v[38:39], v[38:39], v[50:51]
    v_pk_add_f32 v[62:63], v[62:63], v[74:75]
    v_pk_add_f32 v[40:41], v[40:41], v[52:53]
    v_pk_add_f32 v[64:65], v[64:65], v[76:77]
    v_pk_add_f32 v[42:43], v[42:43], v[54:55]
    v_pk_add_f32 v[66:67], v[66:67], v[78:79]
    v_pk_add_f32 v[32:33], v[32:33], v[56:57]
    v_pk_add_f32 v[34:35], v[34:35], v[58:59]
    v_pk_add_f32 v[36:37], v[36:37], v[60:61]
    v_pk_add_f32 v[38:39], v[38:39], v[62:63]
    v_pk_add_f32 v[40:41], v[40:41], v[64:65]
    v_pk_add_f32 v[42:43], v[42:43], v[66:67]
    v_mul_f32 v20, v32, v81
    v_mul_f32 v21, v33, v81
    v_mul_f32 v22, v34, v81
    v_mul_f32 v23, v35, v81
    v_mul_f32 v24, v36, v81
    v_mul_f32 v25, v37, v81
    v_mul_f32 v26, v38, v81
    v_mul_f32 v27, v39, v81
    v_mul_f32 v28, v40, v81
    v_mul_f32 v29, v41, v81
    v_mul_f32 v30, v42, v81
    v_mul_f32 v31, v43, v81
    v_mul_f32 v80, s72, v80
    v_add_f32 v80, v80, v80
    s_nop 0
    v_readfirstlane_b32 s74, v80
    v_readlane_b32 s44, v24, 0
    v_readlane_b32 s45, v24, 32
    v_readlane_b32 s46, v28, 0
    v_mov_b32 v9, 0
    s_barrier
    s_add_u32 m0, s75, 0
    s_add_u32 s39, s67, 0
    buffer_load_dwordx4 v18, s[20:23], s39 offen lds
    s_add_u32 m0, s75, 8192
    s_add_u32 s39, s67, 128
    buffer_load_dwordx4 v18, s[20:23], s39 offen lds
    s_add_u32 m0, s75, 16384
    s_add_u32 s39, s67, 256
    buffer_load_dwordx4 v18, s[20:23], s39 offen lds
    s_add_u32 m0, s75, 24576
    s_add_u32 s39, s67, 384
    buffer_load_dwordx4 v18, s[20:23], s39 offen lds
    s_add_u32 m0, s75, 32768
    s_add_u32 s39, s67, 512
    buffer_load_dwordx4 v18, s[20:23], s39 offen lds
    s_add_u32 m0, s75, 40960
    s_add_u32 s39, s67, 640
    buffer_load_dwordx4 v18, s[20:23], s39 offen lds
    s_waitcnt vmcnt(6)
    v_mov_b32 v6, s97
    v_mov_b32 v7, 1
    s_mov_b64 exec, 1
    buffer_store_dword v7, v6, s[24:27], 0 offen sc1
    s_mov_b64 exec, -1
    s_add_u32 m0, s75, 49152
    s_add_u32 s39, s67, 768
    buffer_load_dwordx4 v18, s[20:23], s39 offen lds
    s_add_u32 m0, s75, 57344
    s_add_u32 s39, s67, 896
    buffer_load_dwordx4 v18, s[20:23], s39 offen lds
    s_add_u32 m0, s75, 65536
    s_add_u32 s39, s67, 1024
    buffer_load_dwordx4 v18, s[20:23], s39 offen lds
    s_add_u32 m0, s75, 73728
    s_add_u32 s39, s67, 1152
    buffer_load_dwordx4 v18, s[20:23], s39 offen lds
    s_add_u32 m0, s75, 81920
    s_add_u32 s39, s67, 1280
    buffer_load_dwordx4 v18, s[20:23], s39 offen lds
    s_add_u32 m0, s75, 90112
    s_add_u32 s39, s67, 1408
    buffer_load_dwordx4 v18, s[20:23], s39 offen lds
    s_mul_i32 s66, s36, 29184
    v_add_u32 v8, s66, v5
    v_mov_b32 v88, 0
    v_mov_b32 v89, 0
    v_mov_b32 v90, 0
    v_mov_b32 v91, 0
    v_lshlrev_b32 v32, 16, v216
    v_and_b32 v33, 0xffff0000, v216
    v_lshlrev_b32 v34, 16, v217
    v_and_b32 v35, 0xffff0000, v217
    v_lshlrev_b32 v36, 16, v218
    v_and_b32 v37, 0xffff0000, v218
    v_lshlrev_b32 v38, 16, v219
    v_and_b32 v39, 0xffff0000, v219
    v_lshlrev_b32 v40, 16, v220
    v_and_b32 v41, 0xffff0000, v220
    v_lshlrev_b32 v42, 16, v221
    v_and_b32 v43, 0xffff0000, v221
    v_lshlrev_b32 v44, 16, v222
    v_and_b32 v45, 0xffff0000, v222
    v_lshlrev_b32 v46, 16, v223
    v_and_b32 v47, 0xffff0000, v223
    v_lshlrev_b32 v48, 16, v224
    v_and_b32 v49, 0xffff0000, v224
    v_lshlrev_b32 v50, 16, v225
    v_and_b32 v51, 0xffff0000, v225
    v_lshlrev_b32 v52, 16, v226
    v_and_b32 v53, 0xffff0000, v226
    v_lshlrev_b32 v54, 16, v227
    v_and_b32 v55, 0xffff0000, v227
    v_lshlrev_b32 v56, 16, v228
    v_and_b32 v57, 0xffff0000, v228
    v_lshlrev_b32 v58, 16, v229
    v_and_b32 v59, 0xffff0000, v229
    v_lshlrev_b32 v60, 16, v230
    v_and_b32 v61, 0xffff0000, v230
    v_lshlrev_b32 v62, 16, v231
    v_and_b32 v63, 0xffff0000, v231
    v_lshlrev_b32 v64, 16, v232
    v_and_b32 v65, 0xffff0000, v232
    v_lshlrev_b32 v66, 16, v233
    v_and_b32 v67, 0xffff0000, v233
    v_lshlrev_b32 v68, 16, v234
    v_and_b32 v69, 0xffff0000, v234
    v_lshlrev_b32 v70, 16, v235
    v_and_b32 v71, 0xffff0000, v235
    v_lshlrev_b32 v72, 16, v236
    v_and_b32 v73, 0xffff0000, v236
    v_lshlrev_b32 v74, 16, v237
    v_and_b32 v75, 0xffff0000, v237
    v_lshlrev_b32 v76, 16, v238
    v_and_b32 v77, 0xffff0000, v238
    v_lshlrev_b32 v78, 16, v239
    v_and_b32 v79, 0xffff0000, v239
    v_lshlrev_b32 v80, 16, v240
    v_and_b32 v81, 0xffff0000, v240
    v_lshlrev_b32 v82, 16, v241
    v_and_b32 v83, 0xffff0000, v241
    v_lshlrev_b32 v84, 16, v242
    v_and_b32 v85, 0xffff0000, v242
    v_lshlrev_b32 v86, 16, v243
    v_and_b32 v87, 0xffff0000, v243
    s_cmp_eq_u32 s65, 1
    s_cbranch_scc1 gf_kernel_b1
    s_cmp_eq_u32 s65, 2
    s_cbranch_scc1 gf_kernel_b2
    s_cmp_eq_u32 s65, 3
    s_cbranch_scc1 gf_kernel_b3
    ds_write_b128 v8, v[88:91] offset:4608
    v_cmp_gt_u32 vcc, 16, v1
    s_and_saveexec_b64 s[40:41], vcc
    ds_write_b128 v8, v[88:91] offset:5632
    s_mov_b64 exec, s[40:41]
    v_cmp_gt_u32 vcc, 32, v1
    s_and_saveexec_b64 s[40:41], vcc
    ds_write_b128 v8, v[88:91] offset:0
    s_mov_b64 exec, s[40:41]
    v_cvt_pk_f16_f32 v100, v32, v33
    v_cvt_pk_f16_f32 v101, v34, v35
    v_cvt_pk_f16_f32 v102, v36, v37
    v_cvt_pk_f16_f32 v103, v38, v39
    v_cvt_pk_f16_f32 v104, v40, v41
    v_cvt_pk_f16_f32 v105, v42, v43
    v_cvt_pk_f16_f32 v106, v44, v45
    v_cvt_pk_f16_f32 v107, v46, v47
    v_cvt_pk_f16_f32 v108, v48, v49
    v_cvt_pk_f16_f32 v109, v50, v51
    v_cvt_pk_f16_f32 v110, v52, v53
    v_cvt_pk_f16_f32 v111, v54, v55
    v_cvt_pk_f16_f32 v112, v56, v57
    v_cvt_pk_f16_f32 v113, v58, v59
    v_cvt_pk_f16_f32 v114, v60, v61
    v_cvt_pk_f16_f32 v115, v62, v63
    v_lshl_add_u32 v10, v1, 6, s66
    ds_write_b128 v10, v[100:103] offset:512
    ds_write_b128 v10, v[104:107] offset:528
    ds_write_b128 v10, v[108:111] offset:544
    ds_write_b128 v10, v[112:115] offset:560
    v_writelane_b32 v9, s44, 63
    v_sub_f32 v23, v23, v9
    v_cvt_pk_f16_f32 v20, v20, v21
    v_cvt_pk_f16_f32 v22, v22, v23
    v_lshrrev_b32 v10, 1, v4
    v_lshlrev_b32 v10, 7, v10
    v_lshl_add_u32 v10, v3, 3, v10
    v_and_b32 v11, 1, v4
    v_lshl_add_u32 v10, v11, 2, v10
    v_sub_u32 v10, 285, v10
    v_lshl_add_u32 v10, v10, 1, s66
    ds_write_b16 v10, v20 offset:4614
    ds_write_b16_d16_hi v10, v20 offset:4612
    ds_write_b16 v10, v22 offset:4610
    ds_write_b16_d16_hi v10, v22 offset:4608
    ds_write_b16 v10, v20 offset:5256
    ds_write_b16_d16_hi v10, v20 offset:5254
    ds_write_b16 v10, v22 offset:5252
    ds_write_b16_d16_hi v10, v22 offset:5250
    s_branch gf_kernel_bd
gf_kernel_b1:
    v_cmp_gt_u32 vcc, 24, v1
    s_and_saveexec_b64 s[40:41], vcc
    ds_write_b128 v8, v[88:91] offset:5888
    s_mov_b64 exec, s[40:41]
    v_add_f32 v37, v36, v37
    v_add_f32 v38, v37, v38
    v_add_f32 v39, v38, v39
    v_add_f32 v40, v39, v40
    v_add_f32 v41, v40, v41
    v_add_f32 v42, v41, v42
    v_add_f32 v43, v42, v43
    v_add_f32 v44, v43, v44
    v_add_f32 v45, v44, v45
    v_add_f32 v46, v45, v46
    v_add_f32 v47, v46, v47
    v_add_f32 v48, v47, v48
    v_add_f32 v49, v48, v49
    v_add_f32 v50, v49, v50
    v_add_f32 v51, v50, v51
    v_add_f32 v52, v51, v52
    v_add_f32 v53, v52, v53
    v_add_f32 v54, v53, v54
    v_add_f32 v55, v54, v55
    v_add_f32 v56, v55, v56
    v_add_f32 v57, v56, v57
    v_add_f32 v58, v57, v58
    v_add_f32 v59, v58, v59
    v_add_f32 v60, v59, v60
    v_add_f32 v61, v60, v61
    v_add_f32 v62, v61, v62
    v_add_f32 v63, v62, v63
    v_add_f32 v64, v63, v64
    v_add_f32 v65, v64, v65
    v_add_f32 v66, v65, v66
    v_add_f32 v67, v66, v67
    v_add_f32 v68, v67, v68
    v_add_f32 v69, v68, v69
    v_add_f32 v70, v69, v70
    v_add_f32 v71, v70, v71
    v_add_f32 v72, v71, v72
    v_add_f32 v73, v72, v73
    v_add_f32 v74, v73, v74
    v_add_f32 v75, v74, v75
    v_add_f32 v76, v75, v76
    v_add_f32 v77, v76, v77
    v_add_f32 v78, v77, v78
    v_add_f32 v79, v78, v79
    v_add_f32 v80, v79, v80
    v_add_f32 v81, v80, v81
    v_add_f32 v82, v81, v82
    v_add_f32 v83, v82, v83
    v_lshl_add_u32 v10, v1, 3, s66
    v_sub_f32 v102, v43, v36
    v_sub_f32 v103, v52, v43
    v_sub_f32 v104, v59, v52
    v_sub_f32 v105, v68, v59
    v_cvt_pk_f16_f32 v100, v102, v103
    v_cvt_pk_f16_f32 v101, v104, v105
    ds_write_b64 v10, v[100:101] offset:8192
    v_sub_f32 v108, v44, v37
    v_sub_f32 v109, v53, v44
    v_sub_f32 v110, v60, v53
    v_sub_f32 v111, v69, v60
    v_cvt_pk_f16_f32 v106, v108, v109
    v_cvt_pk_f16_f32 v107, v110, v111
    ds_write_b64 v10, v[106:107] offset:8528
    v_sub_f32 v102, v45, v38
    v_sub_f32 v103, v54, v45
    v_sub_f32 v104, v61, v54
    v_sub_f32 v105, v70, v61
    v_cvt_pk_f16_f32 v100, v102, v103
    v_cvt_pk_f16_f32 v101, v104, v105
    ds_write_b64 v10, v[100:101] offset:8864
    v_sub_f32 v108, v46, v39
    v_sub_f32 v109, v55, v46
    v_sub_f32 v110, v62, v55
    v_sub_f32 v111, v71, v62
    v_cvt_pk_f16_f32 v106, v108, v109
    v_cvt_pk_f16_f32 v107, v110, v111
    ds_write_b64 v10, v[106:107] offset:9200
    v_sub_f32 v102, v47, v40
    v_sub_f32 v103, v56, v47
    v_sub_f32 v104, v63, v56
    v_sub_f32 v105, v72, v63
    v_cvt_pk_f16_f32 v100, v102, v103
    v_cvt_pk_f16_f32 v101, v104, v105
    ds_write_b64 v10, v[100:101] offset:9536
    v_sub_f32 v108, v48, v41
    v_sub_f32 v109, v57, v48
    v_sub_f32 v110, v64, v57
    v_sub_f32 v111, v73, v64
    v_cvt_pk_f16_f32 v106, v108, v109
    v_cvt_pk_f16_f32 v107, v110, v111
    ds_write_b64 v10, v[106:107] offset:9872
    v_sub_f32 v102, v49, v42
    v_sub_f32 v103, v58, v49
    v_sub_f32 v104, v65, v58
    v_sub_f32 v105, v74, v65
    v_cvt_pk_f16_f32 v100, v102, v103
    v_cvt_pk_f16_f32 v101, v104, v105
    ds_write_b64 v10, v[100:101] offset:10208
    v_sub_f32 v108, v50, v43
    v_sub_f32 v109, v59, v50
    v_sub_f32 v110, v66, v59
    v_sub_f32 v111, v75, v66
    v_cvt_pk_f16_f32 v106, v108, v109
    v_cvt_pk_f16_f32 v107, v110, v111
    ds_write_b64 v10, v[106:107] offset:10544
    v_sub_f32 v102, v51, v44
    v_sub_f32 v103, v60, v51
    v_sub_f32 v104, v67, v60
    v_sub_f32 v105, v76, v67
    v_cvt_pk_f16_f32 v100, v102, v103
    v_cvt_pk_f16_f32 v101, v104, v105
    ds_write_b64 v10, v[100:101] offset:10880
    v_sub_f32 v108, v52, v45
    v_sub_f32 v109, v61, v52
    v_sub_f32 v110, v68, v61
    v_sub_f32 v111, v77, v68
    v_cvt_pk_f16_f32 v106, v108, v109
    v_cvt_pk_f16_f32 v107, v110, v111
    ds_write_b64 v10, v[106:107] offset:11216
    v_sub_f32 v102, v53, v46
    v_sub_f32 v103, v62, v53
    v_sub_f32 v104, v69, v62
    v_sub_f32 v105, v78, v69
    v_cvt_pk_f16_f32 v100, v102, v103
    v_cvt_pk_f16_f32 v101, v104, v105
    ds_write_b64 v10, v[100:101] offset:11552
    v_sub_f32 v108, v54, v47
    v_sub_f32 v109, v63, v54
    v_sub_f32 v110, v70, v63
    v_sub_f32 v111, v79, v70
    v_cvt_pk_f16_f32 v106, v108, v109
    v_cvt_pk_f16_f32 v107, v110, v111
    ds_write_b64 v10, v[106:107] offset:11888
    v_sub_f32 v102, v55, v48
    v_sub_f32 v103, v64, v55
    v_sub_f32 v104, v71, v64
    v_sub_f32 v105, v80, v71
    v_cvt_pk_f16_f32 v100, v102, v103
    v_cvt_pk_f16_f32 v101, v104, v105
    ds_write_b64 v10, v[100:101] offset:12224
    v_sub_f32 v108, v56, v49
    v_sub_f32 v109, v65, v56
    v_sub_f32 v110, v72, v65
    v_sub_f32 v111, v81, v72
    v_cvt_pk_f16_f32 v106, v108, v109
    v_cvt_pk_f16_f32 v107, v110, v111
    ds_write_b64 v10, v[106:107] offset:12560
    v_sub_f32 v102, v57, v50
    v_sub_f32 v103, v66, v57
    v_sub_f32 v104, v73, v66
    v_sub_f32 v105, v82, v73
    v_cvt_pk_f16_f32 v100, v102, v103
    v_cvt_pk_f16_f32 v101, v104, v105
    ds_write_b64 v10, v[100:101] offset:12896
    v_cmp_gt_u32 vcc, 40, v1
    s_and_saveexec_b64 s[40:41], vcc
    v_sub_f32 v108, v58, v51
    v_sub_f32 v109, v67, v58
    v_sub_f32 v110, v74, v67
    v_sub_f32 v111, v83, v74
    v_cvt_pk_f16_f32 v106, v108, v109
    v_cvt_pk_f16_f32 v107, v110, v111
    ds_write_b64 v10, v[106:107] offset:13232
    s_mov_b64 exec, s[40:41]
    v_cvt_pk_f16_f32 v28, v28, v29
    v_cvt_pk_f16_f32 v30, v30, v31
    v_lshl_add_u32 v10, v4, 6, v3
    v_sub_u32 v10, 239, v10
    v_lshl_add_u32 v10, v10, 1, s66
    v_cmp_gt_u32 vcc, 33, v1
    s_and_saveexec_b64 s[40:41], vcc
    ds_write_b16 v10, v28 offset:5728
    s_mov_b32 exec_hi, 0
    ds_write_b16_d16_hi v10, v28 offset:5696
    ds_write_b16 v10, v30 offset:5664
    ds_write_b16_d16_hi v10, v30 offset:5632
    s_mov_b64 exec, s[40:41]
    s_branch gf_kernel_bd
gf_kernel_b2:
    v_cmp_gt_u32 vcc, 24, v1
    s_and_saveexec_b64 s[40:41], vcc
    ds_write_b128 v8, v[88:91] offset:6272
    s_mov_b64 exec, s[40:41]
    v_lshl_add_u32 v10, v1, 5, s66
    v_add_f32 v116, v47, v48
    v_add_f32 v117, v51, v52
    v_add_f32 v118, v55, v56
    v_add_f32 v119, v59, v60
    v_add_f32 v120, v63, v64
    v_add_f32 v121, v67, v68
    v_add_f32 v122, v71, v72
    v_add_f32 v123, v75, v76
    v_add_f32 v116, v116, v49
    v_add_f32 v117, v117, v53
    v_add_f32 v118, v118, v57
    v_add_f32 v119, v119, v61
    v_add_f32 v120, v120, v65
    v_add_f32 v121, v121, v69
    v_add_f32 v122, v122, v73
    v_add_f32 v123, v123, v77
    v_cvt_pk_f16_f32 v100, v46, v116
    v_cvt_pk_f16_f32 v101, v50, v117
    v_cvt_pk_f16_f32 v102, v54, v118
    v_cvt_pk_f16_f32 v103, v58, v119
    v_cvt_pk_f16_f32 v104, v62, v120
    v_cvt_pk_f16_f32 v105, v66, v121
    v_cvt_pk_f16_f32 v106, v70, v122
    v_cvt_pk_f16_f32 v107, v74, v123
    ds_write_b128 v10, v[100:103] offset:13568
    ds_write_b128 v10, v[104:107] offset:13584
    v_add_f32 v116, v48, v49
    v_add_f32 v117, v52, v53
    v_add_f32 v118, v56, v57
    v_add_f32 v119, v60, v61
    v_add_f32 v120, v64, v65
    v_add_f32 v121, v68, v69
    v_add_f32 v122, v72, v73
    v_add_f32 v123, v76, v77
    v_add_f32 v116, v116, v50
    v_add_f32 v117, v117, v54
    v_add_f32 v118, v118, v58
    v_add_f32 v119, v119, v62
    v_add_f32 v120, v120, v66
    v_add_f32 v121, v121, v70
    v_add_f32 v122, v122, v74
    v_add_f32 v123, v123, v78
    v_cvt_pk_f16_f32 v108, v47, v116
    v_cvt_pk_f16_f32 v109, v51, v117
    v_cvt_pk_f16_f32 v110, v55, v118
    v_cvt_pk_f16_f32 v111, v59, v119
    v_cvt_pk_f16_f32 v112, v63, v120
    v_cvt_pk_f16_f32 v113, v67, v121
    v_cvt_pk_f16_f32 v114, v71, v122
    v_cvt_pk_f16_f32 v115, v75, v123
    ds_write_b128 v10, v[108:111] offset:15632
    ds_write_b128 v10, v[112:115] offset:15648
    v_add_f32 v116, v49, v50
    v_add_f32 v117, v53, v54
    v_add_f32 v118, v57, v58
    v_add_f32 v119, v61, v62
    v_add_f32 v120, v65, v66
    v_add_f32 v121, v69, v70
    v_add_f32 v122, v73, v74
    v_add_f32 v123, v77, v78
    v_add_f32 v116, v116, v51
    v_add_f32 v117, v117, v55
    v_add_f32 v118, v118, v59
    v_add_f32 v119, v119, v63
    v_add_f32 v120, v120, v67
    v_add_f32 v121, v121, v71
    v_add_f32 v122, v122, v75
    v_add_f32 v123, v123, v79
    v_cvt_pk_f16_f32 v100, v48, v116
    v_cvt_pk_f16_f32 v101, v52, v117
    v_cvt_pk_f16_f32 v102, v56, v118
    v_cvt_pk_f16_f32 v103, v60, v119
    v_cvt_pk_f16_f32 v104, v64, v120
    v_cvt_pk_f16_f32 v105, v68, v121
    v_cvt_pk_f16_f32 v106, v72, v122
    v_cvt_pk_f16_f32 v107, v76, v123
    ds_write_b128 v10, v[100:103] offset:17696
    ds_write_b128 v10, v[104:107] offset:17712
    v_add_f32 v116, v50, v51
    v_add_f32 v117, v54, v55
    v_add_f32 v118, v58, v59
    v_add_f32 v119, v62, v63
    v_add_f32 v120, v66, v67
    v_add_f32 v121, v70, v71
    v_add_f32 v122, v74, v75
    v_add_f32 v123, v78, v79
    v_add_f32 v116, v116, v52
    v_add_f32 v117, v117, v56
    v_add_f32 v118, v118, v60
    v_add_f32 v119, v119, v64
    v_add_f32 v120, v120, v68
    v_add_f32 v121, v121, v72
    v_add_f32 v122, v122, v76
    v_add_f32 v123, v123, v80
    v_cvt_pk_f16_f32 v108, v49, v116
    v_cvt_pk_f16_f32 v109, v53, v117
    v_cvt_pk_f16_f32 v110, v57, v118
    v_cvt_pk_f16_f32 v111, v61, v119
    v_cvt_pk_f16_f32 v112, v65, v120
    v_cvt_pk_f16_f32 v113, v69, v121
    v_cvt_pk_f16_f32 v114, v73, v122
    v_cvt_pk_f16_f32 v115, v77, v123
    ds_write_b128 v10, v[108:111] offset:19760
    ds_write_b128 v10, v[112:115] offset:19776
    v_writelane_b32 v9, s45, 31
    v_sub_f32 v27, v27, v9
    v_cvt_pk_f16_f32 v24, v24, v25
    v_cvt_pk_f16_f32 v26, v26, v27
    v_and_b32 v11, 1, v4
    v_lshlrev_b32 v11, 6, v11
    v_lshl_add_u32 v10, v3, 2, v11
    v_sub_u32 v10, 156, v10
    v_lshl_add_u32 v10, v10, 1, s66
    s_mov_b32 exec_hi, 0
    ds_write_b16 v10, v24 offset:6278
    ds_write_b16_d16_hi v10, v24 offset:6276
    ds_write_b16 v10, v26 offset:6274
    ds_write_b16_d16_hi v10, v26 offset:6272
    s_mov_b32 exec_hi, -1
    s_branch gf_kernel_bd
gf_kernel_b3:
    v_cmp_gt_u32 vcc, 24, v1
    s_and_saveexec_b64 s[40:41], vcc
    ds_write_b128 v8, v[88:91] offset:6656
    s_mov_b64 exec, s[40:41]
    v_add_f32 v37, v36, v37
    v_add_f32 v38, v37, v38
    v_add_f32 v39, v38, v39
    v_add_f32 v40, v39, v40
    v_add_f32 v41, v40, v41
    v_add_f32 v42, v41, v42
    v_add_f32 v43, v42, v43
    v_add_f32 v44, v43, v44
    v_add_f32 v45, v44, v45
    v_add_f32 v46, v45, v46
    v_add_f32 v47, v46, v47
    v_add_f32 v48, v47, v48
    v_add_f32 v49, v48, v49
    v_add_f32 v50, v49, v50
    v_add_f32 v51, v50, v51
    v_add_f32 v52, v51, v52
    v_add_f32 v53, v52, v53
    v_add_f32 v54, v53, v54
    v_add_f32 v55, v54, v55
    v_add_f32 v56, v55, v56
    v_add_f32 v57, v56, v57
    v_add_f32 v58, v57, v58
    v_add_f32 v59, v58, v59
    v_add_f32 v60, v59, v60
    v_add_f32 v61, v60, v61
    v_add_f32 v62, v61, v62
    v_add_f32 v63, v62, v63
    v_add_f32 v64, v63, v64
    v_add_f32 v65, v64, v65
    v_add_f32 v66, v65, v66
    v_add_f32 v67, v66, v67
    v_add_f32 v68, v67, v68
    v_add_f32 v69, v68, v69
    v_add_f32 v70, v69, v70
    v_add_f32 v71, v70, v71
    v_add_f32 v72, v71, v72
    v_add_f32 v73, v72, v73
    v_add_f32 v74, v73, v74
    v_add_f32 v75, v74, v75
    v_add_f32 v76, v75, v76
    v_add_f32 v77, v76, v77
    v_add_f32 v78, v77, v78
    v_add_f32 v79, v78, v79
    v_add_f32 v80, v79, v80
    v_add_f32 v81, v80, v81
    v_add_f32 v82, v81, v82
    v_add_f32 v83, v82, v83
    v_sub_f32 v104, v45, v42
    v_sub_f32 v108, v50, v45
    v_sub_f32 v105, v53, v50
    v_sub_f32 v109, v58, v53
    v_sub_f32 v106, v61, v58
    v_sub_f32 v110, v66, v61
    v_sub_f32 v107, v69, v66
    v_sub_f32 v111, v74, v69
    v_cvt_pk_f16_f32 v100, v104, v108
    v_cvt_pk_f16_f32 v101, v105, v109
    v_cvt_pk_f16_f32 v102, v106, v110
    v_cvt_pk_f16_f32 v103, v107, v111
    ds_write_b128 v8, v[100:103] offset:21824
    v_sub_f32 v116, v46, v43
    v_sub_f32 v120, v51, v46
    v_sub_f32 v117, v54, v51
    v_sub_f32 v121, v59, v54
    v_sub_f32 v118, v62, v59
    v_sub_f32 v122, v67, v62
    v_sub_f32 v119, v70, v67
    v_sub_f32 v123, v75, v70
    v_cvt_pk_f16_f32 v112, v116, v120
    v_cvt_pk_f16_f32 v113, v117, v121
    v_cvt_pk_f16_f32 v114, v118, v122
    v_cvt_pk_f16_f32 v115, v119, v123
    ds_write_b128 v8, v[112:115] offset:22736
    v_sub_f32 v104, v47, v44
    v_sub_f32 v108, v52, v47
    v_sub_f32 v105, v55, v52
    v_sub_f32 v109, v60, v55
    v_sub_f32 v106, v63, v60
    v_sub_f32 v110, v68, v63
    v_sub_f32 v107, v71, v68
    v_sub_f32 v111, v76, v71
    v_cvt_pk_f16_f32 v100, v104, v108
    v_cvt_pk_f16_f32 v101, v105, v109
    v_cvt_pk_f16_f32 v102, v106, v110
    v_cvt_pk_f16_f32 v103, v107, v111
    ds_write_b128 v8, v[100:103] offset:23648
    v_sub_f32 v116, v48, v45
    v_sub_f32 v120, v53, v48
    v_sub_f32 v117, v56, v53
    v_sub_f32 v121, v61, v56
    v_sub_f32 v118, v64, v61
    v_sub_f32 v122, v69, v64
    v_sub_f32 v119, v72, v69
    v_sub_f32 v123, v77, v72
    v_cvt_pk_f16_f32 v112, v116, v120
    v_cvt_pk_f16_f32 v113, v117, v121
    v_cvt_pk_f16_f32 v114, v118, v122
    v_cvt_pk_f16_f32 v115, v119, v123
    ds_write_b128 v8, v[112:115] offset:24560
    v_sub_f32 v104, v49, v46
    v_sub_f32 v108, v54, v49
    v_sub_f32 v105, v57, v54
    v_sub_f32 v109, v62, v57
    v_sub_f32 v106, v65, v62
    v_sub_f32 v110, v70, v65
    v_sub_f32 v107, v73, v70
    v_sub_f32 v111, v78, v73
    v_cvt_pk_f16_f32 v100, v104, v108
    v_cvt_pk_f16_f32 v101, v105, v109
    v_cvt_pk_f16_f32 v102, v106, v110
    v_cvt_pk_f16_f32 v103, v107, v111
    ds_write_b128 v8, v[100:103] offset:25472
    v_sub_f32 v116, v50, v47
    v_sub_f32 v120, v55, v50
    v_sub_f32 v117, v58, v55
    v_sub_f32 v121, v63, v58
    v_sub_f32 v118, v66, v63
    v_sub_f32 v122, v71, v66
    v_sub_f32 v119, v74, v71
    v_sub_f32 v123, v79, v74
    v_cvt_pk_f16_f32 v112, v116, v120
    v_cvt_pk_f16_f32 v113, v117, v121
    v_cvt_pk_f16_f32 v114, v118, v122
    v_cvt_pk_f16_f32 v115, v119, v123
    ds_write_b128 v8, v[112:115] offset:26384
    v_sub_f32 v104, v51, v48
    v_sub_f32 v108, v56, v51
    v_sub_f32 v105, v59, v56
    v_sub_f32 v109, v64, v59
    v_sub_f32 v106, v67, v64
    v_sub_f32 v110, v72, v67
    v_sub_f32 v107, v75, v72
    v_sub_f32 v111, v80, v75
    v_cvt_pk_f16_f32 v100, v104, v108
    v_cvt_pk_f16_f32 v101, v105, v109
    v_cvt_pk_f16_f32 v102, v106, v110
    v_cvt_pk_f16_f32 v103, v107, v111
    ds_write_b128 v8, v[100:103] offset:27296
    v_cmp_gt_u32 vcc, 56, v1
    s_and_saveexec_b64 s[40:41], vcc
    v_sub_f32 v116, v52, v49
    v_sub_f32 v120, v57, v52
    v_sub_f32 v117, v60, v57
    v_sub_f32 v121, v65, v60
    v_sub_f32 v118, v68, v65
    v_sub_f32 v122, v73, v68
    v_sub_f32 v119, v76, v73
    v_sub_f32 v123, v81, v76
    v_cvt_pk_f16_f32 v112, v116, v120
    v_cvt_pk_f16_f32 v113, v117, v121
    v_cvt_pk_f16_f32 v114, v118, v122
    v_cvt_pk_f16_f32 v115, v119, v123
    ds_write_b128 v8, v[112:115] offset:28208
    s_mov_b64 exec, s[40:41]
    v_writelane_b32 v9, s46, 63
    v_sub_f32 v27, v27, v9
    v_cvt_pk_f16_f32 v24, v24, v25
    v_cvt_pk_f16_f32 v26, v26, v27
    v_and_b32 v11, 1, v4
    v_lshlrev_b32 v11, 6, v11
    v_lshl_add_u32 v11, v3, 1, v11
    v_sub_u32 v11, 126, v11
    v_lshl_add_u32 v11, v11, 1, s66
    s_mov_b32 exec_lo, 0
    ds_write_b16 v11, v24 offset:6722
    ds_write_b16_d16_hi v11, v24 offset:6720
    ds_write_b16 v11, v26 offset:6658
    ds_write_b16_d16_hi v11, v26 offset:6656
    s_mov_b32 exec_lo, -1
gf_kernel_bd:
    s_lshl_b32 s38, s30, 2
    s_sub_u32 s38, s97, s38
    v_and_b32 v6, 31, v1
    v_lshlrev_b32 v6, 2, v6
    buffer_load_dword v0, v6, s[24:27], s38 offen sc1
    s_waitcnt lgkmcnt(0)
    s_barrier
    v_lshlrev_b32 v11, 2, v4
    v_sub_u32 v11, v11, v3
    v_lshlrev_b32 v11, 2, v11
    v_add_u32 v11, 5948, v11
    v_add_u32 v11, s66, v11
    v_lshlrev_b32 v12, 6, v3
    v_lshl_add_u32 v12, v4, 4, v12
    v_add_u32 v12, s66, v12
    v_mul_u32_u24 v13, 336, v3
    v_lshl_add_u32 v13, v4, 4, v13
    v_add_u32 v13, s66, v13
    v_lshrrev_b32 v6, 1, v3
    v_xor_b32 v6, v6, v4
    s_lshl_b32 s38, s36, 2
    v_xor_b32 v6, s38, v6
    v_lshlrev_b32 v7, 7, v3
    v_lshl_add_u32 v19, v6, 4, v7
    v_add_u32 v19, 58368, v19
    s_lshl_b32 s34, s35, 17
    s_lshl_b32 s39, s36, 11
    s_add_u32 s34, s34, s39
    s_add_u32 s34, s34, 6291456
    s_lshl_b32 s33, s64, 12
    s_add_u32 s33, s33, 15728640
    s_add_u32 s68, s10, s33
    s_addc_u32 s69, s11, 0
    s_lshl_b32 s38, s30, 7
    s_lshl_b32 s39, s36, 6
    s_add_u32 s38, s38, s39
    v_lshlrev_b32 v6, 1, v3
    v_add_u32 v6, s38, v6
    global_load_ushort v16, v6, s[60:61] offset:0
    global_load_ushort v17, v6, s[60:61] offset:32
    s_lshl_b32 s33, s65, 11
    v_add_u32 v9, s33, v12
    v_add_u32 v135, 65536, v19
    s_mul_i32 s47, s31, 112
    s_lshl_b32 s39, s3, 2
    s_add_u32 s47, s47, s39
    s_lshl_b32 s47, s47, 10
    s_add_u32 s47, s47, 14680064
    s_lshl_b32 s38, s30, 2
    s_sub_u32 s38, s97, s38
    v_and_b32 v6, 31, v1
    v_lshlrev_b32 v6, 2, v6
    buffer_load_dword v134, v6, s[24:27], s38 offen sc1
    s_cmp_eq_u32 s65, 1
    s_cbranch_scc1 gf_kernel_c1
    s_cmp_eq_u32 s65, 2
    s_cbranch_scc1 gf_kernel_c2
    s_cmp_eq_u32 s65, 3
    s_cbranch_scc1 gf_kernel_c3
    v_and_b32 v10, 1, v3
    v_mul_u32_u24 v10, 642, v10
    v_lshlrev_b32 v14, 3, v4
    v_sub_u32 v14, v14, v3
    v_lshl_add_u32 v10, v14, 1, v10
    v_add_u32 v10, 4640, v10
    v_add_u32 v10, s66, v10
    ds_read2_b32 v[160:161], v10 offset0:128 offset1:129
    ds_read2_b32 v[162:163], v10 offset0:130 offset1:131
    ds_read2_b32 v[164:165], v10 offset0:112 offset1:113
    ds_read2_b32 v[166:167], v10 offset0:114 offset1:115
    ds_read2_b32 v[168:169], v10 offset0:96 offset1:97
    ds_read2_b32 v[170:171], v10 offset0:98 offset1:99
    ds_read2_b32 v[172:173], v10 offset0:80 offset1:81
    ds_read2_b32 v[174:175], v10 offset0:82 offset1:83
    ds_read2_b32 v[176:177], v10 offset0:64 offset1:65
    ds_read2_b32 v[178:179], v10 offset0:66 offset1:67
    ds_read2_b32 v[180:181], v10 offset0:48 offset1:49
    ds_read2_b32 v[182:183], v10 offset0:50 offset1:51
    ds_read2_b32 v[184:185], v10 offset0:32 offset1:33
    ds_read2_b32 v[186:187], v10 offset0:34 offset1:35
    ds_read2_b32 v[188:189], v10 offset0:16 offset1:17
    ds_read2_b32 v[190:191], v10 offset0:18 offset1:19
    ds_read2_b32 v[192:193], v10 offset0:0 offset1:1
    ds_read2_b32 v[194:195], v10 offset0:2 offset1:3
    ds_read2_b32 v[200:201], v11 offset0:64 offset1:65
    ds_read2_b32 v[202:203], v11 offset0:66 offset1:67
    v_mov_b32 v10, s46
    v_cvt_pk_f16_f32 v10, v10, v10
    v_sub_u32 v14, 5, v14
    v_and_b32 v15, 0xffff, v10
    v_and_b32 v20, 0xffff0000, v10
    v_cmp_eq_u32 s[80:81], 0, v14
    v_cmp_eq_u32 s[82:83], 1, v14
    v_cmp_eq_u32 s[84:85], 2, v14
    v_cmp_eq_u32 s[86:87], 3, v14
    v_cmp_eq_u32 s[88:89], 4, v14
    v_cmp_eq_u32 s[90:91], 5, v14
    v_cmp_eq_u32 s[92:93], 6, v14
    v_cmp_eq_u32 s[94:95], 7, v14
    v_cndmask_b32 v196, 0, v15, s[80:81]
    v_cndmask_b32 v197, 0, v15, s[84:85]
    v_cndmask_b32 v198, 0, v15, s[88:89]
    v_cndmask_b32 v199, 0, v15, s[92:93]
    v_cndmask_b32 v196, v196, v20, s[82:83]
    v_cndmask_b32 v197, v197, v20, s[86:87]
    v_cndmask_b32 v198, v198, v20, s[90:91]
    v_cndmask_b32 v199, v199, v20, s[94:95]
    v_lshlrev_b32 v10, 5, v3
    v_lshl_add_u32 v10, v4, 4, v10
    v_add_u32 v10, s66, v10
    s_waitcnt vmcnt(3)
    v_cmp_eq_u32 vcc, 0, v0
    s_and_b32 s38, vcc_lo, 0xffff
    s_cbranch_scc1 pb_5
    s_add_u32 s38, s34, 0
    buffer_load_dwordx4 v[84:87], v5, s[24:27], s38 offen offset:0 sc0
    s_add_u32 s38, s34, 0
    buffer_load_dwordx4 v[88:91], v5, s[24:27], s38 offen offset:1024 sc0
    s_add_u32 s38, s34, 4096
    buffer_load_dwordx4 v[92:95], v5, s[24:27], s38 offen offset:0 sc0
    s_add_u32 s38, s34, 4096
    buffer_load_dwordx4 v[96:99], v5, s[24:27], s38 offen offset:1024 sc0
    s_waitcnt lgkmcnt(0)
    ds_read_b128 v[20:23], v10 offset:480
    ds_read_b128 v[24:27], v10 offset:416
    ds_read_b128 v[28:31], v10 offset:352
    ds_read_b128 v[32:35], v10 offset:288
    ds_read_b128 v[36:39], v10 offset:224
    ds_read_b128 v[40:43], v10 offset:160
    ds_read_b128 v[44:47], v10 offset:96
    ds_read_b128 v[48:51], v10 offset:32
    ds_read_b128 v[52:55], v10 offset:992
    ds_read_b128 v[56:59], v10 offset:928
    s_add_u32 s38, s34, 8192
    buffer_load_dwordx4 v[100:103], v5, s[24:27], s38 offen offset:0 sc0
    s_add_u32 s38, s34, 8192
    buffer_load_dwordx4 v[104:107], v5, s[24:27], s38 offen offset:1024 sc0
    s_waitcnt lgkmcnt(9)
    v_mfma_f32_16x16x32_f16 v[220:223], v[160:163], v[20:23], 0
    s_add_u32 s38, s34, 12288
    buffer_load_dwordx4 v[108:111], v5, s[24:27], s38 offen offset:0 sc0
    s_waitcnt lgkmcnt(8)
    v_mfma_f32_16x16x32_f16 v[220:223], v[164:167], v[24:27], v[220:223]
    s_add_u32 s38, s34, 12288
    buffer_load_dwordx4 v[112:115], v5, s[24:27], s38 offen offset:1024 sc0
    s_waitcnt lgkmcnt(7)
    v_mfma_f32_16x16x32_f16 v[220:223], v[168:171], v[28:31], v[220:223]
    s_add_u32 s38, s34, 16384
    buffer_load_dwordx4 v[116:119], v5, s[24:27], s38 offen offset:0 sc0
    s_waitcnt lgkmcnt(6)
    v_mfma_f32_16x16x32_f16 v[220:223], v[172:175], v[32:35], v[220:223]
    s_add_u32 s38, s34, 16384
    buffer_load_dwordx4 v[120:123], v5, s[24:27], s38 offen offset:1024 sc0
    s_waitcnt lgkmcnt(5)
    v_mfma_f32_16x16x32_f16 v[220:223], v[176:179], v[36:39], v[220:223]
    s_add_u32 s38, s34, 20480
    buffer_load_dwordx4 v[124:127], v5, s[24:27], s38 offen offset:0 sc0
    s_waitcnt lgkmcnt(4)
    v_mfma_f32_16x16x32_f16 v[220:223], v[180:183], v[40:43], v[220:223]
    s_add_u32 s38, s34, 20480
    buffer_load_dwordx4 v[128:131], v5, s[24:27], s38 offen offset:1024 sc0
    s_waitcnt lgkmcnt(3)
    v_mfma_f32_16x16x32_f16 v[220:223], v[184:187], v[44:47], v[220:223]
    s_add_u32 s38, s34, 24576
    buffer_load_dwordx4 v[144:147], v5, s[24:27], s38 offen offset:0 sc0
    s_waitcnt lgkmcnt(2)
    v_mfma_f32_16x16x32_f16 v[220:223], v[188:191], v[48:51], v[220:223]
    s_add_u32 s38, s34, 24576
    buffer_load_dwordx4 v[148:151], v5, s[24:27], s38 offen offset:1024 sc0
    s_waitcnt lgkmcnt(1)
    v_mfma_f32_16x16x32_f16 v[224:227], v[160:163], v[52:55], 0
    s_add_u32 s38, s34, 28672
    buffer_load_dwordx4 v[152:155], v5, s[24:27], s38 offen offset:0 sc0
    s_waitcnt lgkmcnt(0)
    v_mfma_f32_16x16x32_f16 v[224:227], v[164:167], v[56:59], v[224:227]
    s_add_u32 s38, s34, 28672
    buffer_load_dwordx4 v[156:159], v5, s[24:27], s38 offen offset:1024 sc0
    s_branch pj_6
pb_5:
    s_waitcnt lgkmcnt(0)
    ds_read_b128 v[20:23], v10 offset:480
    ds_read_b128 v[24:27], v10 offset:416
    ds_read_b128 v[28:31], v10 offset:352
    ds_read_b128 v[32:35], v10 offset:288
    ds_read_b128 v[36:39], v10 offset:224
    ds_read_b128 v[40:43], v10 offset:160
    ds_read_b128 v[44:47], v10 offset:96
    ds_read_b128 v[48:51], v10 offset:32
    ds_read_b128 v[52:55], v10 offset:992
    ds_read_b128 v[56:59], v10 offset:928
    s_waitcnt lgkmcnt(9)
    v_mfma_f32_16x16x32_f16 v[220:223], v[160:163], v[20:23], 0
    s_waitcnt lgkmcnt(8)
    v_mfma_f32_16x16x32_f16 v[220:223], v[164:167], v[24:27], v[220:223]
    s_waitcnt lgkmcnt(7)
    v_mfma_f32_16x16x32_f16 v[220:223], v[168:171], v[28:31], v[220:223]
    s_waitcnt lgkmcnt(6)
    v_mfma_f32_16x16x32_f16 v[220:223], v[172:175], v[32:35], v[220:223]
    s_waitcnt lgkmcnt(5)
    v_mfma_f32_16x16x32_f16 v[220:223], v[176:179], v[36:39], v[220:223]
    s_waitcnt lgkmcnt(4)
    v_mfma_f32_16x16x32_f16 v[220:223], v[180:183], v[40:43], v[220:223]
    s_waitcnt lgkmcnt(3)
    v_mfma_f32_16x16x32_f16 v[220:223], v[184:187], v[44:47], v[220:223]
    s_waitcnt lgkmcnt(2)
    v_mfma_f32_16x16x32_f16 v[220:223], v[188:191], v[48:51], v[220:223]
    s_waitcnt lgkmcnt(1)
    v_mfma_f32_16x16x32_f16 v[224:227], v[160:163], v[52:55], 0
    s_waitcnt vmcnt(0)
    v_cmp_eq_u32 vcc, 0, v134
    s_and_b32 s38, vcc_lo, 0xffff
    s_cbranch_scc0 ef_7
    s_lshl_b32 s38, s30, 2
    s_sub_u32 s38, s97, s38
    v_mul_u32_u24 v6, 4, v1
    s_mov_b32 s42, 0
    s_mov_b32 exec_hi, 0
    s_mov_b32 exec_lo, 0xffff
pf_8:
    buffer_load_dword v7, v6, s[24:27], s38 offen sc1
    s_waitcnt vmcnt(0)
    v_cmp_eq_u32 vcc, 0, v7
    s_add_u32 s42, s42, 1
    s_cmp_gt_u32 s42, 30000
    s_cbranch_scc1 pfd_9
    s_cmp_eq_u64 vcc, 0
    s_cbranch_scc1 pfd_9
    s_sleep 6
    s_branch pf_8
pfd_9:
    s_mov_b64 exec, -1
ef_7:
    s_waitcnt lgkmcnt(0)
    v_mfma_f32_16x16x32_f16 v[224:227], v[164:167], v[56:59], v[224:227]
    s_add_u32 s38, s34, 0
    buffer_load_dwordx4 v[84:87], v5, s[24:27], s38 offen offset:0 sc0
    s_add_u32 s38, s34, 0
    buffer_load_dwordx4 v[88:91], v5, s[24:27], s38 offen offset:1024 sc0
    s_add_u32 s38, s34, 4096
    buffer_load_dwordx4 v[92:95], v5, s[24:27], s38 offen offset:0 sc0
    s_add_u32 s38, s34, 4096
    buffer_load_dwordx4 v[96:99], v5, s[24:27], s38 offen offset:1024 sc0
    s_add_u32 s38, s34, 8192
    buffer_load_dwordx4 v[100:103], v5, s[24:27], s38 offen offset:0 sc0
    s_add_u32 s38, s34, 8192
    buffer_load_dwordx4 v[104:107], v5, s[24:27], s38 offen offset:1024 sc0
    s_add_u32 s38, s34, 12288
    buffer_load_dwordx4 v[108:111], v5, s[24:27], s38 offen offset:0 sc0
    s_add_u32 s38, s34, 12288
    buffer_load_dwordx4 v[112:115], v5, s[24:27], s38 offen offset:1024 sc0
    s_add_u32 s38, s34, 16384
    buffer_load_dwordx4 v[116:119], v5, s[24:27], s38 offen offset:0 sc0
    s_add_u32 s38, s34, 16384
    buffer_load_dwordx4 v[120:123], v5, s[24:27], s38 offen offset:1024 sc0
    s_add_u32 s38, s34, 20480
    buffer_load_dwordx4 v[124:127], v5, s[24:27], s38 offen offset:0 sc0
    s_add_u32 s38, s34, 20480
    buffer_load_dwordx4 v[128:131], v5, s[24:27], s38 offen offset:1024 sc0
    s_add_u32 s38, s34, 24576
    buffer_load_dwordx4 v[144:147], v5, s[24:27], s38 offen offset:0 sc0
    s_add_u32 s38, s34, 24576
    buffer_load_dwordx4 v[148:151], v5, s[24:27], s38 offen offset:1024 sc0
    s_add_u32 s38, s34, 28672
    buffer_load_dwordx4 v[152:155], v5, s[24:27], s38 offen offset:0 sc0
    s_add_u32 s38, s34, 28672
    buffer_load_dwordx4 v[156:159], v5, s[24:27], s38 offen offset:1024 sc0
pj_6:
    s_barrier
    ds_read_b128 v[52:55], v19 offset:0
    ds_read_b128 v[56:59], v19 offset:2048
    ds_read_b128 v[60:63], v19 offset:4096
    ds_read_b128 v[64:67], v19 offset:6144
    ds_read_b128 v[236:239], v10 offset:864
    ds_read_b128 v[240:243], v10 offset:800
    v_mov_b32 v15, 0xbdd2d3e8
    s_waitcnt vmcnt(14)
    s_waitcnt lgkmcnt(0)
    s_barrier
    v_mfma_f32_16x16x32_bf16 v[20:23], v[84:87], v[52:55], 0
    ds_read_b128 v[68:71], v19 offset:8192
    ds_read_b128 v[72:75], v19 offset:10240
    ds_read_b128 v[76:79], v19 offset:12288
    ds_read_b128 v[80:83], v19 offset:14336
    ds_read_b128 v[244:247], v10 offset:736
    ds_read_b128 v[248:251], v10 offset:672
    v_mfma_f32_16x16x32_bf16 v[24:27], v[88:91], v[52:55], 0
    v_mfma_f32_16x16x32_bf16 v[28:31], v[84:87], v[56:59], 0
    s_add_u32 m0, s75, 0
    s_add_u32 s39, s67, 1536
    buffer_load_dwordx4 v18, s[20:23], s39 offen lds
    v_mfma_f32_16x16x32_bf16 v[32:35], v[88:91], v[56:59], 0
    v_mfma_f32_16x16x32_bf16 v[36:39], v[84:87], v[60:63], 0
    v_mfma_f32_16x16x32_bf16 v[40:43], v[88:91], v[60:63], 0
    v_mfma_f32_16x16x32_bf16 v[44:47], v[84:87], v[64:67], 0
    v_mfma_f32_16x16x32_bf16 v[48:51], v[88:91], v[64:67], 0
    v_mfma_f32_16x16x32_f16 v[224:227], v[168:171], v[236:239], v[224:227]
    v_mfma_f32_16x16x32_f16 v[224:227], v[172:175], v[240:243], v[224:227]
    s_waitcnt vmcnt(13)
    s_waitcnt lgkmcnt(0)
    v_mfma_f32_16x16x32_bf16 v[20:23], v[92:95], v[68:71], v[20:23]
    ds_read_b128 v[52:55], v19 offset:16384
    ds_read_b128 v[56:59], v19 offset:18432
    ds_read_b128 v[60:63], v19 offset:20480
    ds_read_b128 v[64:67], v19 offset:22528
    ds_read_b128 v[236:239], v10 offset:608
    ds_read_b128 v[240:243], v10 offset:544
    v_mfma_f32_16x16x32_bf16 v[24:27], v[96:99], v[68:71], v[24:27]
    v_mfma_f32_16x16x32_bf16 v[28:31], v[92:95], v[72:75], v[28:31]
    s_add_u32 s38, s34, 32768
    buffer_load_dwordx4 v[84:87], v5, s[24:27], s38 offen offset:0 sc0
    v_mfma_f32_16x16x32_bf16 v[32:35], v[96:99], v[72:75], v[32:35]
    v_mfma_f32_16x16x32_bf16 v[36:39], v[92:95], v[76:79], v[36:39]
    s_add_u32 s38, s34, 32768
    buffer_load_dwordx4 v[88:91], v5, s[24:27], s38 offen offset:1024 sc0
    v_mfma_f32_16x16x32_bf16 v[40:43], v[96:99], v[76:79], v[40:43]
    v_mfma_f32_16x16x32_bf16 v[44:47], v[92:95], v[80:83], v[44:47]
    v_mfma_f32_16x16x32_bf16 v[48:51], v[96:99], v[80:83], v[48:51]
    v_mfma_f32_16x16x32_f16 v[224:227], v[176:179], v[244:247], v[224:227]
    v_mfma_f32_16x16x32_f16 v[224:227], v[180:183], v[248:251], v[224:227]
    s_waitcnt vmcnt(13)
    s_waitcnt lgkmcnt(0)
    s_barrier
    v_mfma_f32_16x16x32_bf16 v[20:23], v[100:103], v[52:55], v[20:23]
    ds_read_b128 v[68:71], v19 offset:24576
    ds_read_b128 v[72:75], v19 offset:26624
    ds_read_b128 v[76:79], v19 offset:28672
    ds_read_b128 v[80:83], v19 offset:30720
    ds_read_b128 v[244:247], v10 offset:480
    ds_read_b128 v[248:251], v10 offset:1504
    v_mfma_f32_16x16x32_bf16 v[24:27], v[104:107], v[52:55], v[24:27]
    v_mfma_f32_16x16x32_bf16 v[28:31], v[100:103], v[56:59], v[28:31]
    s_add_u32 m0, s75, 8192
    s_add_u32 s39, s67, 1664
    buffer_load_dwordx4 v18, s[20:23], s39 offen lds
    v_mfma_f32_16x16x32_bf16 v[32:35], v[104:107], v[56:59], v[32:35]
    v_mfma_f32_16x16x32_bf16 v[36:39], v[100:103], v[60:63], v[36:39]
    s_add_u32 m0, s75, 16384
    s_add_u32 s39, s67, 1792
    buffer_load_dwordx4 v18, s[20:23], s39 offen lds
    v_mfma_f32_16x16x32_bf16 v[40:43], v[104:107], v[60:63], v[40:43]
    v_mfma_f32_16x16x32_bf16 v[44:47], v[100:103], v[64:67], v[44:47]
    s_add_u32 s38, s34, 36864
    buffer_load_dwordx4 v[92:95], v5, s[24:27], s38 offen offset:0 sc0
    v_mfma_f32_16x16x32_bf16 v[48:51], v[104:107], v[64:67], v[48:51]
    v_mfma_f32_16x16x32_f16 v[224:227], v[184:187], v[236:239], v[224:227]
    s_add_u32 s38, s34, 36864
    buffer_load_dwordx4 v[96:99], v5, s[24:27], s38 offen offset:1024 sc0
    v_mfma_f32_16x16x32_f16 v[224:227], v[188:191], v[240:243], v[224:227]
    v_lshlrev_b32 v6, 16, v136
    v_and_b32 v7, 0xffff0000, v136
    v_mul_f32 v132, v6, v6
    v_mul_f32 v133, v7, v7
    v_fmaak_f32 v132, v132, v15, 0xc0135761
    v_fmaak_f32 v133, v133, v15, 0xc0135761
    v_mul_f32 v132, v132, v6
    v_mul_f32 v133, v133, v7
    v_exp_f32 v132, v132
    v_exp_f32 v133, v133
    v_add_f32 v132, 1.0, v132
    v_add_f32 v133, 1.0, v133
    v_rcp_f32 v132, v132
    v_rcp_f32 v133, v133
    s_nop 0
    v_mul_f32 v6, v6, v132
    v_mul_f32 v7, v7, v133
    v_cvt_pk_bf16_f32 v136, v6, v7
    s_waitcnt vmcnt(15)
    s_waitcnt lgkmcnt(0)
    v_mfma_f32_16x16x32_bf16 v[20:23], v[108:111], v[68:71], v[20:23]
    ds_read_b128 v[52:55], v19 offset:32768
    ds_read_b128 v[56:59], v19 offset:34816
    ds_read_b128 v[60:63], v19 offset:36864
    ds_read_b128 v[64:67], v19 offset:38912
    ds_read_b128 v[236:239], v10 offset:1440
    ds_read_b128 v[240:243], v10 offset:1376
    v_mfma_f32_16x16x32_bf16 v[24:27], v[112:115], v[68:71], v[24:27]
    v_mfma_f32_16x16x32_bf16 v[28:31], v[108:111], v[72:75], v[28:31]
    s_add_u32 s38, s34, 40960
    buffer_load_dwordx4 v[100:103], v5, s[24:27], s38 offen offset:0 sc0
    v_mfma_f32_16x16x32_bf16 v[32:35], v[112:115], v[72:75], v[32:35]
    v_mfma_f32_16x16x32_bf16 v[36:39], v[108:111], v[76:79], v[36:39]
    s_add_u32 s38, s34, 40960
    buffer_load_dwordx4 v[104:107], v5, s[24:27], s38 offen offset:1024 sc0
    v_mfma_f32_16x16x32_bf16 v[40:43], v[112:115], v[76:79], v[40:43]
    v_mfma_f32_16x16x32_bf16 v[44:47], v[108:111], v[80:83], v[44:47]
    s_lshl_b32 s38, s30, 2
    s_sub_u32 s38, s97, s38
    v_min_u32 v6, 59, v1
    v_lshlrev_b32 v6, 2, v6
    v_add_u32 v6, 18119552, v6
    v_or_b32 v7, 16, v1
    v_lshlrev_b32 v7, 2, v7
    v_add_u32 v7, s38, v7
    v_cmp_gt_u32 vcc, 32, v1
    v_cndmask_b32 v6, v6, v7, vcc
    buffer_load_dword v0, v6, s[24:27], 0 offen sc1
    v_mfma_f32_16x16x32_bf16 v[48:51], v[112:115], v[80:83], v[48:51]
    v_mfma_f32_16x16x32_f16 v[224:227], v[192:195], v[244:247], v[224:227]
    v_mfma_f32_16x16x32_f16 v[228:231], v[160:163], v[248:251], 0
    s_waitcnt vmcnt(16)
    s_waitcnt lgkmcnt(0)
    s_barrier
    v_mfma_f32_16x16x32_bf16 v[20:23], v[116:119], v[52:55], v[20:23]
    ds_read_b128 v[68:71], v19 offset:40960
    ds_read_b128 v[72:75], v19 offset:43008
    ds_read_b128 v[76:79], v19 offset:45056
    ds_read_b128 v[80:83], v19 offset:47104
    ds_read_b128 v[244:247], v10 offset:1312
    ds_read_b128 v[248:251], v10 offset:1248
    v_mfma_f32_16x16x32_bf16 v[24:27], v[120:123], v[52:55], v[24:27]
    v_mfma_f32_16x16x32_bf16 v[28:31], v[116:119], v[56:59], v[28:31]
    s_add_u32 m0, s75, 24576
    s_add_u32 s39, s67, 1920
    buffer_load_dwordx4 v18, s[20:23], s39 offen lds
    v_mfma_f32_16x16x32_bf16 v[32:35], v[120:123], v[56:59], v[32:35]
    v_mfma_f32_16x16x32_bf16 v[36:39], v[116:119], v[60:63], v[36:39]
    s_add_u32 m0, s75, 32768
    s_add_u32 s39, s67, 2048
    buffer_load_dwordx4 v18, s[20:23], s39 offen lds
    v_mfma_f32_16x16x32_bf16 v[40:43], v[120:123], v[60:63], v[40:43]
    v_mfma_f32_16x16x32_bf16 v[44:47], v[116:119], v[64:67], v[44:47]
    s_add_u32 s38, s34, 45056
    buffer_load_dwordx4 v[108:111], v5, s[24:27], s38 offen offset:0 sc0
    v_mfma_f32_16x16x32_bf16 v[48:51], v[120:123], v[64:67], v[48:51]
    v_mfma_f32_16x16x32_f16 v[228:231], v[164:167], v[236:239], v[228:231]
    s_add_u32 s38, s34, 45056
    buffer_load_dwordx4 v[112:115], v5, s[24:27], s38 offen offset:1024 sc0
    v_mfma_f32_16x16x32_f16 v[228:231], v[168:171], v[240:243], v[228:231]
    v_lshlrev_b32 v6, 16, v137
    v_and_b32 v7, 0xffff0000, v137
    v_mul_f32 v132, v6, v6
    v_mul_f32 v133, v7, v7
    v_fmaak_f32 v132, v132, v15, 0xc0135761
    v_fmaak_f32 v133, v133, v15, 0xc0135761
    v_mul_f32 v132, v132, v6
    v_mul_f32 v133, v133, v7
    v_exp_f32 v132, v132
    v_exp_f32 v133, v133
    v_add_f32 v132, 1.0, v132
    v_add_f32 v133, 1.0, v133
    v_rcp_f32 v132, v132
    v_rcp_f32 v133, v133
    s_nop 0
    v_mul_f32 v6, v6, v132
    v_mul_f32 v7, v7, v133
    v_cvt_pk_bf16_f32 v137, v6, v7
    s_waitcnt vmcnt(18)
    s_waitcnt lgkmcnt(0)
    v_mfma_f32_16x16x32_bf16 v[20:23], v[124:127], v[68:71], v[20:23]
    ds_read_b128 v[52:55], v19 offset:49152
    ds_read_b128 v[56:59], v19 offset:51200
    ds_read_b128 v[60:63], v19 offset:53248
    ds_read_b128 v[64:67], v19 offset:55296
    ds_read_b128 v[236:239], v10 offset:1184
    ds_read_b128 v[240:243], v10 offset:1120
    v_mfma_f32_16x16x32_bf16 v[24:27], v[128:131], v[68:71], v[24:27]
    v_mfma_f32_16x16x32_bf16 v[28:31], v[124:127], v[72:75], v[28:31]
    s_add_u32 s38, s34, 49152
    buffer_load_dwordx4 v[116:119], v5, s[24:27], s38 offen offset:0 sc0
    v_mfma_f32_16x16x32_bf16 v[32:35], v[128:131], v[72:75], v[32:35]
    v_mfma_f32_16x16x32_bf16 v[36:39], v[124:127], v[76:79], v[36:39]
    s_add_u32 s38, s34, 49152
    buffer_load_dwordx4 v[120:123], v5, s[24:27], s38 offen offset:1024 sc0
    v_mfma_f32_16x16x32_bf16 v[40:43], v[128:131], v[76:79], v[40:43]
    v_mfma_f32_16x16x32_bf16 v[44:47], v[124:127], v[80:83], v[44:47]
    v_mfma_f32_16x16x32_bf16 v[48:51], v[128:131], v[80:83], v[48:51]
    v_mfma_f32_16x16x32_f16 v[228:231], v[172:175], v[244:247], v[228:231]
    v_mfma_f32_16x16x32_f16 v[228:231], v[176:179], v[248:251], v[228:231]
    s_waitcnt vmcnt(18)
    s_waitcnt lgkmcnt(0)
    s_barrier
    v_mfma_f32_16x16x32_bf16 v[20:23], v[144:147], v[52:55], v[20:23]
    ds_read_b128 v[68:71], v19 offset:57344
    ds_read_b128 v[72:75], v19 offset:59392
    ds_read_b128 v[76:79], v19 offset:61440
    ds_read_b128 v[80:83], v19 offset:63488
    ds_read_b128 v[244:247], v10 offset:1056
    ds_read_b128 v[248:251], v10 offset:992
    v_mfma_f32_16x16x32_bf16 v[24:27], v[148:151], v[52:55], v[24:27]
    v_mfma_f32_16x16x32_bf16 v[28:31], v[144:147], v[56:59], v[28:31]
    s_add_u32 m0, s75, 40960
    s_add_u32 s39, s67, 2176
    buffer_load_dwordx4 v18, s[20:23], s39 offen lds
    v_mfma_f32_16x16x32_bf16 v[32:35], v[148:151], v[56:59], v[32:35]
    v_mfma_f32_16x16x32_bf16 v[36:39], v[144:147], v[60:63], v[36:39]
    s_add_u32 m0, s75, 49152
    s_add_u32 s39, s67, 2304
    buffer_load_dwordx4 v18, s[20:23], s39 offen lds
    v_mfma_f32_16x16x32_bf16 v[40:43], v[148:151], v[60:63], v[40:43]
    v_mfma_f32_16x16x32_bf16 v[44:47], v[144:147], v[64:67], v[44:47]
    s_add_u32 s38, s34, 53248
    buffer_load_dwordx4 v[124:127], v5, s[24:27], s38 offen offset:0 sc0
    v_mfma_f32_16x16x32_bf16 v[48:51], v[148:151], v[64:67], v[48:51]
    v_mfma_f32_16x16x32_f16 v[228:231], v[180:183], v[236:239], v[228:231]
    s_add_u32 s38, s34, 53248
    buffer_load_dwordx4 v[128:131], v5, s[24:27], s38 offen offset:1024 sc0
    v_mfma_f32_16x16x32_f16 v[228:231], v[184:187], v[240:243], v[228:231]
    v_lshlrev_b32 v6, 16, v138
    v_and_b32 v7, 0xffff0000, v138
    v_mul_f32 v132, v6, v6
    v_mul_f32 v133, v7, v7
    v_fmaak_f32 v132, v132, v15, 0xc0135761
    v_fmaak_f32 v133, v133, v15, 0xc0135761
    v_mul_f32 v132, v132, v6
    v_mul_f32 v133, v133, v7
    v_exp_f32 v132, v132
    v_exp_f32 v133, v133
    v_add_f32 v132, 1.0, v132
    v_add_f32 v133, 1.0, v133
    v_rcp_f32 v132, v132
    v_rcp_f32 v133, v133
    s_nop 0
    v_mul_f32 v6, v6, v132
    v_mul_f32 v7, v7, v133
    v_cvt_pk_bf16_f32 v138, v6, v7
    s_waitcnt vmcnt(20)
    s_waitcnt lgkmcnt(0)
    v_mfma_f32_16x16x32_bf16 v[20:23], v[152:155], v[68:71], v[20:23]
    ds_read_b128 v[52:55], v135 offset:0
    ds_read_b128 v[56:59], v135 offset:2048
    ds_read_b128 v[60:63], v135 offset:4096
    ds_read_b128 v[64:67], v135 offset:6144
    ds_read_b128 v[236:239], v10 offset:2016
    ds_read_b128 v[240:243], v10 offset:1952
    v_mfma_f32_16x16x32_bf16 v[24:27], v[156:159], v[68:71], v[24:27]
    v_mfma_f32_16x16x32_bf16 v[28:31], v[152:155], v[72:75], v[28:31]
    s_add_u32 s38, s34, 57344
    buffer_load_dwordx4 v[144:147], v5, s[24:27], s38 offen offset:0 sc0
    v_mfma_f32_16x16x32_bf16 v[32:35], v[156:159], v[72:75], v[32:35]
    v_mfma_f32_16x16x32_bf16 v[36:39], v[152:155], v[76:79], v[36:39]
    s_add_u32 s38, s34, 57344
    buffer_load_dwordx4 v[148:151], v5, s[24:27], s38 offen offset:1024 sc0
    v_mfma_f32_16x16x32_bf16 v[40:43], v[156:159], v[76:79], v[40:43]
    v_mfma_f32_16x16x32_bf16 v[44:47], v[152:155], v[80:83], v[44:47]
    v_mfma_f32_16x16x32_bf16 v[48:51], v[156:159], v[80:83], v[48:51]
    v_mfma_f32_16x16x32_f16 v[228:231], v[188:191], v[244:247], v[228:231]
    v_mfma_f32_16x16x32_f16 v[228:231], v[192:195], v[248:251], v[228:231]
    s_waitcnt vmcnt(19)
    s_waitcnt lgkmcnt(0)
    s_barrier
    v_mfma_f32_16x16x32_bf16 v[20:23], v[84:87], v[52:55], v[20:23]
    ds_read_b128 v[68:71], v135 offset:8192
    ds_read_b128 v[72:75], v135 offset:10240
    ds_read_b128 v[76:79], v135 offset:12288
    ds_read_b128 v[80:83], v135 offset:14336
    ds_read_b128 v[244:247], v10 offset:1888
    ds_read_b128 v[248:251], v10 offset:1824
    v_mfma_f32_16x16x32_bf16 v[24:27], v[88:91], v[52:55], v[24:27]
    v_mfma_f32_16x16x32_bf16 v[28:31], v[84:87], v[56:59], v[28:31]
    s_add_u32 m0, s75, 57344
    s_add_u32 s39, s67, 2432
    buffer_load_dwordx4 v18, s[20:23], s39 offen lds
    v_mfma_f32_16x16x32_bf16 v[32:35], v[88:91], v[56:59], v[32:35]
    v_mfma_f32_16x16x32_bf16 v[36:39], v[84:87], v[60:63], v[36:39]
    s_add_u32 m0, s75, 65536
    s_add_u32 s39, s67, 2560
    buffer_load_dwordx4 v18, s[20:23], s39 offen lds
    v_mfma_f32_16x16x32_bf16 v[40:43], v[88:91], v[60:63], v[40:43]
    v_mfma_f32_16x16x32_bf16 v[44:47], v[84:87], v[64:67], v[44:47]
    s_add_u32 s38, s34, 61440
    buffer_load_dwordx4 v[152:155], v5, s[24:27], s38 offen offset:0 sc0
    v_mfma_f32_16x16x32_bf16 v[48:51], v[88:91], v[64:67], v[48:51]
    v_mfma_f32_16x16x32_f16 v[232:235], v[160:163], v[236:239], 0
    s_add_u32 s38, s34, 61440
    buffer_load_dwordx4 v[156:159], v5, s[24:27], s38 offen offset:1024 sc0
    v_mfma_f32_16x16x32_f16 v[232:235], v[164:167], v[240:243], v[232:235]
    v_lshlrev_b32 v6, 16, v139
    v_and_b32 v7, 0xffff0000, v139
    v_mul_f32 v132, v6, v6
    v_mul_f32 v133, v7, v7
    v_fmaak_f32 v132, v132, v15, 0xc0135761
    v_fmaak_f32 v133, v133, v15, 0xc0135761
    v_mul_f32 v132, v132, v6
    v_mul_f32 v133, v133, v7
    v_exp_f32 v132, v132
    v_exp_f32 v133, v133
    v_add_f32 v132, 1.0, v132
    v_add_f32 v133, 1.0, v133
    v_rcp_f32 v132, v132
    v_rcp_f32 v133, v133
    s_nop 0
    v_mul_f32 v6, v6, v132
    v_mul_f32 v7, v7, v133
    v_cvt_pk_bf16_f32 v139, v6, v7
    s_waitcnt vmcnt(19)
    s_waitcnt vmcnt(16)
    v_cmp_eq_u32 vcc, 0, v0
    s_cmp_eq_u64 vcc, 0
    s_cbranch_scc1 fs_10
    s_lshl_b32 s38, s30, 2
    s_sub_u32 s38, s97, s38
    v_min_u32 v6, 59, v1
    v_lshlrev_b32 v6, 2, v6
    v_add_u32 v6, 18119552, v6
    v_or_b32 v7, 16, v1
    v_lshlrev_b32 v7, 2, v7
    v_add_u32 v7, s38, v7
    v_cmp_gt_u32 vcc, 32, v1
    v_cndmask_b32 v6, v6, v7, vcc
    v_mov_b32 v0, 0
    s_mov_b32 s42, 0
ck_11:
    v_cmp_eq_u32 vcc, 0, v0
    s_add_u32 s42, s42, 1
    s_cmp_gt_u32 s42, 30000
    s_cbranch_scc1 ckd_12
    s_cmp_eq_u64 vcc, 0
    s_cbranch_scc1 ckd_12
    s_sleep 2
    buffer_load_dword v0, v6, s[24:27], 0 offen sc1
    s_waitcnt vmcnt(0)
    s_branch ck_11
ckd_12:
fs_10:
    s_waitcnt lgkmcnt(0)
    v_mfma_f32_16x16x32_bf16 v[20:23], v[92:95], v[68:71], v[20:23]
    ds_read_b128 v[52:55], v135 offset:16384
    ds_read_b128 v[56:59], v135 offset:18432
    ds_read_b128 v[60:63], v135 offset:20480
    ds_read_b128 v[64:67], v135 offset:22528
    ds_read_b128 v[236:239], v10 offset:1760
    ds_read_b128 v[240:243], v10 offset:1696
    v_mfma_f32_16x16x32_bf16 v[24:27], v[96:99], v[68:71], v[24:27]
    v_mfma_f32_16x16x32_bf16 v[28:31], v[92:95], v[72:75], v[28:31]
    s_add_u32 s38, s34, 65536
    buffer_load_dwordx4 v[84:87], v5, s[24:27], s38 offen offset:0 sc0
    v_mfma_f32_16x16x32_bf16 v[32:35], v[96:99], v[72:75], v[32:35]
    v_mfma_f32_16x16x32_bf16 v[36:39], v[92:95], v[76:79], v[36:39]
    s_add_u32 s38, s34, 65536
    buffer_load_dwordx4 v[88:91], v5, s[24:27], s38 offen offset:1024 sc0
    v_mfma_f32_16x16x32_bf16 v[40:43], v[96:99], v[76:79], v[40:43]
    v_mfma_f32_16x16x32_bf16 v[44:47], v[92:95], v[80:83], v[44:47]
    v_mfma_f32_16x16x32_bf16 v[48:51], v[96:99], v[80:83], v[48:51]
    v_mfma_f32_16x16x32_f16 v[232:235], v[168:171], v[244:247], v[232:235]
    v_mfma_f32_16x16x32_f16 v[232:235], v[172:175], v[248:251], v[232:235]
    s_waitcnt lgkmcnt(0)
    s_barrier
    v_mfma_f32_16x16x32_bf16 v[20:23], v[100:103], v[52:55], v[20:23]
    ds_read_b128 v[68:71], v135 offset:24576
    ds_read_b128 v[72:75], v135 offset:26624
    ds_read_b128 v[76:79], v135 offset:28672
    ds_read_b128 v[80:83], v135 offset:30720
    ds_read_b128 v[244:247], v10 offset:1632
    ds_read_b128 v[248:251], v10 offset:1568
    v_mfma_f32_16x16x32_bf16 v[24:27], v[104:107], v[52:55], v[24:27]
    v_mfma_f32_16x16x32_bf16 v[28:31], v[100:103], v[56:59], v[28:31]
    s_add_u32 m0, s75, 73728
    s_add_u32 s39, s67, 2688
    buffer_load_dwordx4 v18, s[20:23], s39 offen lds
    v_mfma_f32_16x16x32_bf16 v[32:35], v[104:107], v[56:59], v[32:35]
    v_mfma_f32_16x16x32_bf16 v[36:39], v[100:103], v[60:63], v[36:39]
    s_add_u32 m0, s75, 81920
    s_add_u32 s39, s67, 2816
    buffer_load_dwordx4 v18, s[20:23], s39 offen lds
    v_mfma_f32_16x16x32_bf16 v[40:43], v[104:107], v[60:63], v[40:43]
    v_mfma_f32_16x16x32_bf16 v[44:47], v[100:103], v[64:67], v[44:47]
    s_add_u32 s38, s34, 69632
    buffer_load_dwordx4 v[92:95], v5, s[24:27], s38 offen offset:0 sc0
    v_mfma_f32_16x16x32_bf16 v[48:51], v[104:107], v[64:67], v[48:51]
    v_mfma_f32_16x16x32_f16 v[232:235], v[176:179], v[236:239], v[232:235]
    s_add_u32 s38, s34, 69632
    buffer_load_dwordx4 v[96:99], v5, s[24:27], s38 offen offset:1024 sc0
    v_mfma_f32_16x16x32_f16 v[232:235], v[180:183], v[240:243], v[232:235]
    v_lshlrev_b32 v6, 16, v140
    v_and_b32 v7, 0xffff0000, v140
    v_mul_f32 v132, v6, v6
    v_mul_f32 v133, v7, v7
    v_fmaak_f32 v132, v132, v15, 0xc0135761
    v_fmaak_f32 v133, v133, v15, 0xc0135761
    v_mul_f32 v132, v132, v6
    v_mul_f32 v133, v133, v7
    v_exp_f32 v132, v132
    v_exp_f32 v133, v133
    v_add_f32 v132, 1.0, v132
    v_add_f32 v133, 1.0, v133
    v_rcp_f32 v132, v132
    v_rcp_f32 v133, v133
    s_nop 0
    v_mul_f32 v6, v6, v132
    v_mul_f32 v7, v7, v133
    v_cvt_pk_bf16_f32 v140, v6, v7
    s_waitcnt vmcnt(18)
    s_waitcnt lgkmcnt(0)
    v_mfma_f32_16x16x32_bf16 v[20:23], v[108:111], v[68:71], v[20:23]
    ds_read_b128 v[52:55], v19 offset:0
    ds_read_b128 v[56:59], v19 offset:2048
    ds_read_b128 v[60:63], v19 offset:4096
    ds_read_b128 v[64:67], v19 offset:6144
    ds_read_b128 v[236:239], v10 offset:1504
    ds_read_b128 v[240:243], v10 offset:0
    v_mfma_f32_16x16x32_bf16 v[24:27], v[112:115], v[68:71], v[24:27]
    v_mfma_f32_16x16x32_bf16 v[28:31], v[108:111], v[72:75], v[28:31]
    s_add_u32 s38, s34, 73728
    buffer_load_dwordx4 v[100:103], v5, s[24:27], s38 offen offset:0 sc0
    v_mfma_f32_16x16x32_bf16 v[32:35], v[112:115], v[72:75], v[32:35]
    v_mfma_f32_16x16x32_bf16 v[36:39], v[108:111], v[76:79], v[36:39]
    s_add_u32 s38, s34, 73728
    buffer_load_dwordx4 v[104:107], v5, s[24:27], s38 offen offset:1024 sc0
    v_mfma_f32_16x16x32_bf16 v[40:43], v[112:115], v[76:79], v[40:43]
    v_mfma_f32_16x16x32_bf16 v[44:47], v[108:111], v[80:83], v[44:47]
    v_mfma_f32_16x16x32_bf16 v[48:51], v[112:115], v[80:83], v[48:51]
    v_mfma_f32_16x16x32_f16 v[232:235], v[184:187], v[244:247], v[232:235]
    v_mfma_f32_16x16x32_f16 v[232:235], v[188:191], v[248:251], v[232:235]
    s_waitcnt vmcnt(18)
    s_waitcnt lgkmcnt(0)
    s_barrier
    v_mfma_f32_16x16x32_bf16 v[20:23], v[116:119], v[52:55], v[20:23]
    ds_read_b128 v[68:71], v19 offset:8192
    ds_read_b128 v[72:75], v19 offset:10240
    ds_read_b128 v[76:79], v19 offset:12288
    ds_read_b128 v[80:83], v19 offset:14336
    ds_read_b128 v[244:247], v13 offset:8192
    v_mfma_f32_16x16x32_bf16 v[24:27], v[120:123], v[52:55], v[24:27]
    v_mfma_f32_16x16x32_bf16 v[28:31], v[116:119], v[56:59], v[28:31]
    s_add_u32 m0, s75, 90112
    s_add_u32 s39, s67, 2944
    buffer_load_dwordx4 v18, s[20:23], s39 offen lds
    v_mfma_f32_16x16x32_bf16 v[32:35], v[120:123], v[56:59], v[32:35]
    v_mfma_f32_16x16x32_bf16 v[36:39], v[116:119], v[60:63], v[36:39]
    s_add_u32 m0, s75, 0
    s_add_u32 s39, s67, 3072
    buffer_load_dwordx4 v18, s[20:23], s39 offen lds
    v_mfma_f32_16x16x32_bf16 v[40:43], v[120:123], v[60:63], v[40:43]
    v_mfma_f32_16x16x32_bf16 v[44:47], v[116:119], v[64:67], v[44:47]
    s_add_u32 s38, s34, 77824
    buffer_load_dwordx4 v[108:111], v5, s[24:27], s38 offen offset:0 sc0
    v_mfma_f32_16x16x32_bf16 v[48:51], v[120:123], v[64:67], v[48:51]
    v_mfma_f32_16x16x32_f16 v[232:235], v[192:195], v[236:239], v[232:235]
    s_add_u32 s38, s34, 77824
    buffer_load_dwordx4 v[112:115], v5, s[24:27], s38 offen offset:1024 sc0
    v_mfma_f32_16x16x32_f16 v[232:235], v[196:199], v[240:243], v[232:235]
    v_lshlrev_b32 v6, 16, v141
    v_and_b32 v7, 0xffff0000, v141
    v_mul_f32 v132, v6, v6
    v_mul_f32 v133, v7, v7
    v_fmaak_f32 v132, v132, v15, 0xc0135761
    v_fmaak_f32 v133, v133, v15, 0xc0135761
    v_mul_f32 v132, v132, v6
    v_mul_f32 v133, v133, v7
    v_exp_f32 v132, v132
    v_exp_f32 v133, v133
    v_add_f32 v132, 1.0, v132
    v_add_f32 v133, 1.0, v133
    v_rcp_f32 v132, v132
    v_rcp_f32 v133, v133
    s_nop 0
    v_mul_f32 v6, v6, v132
    v_mul_f32 v7, v7, v133
    v_cvt_pk_bf16_f32 v141, v6, v7
    s_waitcnt vmcnt(18)
    s_waitcnt lgkmcnt(0)
    v_mfma_f32_16x16x32_bf16 v[20:23], v[124:127], v[68:71], v[20:23]
    ds_read_b128 v[52:55], v19 offset:16384
    ds_read_b128 v[56:59], v19 offset:18432
    ds_read_b128 v[60:63], v19 offset:20480
    ds_read_b128 v[64:67], v19 offset:22528
    v_mfma_f32_16x16x32_bf16 v[24:27], v[128:131], v[68:71], v[24:27]
    v_mfma_f32_16x16x32_bf16 v[28:31], v[124:127], v[72:75], v[28:31]
    s_add_u32 s38, s34, 81920
    buffer_load_dwordx4 v[116:119], v5, s[24:27], s38 offen offset:0 sc0
    v_mfma_f32_16x16x32_bf16 v[32:35], v[128:131], v[72:75], v[32:35]
    v_mfma_f32_16x16x32_bf16 v[36:39], v[124:127], v[76:79], v[36:39]
    s_add_u32 s38, s34, 81920
    buffer_load_dwordx4 v[120:123], v5, s[24:27], s38 offen offset:1024 sc0
    v_mfma_f32_16x16x32_bf16 v[40:43], v[128:131], v[76:79], v[40:43]
    v_mfma_f32_16x16x32_bf16 v[44:47], v[124:127], v[80:83], v[44:47]
    v_mfma_f32_16x16x32_bf16 v[48:51], v[128:131], v[80:83], v[48:51]
    v_mfma_f32_16x16x32_f16 v[232:235], v[244:247], v[200:203], v[232:235]
    s_waitcnt vmcnt(18)
    s_waitcnt lgkmcnt(0)
    s_barrier
    v_mfma_f32_16x16x32_bf16 v[20:23], v[144:147], v[52:55], v[20:23]
    ds_read_b128 v[68:71], v19 offset:24576
    ds_read_b128 v[72:75], v19 offset:26624
    ds_read_b128 v[76:79], v19 offset:28672
    ds_read_b128 v[80:83], v19 offset:30720
    v_mfma_f32_16x16x32_bf16 v[24:27], v[148:151], v[52:55], v[24:27]
    v_mfma_f32_16x16x32_bf16 v[28:31], v[144:147], v[56:59], v[28:31]
    s_add_u32 m0, s75, 8192
    s_add_u32 s39, s67, 3200
    buffer_load_dwordx4 v18, s[20:23], s39 offen lds
    v_mfma_f32_16x16x32_bf16 v[32:35], v[148:151], v[56:59], v[32:35]
    v_mfma_f32_16x16x32_bf16 v[36:39], v[144:147], v[60:63], v[36:39]
    s_add_u32 m0, s75, 16384
    s_add_u32 s39, s67, 3328
    buffer_load_dwordx4 v18, s[20:23], s39 offen lds
    v_mfma_f32_16x16x32_bf16 v[40:43], v[148:151], v[60:63], v[40:43]
    v_mfma_f32_16x16x32_bf16 v[44:47], v[144:147], v[64:67], v[44:47]
    s_add_u32 s38, s34, 86016
    buffer_load_dwordx4 v[124:127], v5, s[24:27], s38 offen offset:0 sc0
    v_mfma_f32_16x16x32_bf16 v[48:51], v[148:151], v[64:67], v[48:51]
    s_add_u32 s38, s34, 86016
    buffer_load_dwordx4 v[128:131], v5, s[24:27], s38 offen offset:1024 sc0
    v_lshlrev_b32 v6, 16, v142
    v_and_b32 v7, 0xffff0000, v142
    v_mul_f32 v132, v6, v6
    v_mul_f32 v133, v7, v7
    v_fmaak_f32 v132, v132, v15, 0xc0135761
    v_fmaak_f32 v133, v133, v15, 0xc0135761
    v_mul_f32 v132, v132, v6
    v_mul_f32 v133, v133, v7
    v_exp_f32 v132, v132
    v_exp_f32 v133, v133
    v_add_f32 v132, 1.0, v132
    v_add_f32 v133, 1.0, v133
    v_rcp_f32 v132, v132
    v_rcp_f32 v133, v133
    s_nop 0
    v_mul_f32 v6, v6, v132
    v_mul_f32 v7, v7, v133
    v_cvt_pk_bf16_f32 v142, v6, v7
    s_waitcnt vmcnt(18)
    s_waitcnt lgkmcnt(0)
    v_mfma_f32_16x16x32_bf16 v[20:23], v[152:155], v[68:71], v[20:23]
    ds_read_b128 v[52:55], v19 offset:32768
    ds_read_b128 v[56:59], v19 offset:34816
    ds_read_b128 v[60:63], v19 offset:36864
    ds_read_b128 v[64:67], v19 offset:38912
    v_mfma_f32_16x16x32_bf16 v[24:27], v[156:159], v[68:71], v[24:27]
    v_mfma_f32_16x16x32_bf16 v[28:31], v[152:155], v[72:75], v[28:31]
    s_add_u32 s38, s34, 90112
    buffer_load_dwordx4 v[144:147], v5, s[24:27], s38 offen offset:0 sc0
    v_mfma_f32_16x16x32_bf16 v[32:35], v[156:159], v[72:75], v[32:35]
    v_mfma_f32_16x16x32_bf16 v[36:39], v[152:155], v[76:79], v[36:39]
    s_add_u32 s38, s34, 90112
    buffer_load_dwordx4 v[148:151], v5, s[24:27], s38 offen offset:1024 sc0
    v_mfma_f32_16x16x32_bf16 v[40:43], v[156:159], v[76:79], v[40:43]
    v_mfma_f32_16x16x32_bf16 v[44:47], v[152:155], v[80:83], v[44:47]
    v_mfma_f32_16x16x32_bf16 v[48:51], v[156:159], v[80:83], v[48:51]
    s_waitcnt vmcnt(18)
    s_waitcnt lgkmcnt(0)
    s_barrier
    v_mfma_f32_16x16x32_bf16 v[20:23], v[84:87], v[52:55], v[20:23]
    ds_read_b128 v[68:71], v19 offset:40960
    ds_read_b128 v[72:75], v19 offset:43008
    ds_read_b128 v[76:79], v19 offset:45056
    ds_read_b128 v[80:83], v19 offset:47104
    v_mfma_f32_16x16x32_bf16 v[24:27], v[88:91], v[52:55], v[24:27]
    v_mfma_f32_16x16x32_bf16 v[28:31], v[84:87], v[56:59], v[28:31]
    s_add_u32 m0, s75, 24576
    s_add_u32 s39, s67, 3456
    buffer_load_dwordx4 v18, s[20:23], s39 offen lds
    v_mfma_f32_16x16x32_bf16 v[32:35], v[88:91], v[56:59], v[32:35]
    v_mfma_f32_16x16x32_bf16 v[36:39], v[84:87], v[60:63], v[36:39]
    s_add_u32 m0, s75, 32768
    s_add_u32 s39, s67, 3584
    buffer_load_dwordx4 v18, s[20:23], s39 offen lds
    v_mfma_f32_16x16x32_bf16 v[40:43], v[88:91], v[60:63], v[40:43]
    v_mfma_f32_16x16x32_bf16 v[44:47], v[84:87], v[64:67], v[44:47]
    s_add_u32 s38, s34, 94208
    buffer_load_dwordx4 v[152:155], v5, s[24:27], s38 offen offset:0 sc0
    v_mfma_f32_16x16x32_bf16 v[48:51], v[88:91], v[64:67], v[48:51]
    s_add_u32 s38, s34, 94208
    buffer_load_dwordx4 v[156:159], v5, s[24:27], s38 offen offset:1024 sc0
    v_lshlrev_b32 v6, 16, v143
    v_and_b32 v7, 0xffff0000, v143
    v_mul_f32 v132, v6, v6
    v_mul_f32 v133, v7, v7
    v_fmaak_f32 v132, v132, v15, 0xc0135761
    v_fmaak_f32 v133, v133, v15, 0xc0135761
    v_mul_f32 v132, v132, v6
    v_mul_f32 v133, v133, v7
    v_exp_f32 v132, v132
    v_exp_f32 v133, v133
    v_add_f32 v132, 1.0, v132
    v_add_f32 v133, 1.0, v133
    v_rcp_f32 v132, v132
    v_rcp_f32 v133, v133
    s_nop 0
    v_mul_f32 v6, v6, v132
    v_mul_f32 v7, v7, v133
    v_cvt_pk_bf16_f32 v143, v6, v7
    s_waitcnt vmcnt(18)
    s_waitcnt lgkmcnt(0)
    v_mfma_f32_16x16x32_bf16 v[20:23], v[92:95], v[68:71], v[20:23]
    ds_read_b128 v[52:55], v19 offset:49152
    ds_read_b128 v[56:59], v19 offset:51200
    ds_read_b128 v[60:63], v19 offset:53248
    ds_read_b128 v[64:67], v19 offset:55296
    v_mfma_f32_16x16x32_bf16 v[24:27], v[96:99], v[68:71], v[24:27]
    v_mfma_f32_16x16x32_bf16 v[28:31], v[92:95], v[72:75], v[28:31]
    s_add_u32 s38, s34, 98304
    buffer_load_dwordx4 v[84:87], v5, s[24:27], s38 offen offset:0 sc0
    v_mfma_f32_16x16x32_bf16 v[32:35], v[96:99], v[72:75], v[32:35]
    v_mfma_f32_16x16x32_bf16 v[36:39], v[92:95], v[76:79], v[36:39]
    s_add_u32 s38, s34, 98304
    buffer_load_dwordx4 v[88:91], v5, s[24:27], s38 offen offset:1024 sc0
    v_mfma_f32_16x16x32_bf16 v[40:43], v[96:99], v[76:79], v[40:43]
    v_mfma_f32_16x16x32_bf16 v[44:47], v[92:95], v[80:83], v[44:47]
    v_mfma_f32_16x16x32_bf16 v[48:51], v[96:99], v[80:83], v[48:51]
    s_waitcnt vmcnt(18)
    s_waitcnt lgkmcnt(0)
    s_barrier
    v_mfma_f32_16x16x32_bf16 v[20:23], v[100:103], v[52:55], v[20:23]
    ds_read_b128 v[68:71], v19 offset:57344
    ds_read_b128 v[72:75], v19 offset:59392
    ds_read_b128 v[76:79], v19 offset:61440
    ds_read_b128 v[80:83], v19 offset:63488
    v_mfma_f32_16x16x32_bf16 v[24:27], v[104:107], v[52:55], v[24:27]
    v_mfma_f32_16x16x32_bf16 v[28:31], v[100:103], v[56:59], v[28:31]
    s_add_u32 m0, s75, 40960
    s_add_u32 s39, s67, 3712
    buffer_load_dwordx4 v18, s[20:23], s39 offen lds
    v_mfma_f32_16x16x32_bf16 v[32:35], v[104:107], v[56:59], v[32:35]
    v_mfma_f32_16x16x32_bf16 v[36:39], v[100:103], v[60:63], v[36:39]
    s_add_u32 m0, s75, 49152
    s_add_u32 s39, s67, 3840
    buffer_load_dwordx4 v18, s[20:23], s39 offen lds
    v_mfma_f32_16x16x32_bf16 v[40:43], v[104:107], v[60:63], v[40:43]
    v_mfma_f32_16x16x32_bf16 v[44:47], v[100:103], v[64:67], v[44:47]
    s_add_u32 s38, s34, 102400
    buffer_load_dwordx4 v[92:95], v5, s[24:27], s38 offen offset:0 sc0
    v_mfma_f32_16x16x32_bf16 v[48:51], v[104:107], v[64:67], v[48:51]
    s_add_u32 s38, s34, 102400
    buffer_load_dwordx4 v[96:99], v5, s[24:27], s38 offen offset:1024 sc0
    s_waitcnt vmcnt(18)
    s_waitcnt lgkmcnt(0)
    v_mfma_f32_16x16x32_bf16 v[20:23], v[108:111], v[68:71], v[20:23]
    ds_read_b128 v[52:55], v135 offset:0
    ds_read_b128 v[56:59], v135 offset:2048
    ds_read_b128 v[60:63], v135 offset:4096
    ds_read_b128 v[64:67], v135 offset:6144
    v_mfma_f32_16x16x32_bf16 v[24:27], v[112:115], v[68:71], v[24:27]
    v_mfma_f32_16x16x32_bf16 v[28:31], v[108:111], v[72:75], v[28:31]
    s_add_u32 s38, s34, 106496
    buffer_load_dwordx4 v[100:103], v5, s[24:27], s38 offen offset:0 sc0
    v_mfma_f32_16x16x32_bf16 v[32:35], v[112:115], v[72:75], v[32:35]
    v_mfma_f32_16x16x32_bf16 v[36:39], v[108:111], v[76:79], v[36:39]
    s_add_u32 s38, s34, 106496
    buffer_load_dwordx4 v[104:107], v5, s[24:27], s38 offen offset:1024 sc0
    v_mfma_f32_16x16x32_bf16 v[40:43], v[112:115], v[76:79], v[40:43]
    v_mfma_f32_16x16x32_bf16 v[44:47], v[108:111], v[80:83], v[44:47]
    v_mfma_f32_16x16x32_bf16 v[48:51], v[112:115], v[80:83], v[48:51]
    s_waitcnt vmcnt(18)
    s_waitcnt lgkmcnt(0)
    s_barrier
    v_mfma_f32_16x16x32_bf16 v[20:23], v[116:119], v[52:55], v[20:23]
    ds_read_b128 v[68:71], v135 offset:8192
    ds_read_b128 v[72:75], v135 offset:10240
    ds_read_b128 v[76:79], v135 offset:12288
    ds_read_b128 v[80:83], v135 offset:14336
    v_mfma_f32_16x16x32_bf16 v[24:27], v[120:123], v[52:55], v[24:27]
    v_mfma_f32_16x16x32_bf16 v[28:31], v[116:119], v[56:59], v[28:31]
    s_add_u32 m0, s75, 57344
    s_add_u32 s39, s67, 3968
    buffer_load_dwordx4 v18, s[20:23], s39 offen lds
    v_mfma_f32_16x16x32_bf16 v[32:35], v[120:123], v[56:59], v[32:35]
    v_mfma_f32_16x16x32_bf16 v[36:39], v[116:119], v[60:63], v[36:39]
    s_add_u32 s38, s34, 110592
    buffer_load_dwordx4 v[108:111], v5, s[24:27], s38 offen offset:0 sc0
    v_mfma_f32_16x16x32_bf16 v[40:43], v[120:123], v[60:63], v[40:43]
    v_mfma_f32_16x16x32_bf16 v[44:47], v[116:119], v[64:67], v[44:47]
    s_add_u32 s38, s34, 110592
    buffer_load_dwordx4 v[112:115], v5, s[24:27], s38 offen offset:1024 sc0
    v_mfma_f32_16x16x32_bf16 v[48:51], v[120:123], v[64:67], v[48:51]
    s_waitcnt vmcnt(17)
    s_waitcnt lgkmcnt(0)
    v_mfma_f32_16x16x32_bf16 v[20:23], v[124:127], v[68:71], v[20:23]
    ds_read_b128 v[52:55], v135 offset:16384
    ds_read_b128 v[56:59], v135 offset:18432
    ds_read_b128 v[60:63], v135 offset:20480
    ds_read_b128 v[64:67], v135 offset:22528
    v_mfma_f32_16x16x32_bf16 v[24:27], v[128:131], v[68:71], v[24:27]
    v_mfma_f32_16x16x32_bf16 v[28:31], v[124:127], v[72:75], v[28:31]
    s_add_u32 s38, s34, 114688
    buffer_load_dwordx4 v[116:119], v5, s[24:27], s38 offen offset:0 sc0
    v_mfma_f32_16x16x32_bf16 v[32:35], v[128:131], v[72:75], v[32:35]
    v_mfma_f32_16x16x32_bf16 v[36:39], v[124:127], v[76:79], v[36:39]
    s_add_u32 s38, s34, 114688
    buffer_load_dwordx4 v[120:123], v5, s[24:27], s38 offen offset:1024 sc0
    v_mfma_f32_16x16x32_bf16 v[40:43], v[128:131], v[76:79], v[40:43]
    v_mfma_f32_16x16x32_bf16 v[44:47], v[124:127], v[80:83], v[44:47]
    v_mfma_f32_16x16x32_bf16 v[48:51], v[128:131], v[80:83], v[48:51]
    s_waitcnt vmcnt(17)
    s_waitcnt lgkmcnt(0)
    s_barrier
    v_mfma_f32_16x16x32_bf16 v[20:23], v[144:147], v[52:55], v[20:23]
    ds_read_b128 v[68:71], v135 offset:24576
    ds_read_b128 v[72:75], v135 offset:26624
    ds_read_b128 v[76:79], v135 offset:28672
    ds_read_b128 v[80:83], v135 offset:30720
    ds_write_b128 v12, v[220:223] offset:0
    ds_write_b128 v12, v[224:227] offset:1024
    ds_write_b128 v12, v[228:231] offset:2048
    ds_write_b128 v12, v[232:235] offset:3072
    v_mfma_f32_16x16x32_bf16 v[24:27], v[148:151], v[52:55], v[24:27]
    v_mfma_f32_16x16x32_bf16 v[28:31], v[144:147], v[56:59], v[28:31]
    s_add_u32 s38, s34, 118784
    buffer_load_dwordx4 v[124:127], v5, s[24:27], s38 offen offset:0 sc0
    v_mfma_f32_16x16x32_bf16 v[32:35], v[148:151], v[56:59], v[32:35]
    v_mfma_f32_16x16x32_bf16 v[36:39], v[144:147], v[60:63], v[36:39]
    s_add_u32 s38, s34, 118784
    buffer_load_dwordx4 v[128:131], v5, s[24:27], s38 offen offset:1024 sc0
    v_mfma_f32_16x16x32_bf16 v[40:43], v[148:151], v[60:63], v[40:43]
    v_mfma_f32_16x16x32_bf16 v[44:47], v[144:147], v[64:67], v[44:47]
    v_mfma_f32_16x16x32_bf16 v[48:51], v[148:151], v[64:67], v[48:51]
    s_waitcnt vmcnt(15)
    s_waitcnt lgkmcnt(0)
    s_barrier
    v_mfma_f32_16x16x32_bf16 v[20:23], v[152:155], v[68:71], v[20:23]
    ds_read_b128 v[52:55], v19 offset:0
    ds_read_b128 v[56:59], v19 offset:2048
    ds_read_b128 v[60:63], v19 offset:4096
    ds_read_b128 v[64:67], v19 offset:6144
    ds_read_b128 v[160:163], v9 offset:0
    ds_read_b128 v[164:167], v9 offset:13568
    ds_read_b128 v[176:179], v9 offset:1024
    ds_read_b128 v[180:183], v9 offset:14592
    ds_read_b128 v[184:187], v9 offset:21824
    v_mfma_f32_16x16x32_bf16 v[24:27], v[156:159], v[68:71], v[24:27]
    v_mfma_f32_16x16x32_bf16 v[28:31], v[152:155], v[72:75], v[28:31]
    s_add_u32 s38, s34, 122880
    buffer_load_dwordx4 v[144:147], v5, s[24:27], s38 offen offset:0 sc0
    v_mfma_f32_16x16x32_bf16 v[32:35], v[156:159], v[72:75], v[32:35]
    v_mfma_f32_16x16x32_bf16 v[36:39], v[152:155], v[76:79], v[36:39]
    s_add_u32 s38, s34, 122880
    buffer_load_dwordx4 v[148:151], v5, s[24:27], s38 offen offset:1024 sc0
    v_mfma_f32_16x16x32_bf16 v[40:43], v[156:159], v[76:79], v[40:43]
    v_mfma_f32_16x16x32_bf16 v[44:47], v[152:155], v[80:83], v[44:47]
    v_mfma_f32_16x16x32_bf16 v[48:51], v[156:159], v[80:83], v[48:51]
    s_waitcnt vmcnt(15)
    s_waitcnt lgkmcnt(0)
    s_barrier
    v_mfma_f32_16x16x32_bf16 v[20:23], v[84:87], v[52:55], v[20:23]
    ds_read_b128 v[68:71], v19 offset:8192
    ds_read_b128 v[72:75], v19 offset:10240
    ds_read_b128 v[76:79], v19 offset:12288
    ds_read_b128 v[80:83], v19 offset:14336
    v_mfma_f32_16x16x32_bf16 v[24:27], v[88:91], v[52:55], v[24:27]
    v_mfma_f32_16x16x32_bf16 v[28:31], v[84:87], v[56:59], v[28:31]
    s_add_u32 s38, s34, 126976
    buffer_load_dwordx4 v[152:155], v5, s[24:27], s38 offen offset:0 sc0
    v_mfma_f32_16x16x32_bf16 v[32:35], v[88:91], v[56:59], v[32:35]
    v_mfma_f32_16x16x32_bf16 v[36:39], v[84:87], v[60:63], v[36:39]
    s_add_u32 s38, s34, 126976
    buffer_load_dwordx4 v[156:159], v5, s[24:27], s38 offen offset:1024 sc0
    v_mfma_f32_16x16x32_bf16 v[40:43], v[88:91], v[60:63], v[40:43]
    v_mfma_f32_16x16x32_bf16 v[44:47], v[84:87], v[64:67], v[44:47]
    v_mfma_f32_16x16x32_bf16 v[48:51], v[88:91], v[64:67], v[48:51]
    v_pk_add_f32 v[160:161], v[160:161], v[164:165]
    v_mul_f32 v160, s74, v160
    v_mul_f32 v161, s74, v161
    v_lshlrev_b32 v192, 16, v252
    v_and_b32 v193, 0xffff0000, v252
    v_mul_f32 v192, s73, v192
    v_mul_f32 v193, s73, v193
    v_cvt_pk_bf16_f32 v252, v192, v193
    v_cvt_pk_bf16_f32 v194, v160, v161
    v_lshlrev_b32 v192, 16, v252
    v_and_b32 v193, 0xffff0000, v252
    v_lshlrev_b32 v160, 16, v194
    v_and_b32 v161, 0xffff0000, v194
    v_pk_add_f32 v[192:193], v[192:193], v[160:161]
    v_cvt_pk_bf16_f32 v252, v192, v193
    v_pk_add_f32 v[162:163], v[162:163], v[166:167]
    v_mul_f32 v162, s74, v162
    v_mul_f32 v163, s74, v163
    v_lshlrev_b32 v196, 16, v253
    v_and_b32 v197, 0xffff0000, v253
    v_mul_f32 v196, s73, v196
    v_mul_f32 v197, s73, v197
    v_cvt_pk_bf16_f32 v253, v196, v197
    v_cvt_pk_bf16_f32 v198, v162, v163
    v_lshlrev_b32 v196, 16, v253
    v_and_b32 v197, 0xffff0000, v253
    v_lshlrev_b32 v162, 16, v198
    v_and_b32 v163, 0xffff0000, v198
    v_pk_add_f32 v[196:197], v[196:197], v[162:163]
    v_cvt_pk_bf16_f32 v253, v196, v197
    buffer_store_dwordx2 v[252:253], v2, s[68:71], 0 offen offset:0 sc1
    s_waitcnt vmcnt(14)
    s_waitcnt lgkmcnt(0)
    v_mfma_f32_16x16x32_bf16 v[20:23], v[92:95], v[68:71], v[20:23]
    ds_read_b128 v[52:55], v19 offset:16384
    ds_read_b128 v[56:59], v19 offset:18432
    ds_read_b128 v[60:63], v19 offset:20480
    ds_read_b128 v[64:67], v19 offset:22528
    v_mfma_f32_16x16x32_bf16 v[24:27], v[96:99], v[68:71], v[24:27]
    v_mfma_f32_16x16x32_bf16 v[28:31], v[92:95], v[72:75], v[28:31]
    v_mfma_f32_16x16x32_bf16 v[32:35], v[96:99], v[72:75], v[32:35]
    v_mfma_f32_16x16x32_bf16 v[36:39], v[92:95], v[76:79], v[36:39]
    v_mfma_f32_16x16x32_bf16 v[40:43], v[96:99], v[76:79], v[40:43]
    v_mfma_f32_16x16x32_bf16 v[44:47], v[92:95], v[80:83], v[44:47]
    v_mfma_f32_16x16x32_bf16 v[48:51], v[96:99], v[80:83], v[48:51]
    v_pk_add_f32 v[180:181], v[180:181], v[184:185]
    v_pk_add_f32 v[176:177], v[176:177], v[180:181]
    v_mul_f32 v176, s74, v176
    v_mul_f32 v177, s74, v177
    v_lshlrev_b32 v200, 16, v254
    v_and_b32 v201, 0xffff0000, v254
    v_mul_f32 v200, s73, v200
    v_mul_f32 v201, s73, v201
    v_cvt_pk_bf16_f32 v254, v200, v201
    v_cvt_pk_bf16_f32 v202, v176, v177
    v_lshlrev_b32 v200, 16, v254
    v_and_b32 v201, 0xffff0000, v254
    v_lshlrev_b32 v176, 16, v202
    v_and_b32 v177, 0xffff0000, v202
    v_pk_add_f32 v[200:201], v[200:201], v[176:177]
    v_cvt_pk_bf16_f32 v254, v200, v201
    v_pk_add_f32 v[182:183], v[182:183], v[186:187]
    v_pk_add_f32 v[178:179], v[178:179], v[182:183]
    v_mul_f32 v178, s74, v178
    v_mul_f32 v179, s74, v179
    v_lshlrev_b32 v204, 16, v255
    v_and_b32 v205, 0xffff0000, v255
    v_mul_f32 v204, s73, v204
    v_mul_f32 v205, s73, v205
    v_cvt_pk_bf16_f32 v255, v204, v205
    v_cvt_pk_bf16_f32 v206, v178, v179
    v_lshlrev_b32 v204, 16, v255
    v_and_b32 v205, 0xffff0000, v255
    v_lshlrev_b32 v178, 16, v206
    v_and_b32 v179, 0xffff0000, v206
    v_pk_add_f32 v[204:205], v[204:205], v[178:179]
    v_cvt_pk_bf16_f32 v255, v204, v205
    buffer_store_dwordx2 v[254:255], v2, s[68:71], 0 offen offset:512 sc1
    s_waitcnt vmcnt(13)
    s_waitcnt lgkmcnt(0)
    s_barrier
    v_mfma_f32_16x16x32_bf16 v[20:23], v[100:103], v[52:55], v[20:23]
    ds_read_b128 v[68:71], v19 offset:24576
    ds_read_b128 v[72:75], v19 offset:26624
    ds_read_b128 v[76:79], v19 offset:28672
    ds_read_b128 v[80:83], v19 offset:30720
    v_mfma_f32_16x16x32_bf16 v[24:27], v[104:107], v[52:55], v[24:27]
    v_mfma_f32_16x16x32_bf16 v[28:31], v[100:103], v[56:59], v[28:31]
    v_mfma_f32_16x16x32_bf16 v[32:35], v[104:107], v[56:59], v[32:35]
    v_mfma_f32_16x16x32_bf16 v[36:39], v[100:103], v[60:63], v[36:39]
    v_mfma_f32_16x16x32_bf16 v[40:43], v[104:107], v[60:63], v[40:43]
    v_mfma_f32_16x16x32_bf16 v[44:47], v[100:103], v[64:67], v[44:47]
    v_mfma_f32_16x16x32_bf16 v[48:51], v[104:107], v[64:67], v[48:51]
    s_waitcnt vmcnt(10)
    s_waitcnt lgkmcnt(0)
    v_mfma_f32_16x16x32_bf16 v[20:23], v[108:111], v[68:71], v[20:23]
    ds_read_b128 v[52:55], v19 offset:32768
    ds_read_b128 v[56:59], v19 offset:34816
    ds_read_b128 v[60:63], v19 offset:36864
    ds_read_b128 v[64:67], v19 offset:38912
    v_mfma_f32_16x16x32_bf16 v[24:27], v[112:115], v[68:71], v[24:27]
    v_mfma_f32_16x16x32_bf16 v[28:31], v[108:111], v[72:75], v[28:31]
    v_mfma_f32_16x16x32_bf16 v[32:35], v[112:115], v[72:75], v[32:35]
    v_mfma_f32_16x16x32_bf16 v[36:39], v[108:111], v[76:79], v[36:39]
    v_mfma_f32_16x16x32_bf16 v[40:43], v[112:115], v[76:79], v[40:43]
    v_mfma_f32_16x16x32_bf16 v[44:47], v[108:111], v[80:83], v[44:47]
    v_mfma_f32_16x16x32_bf16 v[48:51], v[112:115], v[80:83], v[48:51]
    s_waitcnt vmcnt(8)
    s_waitcnt lgkmcnt(0)
    s_barrier
    v_mfma_f32_16x16x32_bf16 v[20:23], v[116:119], v[52:55], v[20:23]
    ds_read_b128 v[68:71], v19 offset:40960
    ds_read_b128 v[72:75], v19 offset:43008
    ds_read_b128 v[76:79], v19 offset:45056
    ds_read_b128 v[80:83], v19 offset:47104
    v_mfma_f32_16x16x32_bf16 v[24:27], v[120:123], v[52:55], v[24:27]
    v_mfma_f32_16x16x32_bf16 v[28:31], v[116:119], v[56:59], v[28:31]
    s_add_u32 s38, s47, 0
    buffer_load_dwordx4 v[160:163], v5, s[24:27], s38 offen offset:0
    v_mfma_f32_16x16x32_bf16 v[32:35], v[120:123], v[56:59], v[32:35]
    v_mfma_f32_16x16x32_bf16 v[36:39], v[116:119], v[60:63], v[36:39]
    s_add_u32 s38, s47, 0
    buffer_load_dwordx4 v[176:179], v5, s[24:27], s38 offen offset:1024
    v_mfma_f32_16x16x32_bf16 v[40:43], v[120:123], v[60:63], v[40:43]
    v_mfma_f32_16x16x32_bf16 v[44:47], v[116:119], v[64:67], v[44:47]
    v_mfma_f32_16x16x32_bf16 v[48:51], v[120:123], v[64:67], v[48:51]
    s_waitcnt vmcnt(8)
    s_waitcnt lgkmcnt(0)
    v_mfma_f32_16x16x32_bf16 v[20:23], v[124:127], v[68:71], v[20:23]
    ds_read_b128 v[52:55], v19 offset:49152
    ds_read_b128 v[56:59], v19 offset:51200
    ds_read_b128 v[60:63], v19 offset:53248
    ds_read_b128 v[64:67], v19 offset:55296
    v_mfma_f32_16x16x32_bf16 v[24:27], v[128:131], v[68:71], v[24:27]
    v_mfma_f32_16x16x32_bf16 v[28:31], v[124:127], v[72:75], v[28:31]
    s_add_u32 s38, s47, 0
    buffer_load_dwordx4 v[192:195], v5, s[24:27], s38 offen offset:2048
    v_mfma_f32_16x16x32_bf16 v[32:35], v[128:131], v[72:75], v[32:35]
    v_mfma_f32_16x16x32_bf16 v[36:39], v[124:127], v[76:79], v[36:39]
    s_add_u32 s38, s47, 0
    buffer_load_dwordx4 v[208:211], v5, s[24:27], s38 offen offset:3072
    v_mfma_f32_16x16x32_bf16 v[40:43], v[128:131], v[76:79], v[40:43]
    v_mfma_f32_16x16x32_bf16 v[44:47], v[124:127], v[80:83], v[44:47]
    v_mfma_f32_16x16x32_bf16 v[48:51], v[128:131], v[80:83], v[48:51]
    s_waitcnt vmcnt(8)
    s_waitcnt lgkmcnt(0)
    s_barrier
    v_mfma_f32_16x16x32_bf16 v[20:23], v[144:147], v[52:55], v[20:23]
    ds_read_b128 v[68:71], v19 offset:57344
    ds_read_b128 v[72:75], v19 offset:59392
    ds_read_b128 v[76:79], v19 offset:61440
    ds_read_b128 v[80:83], v19 offset:63488
    v_mfma_f32_16x16x32_bf16 v[24:27], v[148:151], v[52:55], v[24:27]
    v_mfma_f32_16x16x32_bf16 v[28:31], v[144:147], v[56:59], v[28:31]
    s_add_u32 s38, s47, 28672
    buffer_load_dwordx4 v[164:167], v5, s[24:27], s38 offen offset:0
    v_mfma_f32_16x16x32_bf16 v[32:35], v[148:151], v[56:59], v[32:35]
    v_mfma_f32_16x16x32_bf16 v[36:39], v[144:147], v[60:63], v[36:39]
    s_add_u32 s38, s47, 28672
    buffer_load_dwordx4 v[180:183], v5, s[24:27], s38 offen offset:1024
    v_mfma_f32_16x16x32_bf16 v[40:43], v[148:151], v[60:63], v[40:43]
    v_mfma_f32_16x16x32_bf16 v[44:47], v[144:147], v[64:67], v[44:47]
    v_mfma_f32_16x16x32_bf16 v[48:51], v[148:151], v[64:67], v[48:51]
    s_waitcnt vmcnt(6)
    v_mov_b32 v6, s98
    v_mov_b32 v7, 1
    s_mov_b64 exec, 1
    buffer_store_dword v7, v6, s[24:27], 0 offen sc1
    s_mov_b64 exec, -1
    s_waitcnt lgkmcnt(0)
    v_mfma_f32_16x16x32_bf16 v[20:23], v[152:155], v[68:71], v[20:23]
    v_mfma_f32_16x16x32_bf16 v[24:27], v[156:159], v[68:71], v[24:27]
    v_mfma_f32_16x16x32_bf16 v[28:31], v[152:155], v[72:75], v[28:31]
    s_add_u32 s38, s47, 28672
    buffer_load_dwordx4 v[196:199], v5, s[24:27], s38 offen offset:2048
    v_mfma_f32_16x16x32_bf16 v[32:35], v[156:159], v[72:75], v[32:35]
    v_mfma_f32_16x16x32_bf16 v[36:39], v[152:155], v[76:79], v[36:39]
    s_add_u32 s38, s47, 28672
    buffer_load_dwordx4 v[212:215], v5, s[24:27], s38 offen offset:3072
    v_mfma_f32_16x16x32_bf16 v[40:43], v[156:159], v[76:79], v[40:43]
    v_mfma_f32_16x16x32_bf16 v[44:47], v[152:155], v[80:83], v[44:47]
    v_mfma_f32_16x16x32_bf16 v[48:51], v[156:159], v[80:83], v[48:51]
    s_branch gf_kernel_cd
gf_kernel_c1:
    v_and_b32 v10, 1, v3
    v_mul_u32_u24 v10, 642, v10
    v_lshlrev_b32 v14, 3, v4
    v_sub_u32 v14, v14, v3
    v_lshl_add_u32 v10, v14, 1, v10
    v_add_u32 v10, 4640, v10
    v_add_u32 v10, s66, v10
    ds_read2_b32 v[160:161], v10 offset0:128 offset1:129
    ds_read2_b32 v[162:163], v10 offset0:130 offset1:131
    ds_read2_b32 v[164:165], v10 offset0:112 offset1:113
    ds_read2_b32 v[166:167], v10 offset0:114 offset1:115
    ds_read2_b32 v[168:169], v10 offset0:96 offset1:97
    ds_read2_b32 v[170:171], v10 offset0:98 offset1:99
    ds_read2_b32 v[172:173], v10 offset0:80 offset1:81
    ds_read2_b32 v[174:175], v10 offset0:82 offset1:83
    ds_read2_b32 v[176:177], v10 offset0:64 offset1:65
    ds_read2_b32 v[178:179], v10 offset0:66 offset1:67
    ds_read2_b32 v[180:181], v10 offset0:48 offset1:49
    ds_read2_b32 v[182:183], v10 offset0:50 offset1:51
    ds_read2_b32 v[184:185], v10 offset0:32 offset1:33
    ds_read2_b32 v[186:187], v10 offset0:34 offset1:35
    ds_read2_b32 v[188:189], v10 offset0:16 offset1:17
    ds_read2_b32 v[190:191], v10 offset0:18 offset1:19
    ds_read2_b32 v[192:193], v10 offset0:0 offset1:1
    ds_read2_b32 v[194:195], v10 offset0:2 offset1:3
    ds_read2_b32 v[200:201], v11 offset0:64 offset1:65
    ds_read2_b32 v[202:203], v11 offset0:66 offset1:67
    ds_read2_b32 v[204:205], v11 offset0:48 offset1:49
    ds_read2_b32 v[206:207], v11 offset0:50 offset1:51
    ds_read2_b32 v[208:209], v11 offset0:32 offset1:33
    ds_read2_b32 v[210:211], v11 offset0:34 offset1:35
    ds_read2_b32 v[212:213], v11 offset0:16 offset1:17
    ds_read2_b32 v[214:215], v11 offset0:18 offset1:19
    ds_read2_b32 v[216:217], v11 offset0:0 offset1:1
    ds_read2_b32 v[218:219], v11 offset0:2 offset1:3
    v_mov_b32 v10, s46
    v_cvt_pk_f16_f32 v10, v10, v10
    v_sub_u32 v14, 5, v14
    v_and_b32 v15, 0xffff, v10
    v_and_b32 v20, 0xffff0000, v10
    v_cmp_eq_u32 s[80:81], 0, v14
    v_cmp_eq_u32 s[82:83], 1, v14
    v_cmp_eq_u32 s[84:85], 2, v14
    v_cmp_eq_u32 s[86:87], 3, v14
    v_cmp_eq_u32 s[88:89], 4, v14
    v_cmp_eq_u32 s[90:91], 5, v14
    v_cmp_eq_u32 s[92:93], 6, v14
    v_cmp_eq_u32 s[94:95], 7, v14
    v_cndmask_b32 v196, 0, v15, s[80:81]
    v_cndmask_b32 v197, 0, v15, s[84:85]
    v_cndmask_b32 v198, 0, v15, s[88:89]
    v_cndmask_b32 v199, 0, v15, s[92:93]
    v_cndmask_b32 v196, v196, v20, s[82:83]
    v_cndmask_b32 v197, v197, v20, s[86:87]
    v_cndmask_b32 v198, v198, v20, s[90:91]
    v_cndmask_b32 v199, v199, v20, s[94:95]
    v_lshlrev_b32 v10, 5, v3
    v_lshl_add_u32 v10, v4, 4, v10
    v_add_u32 v10, s66, v10
    s_waitcnt vmcnt(3)
    v_cmp_eq_u32 vcc, 0, v0
    s_and_b32 s38, vcc_lo, 0xffff
    s_cbranch_scc1 pb_13
    s_add_u32 s38, s34, 0
    buffer_load_dwordx4 v[84:87], v5, s[24:27], s38 offen offset:0 sc0
    s_add_u32 s38, s34, 0
    buffer_load_dwordx4 v[88:91], v5, s[24:27], s38 offen offset:1024 sc0
    s_add_u32 s38, s34, 4096
    buffer_load_dwordx4 v[92:95], v5, s[24:27], s38 offen offset:0 sc0
    s_add_u32 s38, s34, 4096
    buffer_load_dwordx4 v[96:99], v5, s[24:27], s38 offen offset:1024 sc0
    s_waitcnt lgkmcnt(0)
    ds_read_b128 v[20:23], v10 offset:2528
    ds_read_b128 v[24:27], v10 offset:2464
    ds_read_b128 v[28:31], v10 offset:2400
    ds_read_b128 v[32:35], v10 offset:2336
    ds_read_b128 v[36:39], v10 offset:2272
    ds_read_b128 v[40:43], v10 offset:2208
    ds_read_b128 v[44:47], v10 offset:2144
    ds_read_b128 v[48:51], v10 offset:2080
    ds_read_b128 v[52:55], v10 offset:2016
    ds_read_b128 v[56:59], v10 offset:512
    s_add_u32 s38, s34, 8192
    buffer_load_dwordx4 v[100:103], v5, s[24:27], s38 offen offset:0 sc0
    s_add_u32 s38, s34, 8192
    buffer_load_dwordx4 v[104:107], v5, s[24:27], s38 offen offset:1024 sc0
    s_waitcnt lgkmcnt(9)
    v_mfma_f32_16x16x32_f16 v[220:223], v[160:163], v[20:23], 0
    s_add_u32 s38, s34, 12288
    buffer_load_dwordx4 v[108:111], v5, s[24:27], s38 offen offset:0 sc0
    s_waitcnt lgkmcnt(8)
    v_mfma_f32_16x16x32_f16 v[220:223], v[164:167], v[24:27], v[220:223]
    s_add_u32 s38, s34, 12288
    buffer_load_dwordx4 v[112:115], v5, s[24:27], s38 offen offset:1024 sc0
    s_waitcnt lgkmcnt(7)
    v_mfma_f32_16x16x32_f16 v[220:223], v[168:171], v[28:31], v[220:223]
    s_add_u32 s38, s34, 16384
    buffer_load_dwordx4 v[116:119], v5, s[24:27], s38 offen offset:0 sc0
    s_waitcnt lgkmcnt(6)
    v_mfma_f32_16x16x32_f16 v[220:223], v[172:175], v[32:35], v[220:223]
    s_add_u32 s38, s34, 16384
    buffer_load_dwordx4 v[120:123], v5, s[24:27], s38 offen offset:1024 sc0
    s_waitcnt lgkmcnt(5)
    v_mfma_f32_16x16x32_f16 v[220:223], v[176:179], v[36:39], v[220:223]
    s_add_u32 s38, s34, 20480
    buffer_load_dwordx4 v[124:127], v5, s[24:27], s38 offen offset:0 sc0
    s_waitcnt lgkmcnt(4)
    v_mfma_f32_16x16x32_f16 v[220:223], v[180:183], v[40:43], v[220:223]
    s_add_u32 s38, s34, 20480
    buffer_load_dwordx4 v[128:131], v5, s[24:27], s38 offen offset:1024 sc0
    s_waitcnt lgkmcnt(3)
    v_mfma_f32_16x16x32_f16 v[220:223], v[184:187], v[44:47], v[220:223]
    s_add_u32 s38, s34, 24576
    buffer_load_dwordx4 v[144:147], v5, s[24:27], s38 offen offset:0 sc0
    s_waitcnt lgkmcnt(2)
    v_mfma_f32_16x16x32_f16 v[220:223], v[188:191], v[48:51], v[220:223]
    s_add_u32 s38, s34, 24576
    buffer_load_dwordx4 v[148:151], v5, s[24:27], s38 offen offset:1024 sc0
    s_waitcnt lgkmcnt(1)
    v_mfma_f32_16x16x32_f16 v[220:223], v[192:195], v[52:55], v[220:223]
    s_add_u32 s38, s34, 28672
    buffer_load_dwordx4 v[152:155], v5, s[24:27], s38 offen offset:0 sc0
    s_waitcnt lgkmcnt(0)
    v_mfma_f32_16x16x32_f16 v[220:223], v[196:199], v[56:59], v[220:223]
    s_add_u32 s38, s34, 28672
    buffer_load_dwordx4 v[156:159], v5, s[24:27], s38 offen offset:1024 sc0
    s_branch pj_14
pb_13:
    s_waitcnt lgkmcnt(0)
    ds_read_b128 v[20:23], v10 offset:2528
    ds_read_b128 v[24:27], v10 offset:2464
    ds_read_b128 v[28:31], v10 offset:2400
    ds_read_b128 v[32:35], v10 offset:2336
    ds_read_b128 v[36:39], v10 offset:2272
    ds_read_b128 v[40:43], v10 offset:2208
    ds_read_b128 v[44:47], v10 offset:2144
    ds_read_b128 v[48:51], v10 offset:2080
    ds_read_b128 v[52:55], v10 offset:2016
    ds_read_b128 v[56:59], v10 offset:512
    s_waitcnt lgkmcnt(9)
    v_mfma_f32_16x16x32_f16 v[220:223], v[160:163], v[20:23], 0
    s_waitcnt lgkmcnt(8)
    v_mfma_f32_16x16x32_f16 v[220:223], v[164:167], v[24:27], v[220:223]
    s_waitcnt lgkmcnt(7)
    v_mfma_f32_16x16x32_f16 v[220:223], v[168:171], v[28:31], v[220:223]
    s_waitcnt lgkmcnt(6)
    v_mfma_f32_16x16x32_f16 v[220:223], v[172:175], v[32:35], v[220:223]
    s_waitcnt lgkmcnt(5)
    v_mfma_f32_16x16x32_f16 v[220:223], v[176:179], v[36:39], v[220:223]
    s_waitcnt lgkmcnt(4)
    v_mfma_f32_16x16x32_f16 v[220:223], v[180:183], v[40:43], v[220:223]
    s_waitcnt lgkmcnt(3)
    v_mfma_f32_16x16x32_f16 v[220:223], v[184:187], v[44:47], v[220:223]
    s_waitcnt lgkmcnt(2)
    v_mfma_f32_16x16x32_f16 v[220:223], v[188:191], v[48:51], v[220:223]
    s_waitcnt lgkmcnt(1)
    v_mfma_f32_16x16x32_f16 v[220:223], v[192:195], v[52:55], v[220:223]
    s_waitcnt vmcnt(0)
    v_cmp_eq_u32 vcc, 0, v134
    s_and_b32 s38, vcc_lo, 0xffff
    s_cbranch_scc0 ef_15
    s_lshl_b32 s38, s30, 2
    s_sub_u32 s38, s97, s38
    v_mul_u32_u24 v6, 4, v1
    s_mov_b32 s42, 0
    s_mov_b32 exec_hi, 0
    s_mov_b32 exec_lo, 0xffff
pf_16:
    buffer_load_dword v7, v6, s[24:27], s38 offen sc1
    s_waitcnt vmcnt(0)
    v_cmp_eq_u32 vcc, 0, v7
    s_add_u32 s42, s42, 1
    s_cmp_gt_u32 s42, 30000
    s_cbranch_scc1 pfd_17
    s_cmp_eq_u64 vcc, 0
    s_cbranch_scc1 pfd_17
    s_sleep 6
    s_branch pf_16
pfd_17:
    s_mov_b64 exec, -1
ef_15:
    s_waitcnt lgkmcnt(0)
    v_mfma_f32_16x16x32_f16 v[220:223], v[196:199], v[56:59], v[220:223]
    s_add_u32 s38, s34, 0
    buffer_load_dwordx4 v[84:87], v5, s[24:27], s38 offen offset:0 sc0
    s_add_u32 s38, s34, 0
    buffer_load_dwordx4 v[88:91], v5, s[24:27], s38 offen offset:1024 sc0
    s_add_u32 s38, s34, 4096
    buffer_load_dwordx4 v[92:95], v5, s[24:27], s38 offen offset:0 sc0
    s_add_u32 s38, s34, 4096
    buffer_load_dwordx4 v[96:99], v5, s[24:27], s38 offen offset:1024 sc0
    s_add_u32 s38, s34, 8192
    buffer_load_dwordx4 v[100:103], v5, s[24:27], s38 offen offset:0 sc0
    s_add_u32 s38, s34, 8192
    buffer_load_dwordx4 v[104:107], v5, s[24:27], s38 offen offset:1024 sc0
    s_add_u32 s38, s34, 12288
    buffer_load_dwordx4 v[108:111], v5, s[24:27], s38 offen offset:0 sc0
    s_add_u32 s38, s34, 12288
    buffer_load_dwordx4 v[112:115], v5, s[24:27], s38 offen offset:1024 sc0
    s_add_u32 s38, s34, 16384
    buffer_load_dwordx4 v[116:119], v5, s[24:27], s38 offen offset:0 sc0
    s_add_u32 s38, s34, 16384
    buffer_load_dwordx4 v[120:123], v5, s[24:27], s38 offen offset:1024 sc0
    s_add_u32 s38, s34, 20480
    buffer_load_dwordx4 v[124:127], v5, s[24:27], s38 offen offset:0 sc0
    s_add_u32 s38, s34, 20480
    buffer_load_dwordx4 v[128:131], v5, s[24:27], s38 offen offset:1024 sc0
    s_add_u32 s38, s34, 24576
    buffer_load_dwordx4 v[144:147], v5, s[24:27], s38 offen offset:0 sc0
    s_add_u32 s38, s34, 24576
    buffer_load_dwordx4 v[148:151], v5, s[24:27], s38 offen offset:1024 sc0
    s_add_u32 s38, s34, 28672
    buffer_load_dwordx4 v[152:155], v5, s[24:27], s38 offen offset:0 sc0
    s_add_u32 s38, s34, 28672
    buffer_load_dwordx4 v[156:159], v5, s[24:27], s38 offen offset:1024 sc0
pj_14:
    s_barrier
    ds_read_b128 v[52:55], v19 offset:0
    ds_read_b128 v[56:59], v19 offset:2048
    ds_read_b128 v[60:63], v19 offset:4096
    ds_read_b128 v[64:67], v19 offset:6144
    ds_read_b128 v[236:239], v13 offset:8256
    ds_read_b128 v[240:243], v13 offset:8192
    v_mov_b32 v15, 0xbdd2d3e8
    s_waitcnt vmcnt(14)
    s_waitcnt lgkmcnt(0)
    s_barrier
    v_mfma_f32_16x16x32_bf16 v[20:23], v[84:87], v[52:55], 0
    ds_read_b128 v[68:71], v19 offset:8192
    ds_read_b128 v[72:75], v19 offset:10240
    ds_read_b128 v[76:79], v19 offset:12288
    ds_read_b128 v[80:83], v19 offset:14336
    ds_read_b128 v[244:247], v10 offset:3040
    ds_read_b128 v[248:251], v10 offset:2976
    v_mfma_f32_16x16x32_bf16 v[24:27], v[88:91], v[52:55], 0
    v_mfma_f32_16x16x32_bf16 v[28:31], v[84:87], v[56:59], 0
    s_add_u32 m0, s75, 0
    s_add_u32 s39, s67, 1536
    buffer_load_dwordx4 v18, s[20:23], s39 offen lds
    v_mfma_f32_16x16x32_bf16 v[32:35], v[88:91], v[56:59], 0
    v_mfma_f32_16x16x32_bf16 v[36:39], v[84:87], v[60:63], 0
    v_mfma_f32_16x16x32_bf16 v[40:43], v[88:91], v[60:63], 0
    v_mfma_f32_16x16x32_bf16 v[44:47], v[84:87], v[64:67], 0
    v_mfma_f32_16x16x32_bf16 v[48:51], v[88:91], v[64:67], 0
    v_mfma_f32_16x16x32_f16 v[220:223], v[236:239], v[200:203], v[220:223]
    v_mfma_f32_16x16x32_f16 v[220:223], v[240:243], v[204:207], v[220:223]
    s_waitcnt vmcnt(13)
    s_waitcnt lgkmcnt(0)
    v_mfma_f32_16x16x32_bf16 v[20:23], v[92:95], v[68:71], v[20:23]
    ds_read_b128 v[52:55], v19 offset:16384
    ds_read_b128 v[56:59], v19 offset:18432
    ds_read_b128 v[60:63], v19 offset:20480
    ds_read_b128 v[64:67], v19 offset:22528
    ds_read_b128 v[236:239], v10 offset:2912
    ds_read_b128 v[240:243], v10 offset:2848
    v_mfma_f32_16x16x32_bf16 v[24:27], v[96:99], v[68:71], v[24:27]
    v_mfma_f32_16x16x32_bf16 v[28:31], v[92:95], v[72:75], v[28:31]
    s_add_u32 s38, s34, 32768
    buffer_load_dwordx4 v[84:87], v5, s[24:27], s38 offen offset:0 sc0
    v_mfma_f32_16x16x32_bf16 v[32:35], v[96:99], v[72:75], v[32:35]
    v_mfma_f32_16x16x32_bf16 v[36:39], v[92:95], v[76:79], v[36:39]
    s_add_u32 s38, s34, 32768
    buffer_load_dwordx4 v[88:91], v5, s[24:27], s38 offen offset:1024 sc0
    v_mfma_f32_16x16x32_bf16 v[40:43], v[96:99], v[76:79], v[40:43]
    v_mfma_f32_16x16x32_bf16 v[44:47], v[92:95], v[80:83], v[44:47]
    v_mfma_f32_16x16x32_bf16 v[48:51], v[96:99], v[80:83], v[48:51]
    v_mfma_f32_16x16x32_f16 v[224:227], v[160:163], v[244:247], 0
    v_mfma_f32_16x16x32_f16 v[224:227], v[164:167], v[248:251], v[224:227]
    s_waitcnt vmcnt(13)
    s_waitcnt lgkmcnt(0)
    s_barrier
    v_mfma_f32_16x16x32_bf16 v[20:23], v[100:103], v[52:55], v[20:23]
    ds_read_b128 v[68:71], v19 offset:24576
    ds_read_b128 v[72:75], v19 offset:26624
    ds_read_b128 v[76:79], v19 offset:28672
    ds_read_b128 v[80:83], v19 offset:30720
    ds_read_b128 v[244:247], v10 offset:2784
    ds_read_b128 v[248:251], v10 offset:2720
    v_mfma_f32_16x16x32_bf16 v[24:27], v[104:107], v[52:55], v[24:27]
    v_mfma_f32_16x16x32_bf16 v[28:31], v[100:103], v[56:59], v[28:31]
    s_add_u32 m0, s75, 8192
    s_add_u32 s39, s67, 1664
    buffer_load_dwordx4 v18, s[20:23], s39 offen lds
    v_mfma_f32_16x16x32_bf16 v[32:35], v[104:107], v[56:59], v[32:35]
    v_mfma_f32_16x16x32_bf16 v[36:39], v[100:103], v[60:63], v[36:39]
    s_add_u32 m0, s75, 16384
    s_add_u32 s39, s67, 1792
    buffer_load_dwordx4 v18, s[20:23], s39 offen lds
    v_mfma_f32_16x16x32_bf16 v[40:43], v[104:107], v[60:63], v[40:43]
    v_mfma_f32_16x16x32_bf16 v[44:47], v[100:103], v[64:67], v[44:47]
    s_add_u32 s38, s34, 36864
    buffer_load_dwordx4 v[92:95], v5, s[24:27], s38 offen offset:0 sc0
    v_mfma_f32_16x16x32_bf16 v[48:51], v[104:107], v[64:67], v[48:51]
    v_mfma_f32_16x16x32_f16 v[224:227], v[168:171], v[236:239], v[224:227]
    s_add_u32 s38, s34, 36864
    buffer_load_dwordx4 v[96:99], v5, s[24:27], s38 offen offset:1024 sc0
    v_mfma_f32_16x16x32_f16 v[224:227], v[172:175], v[240:243], v[224:227]
    v_lshlrev_b32 v6, 16, v136
    v_and_b32 v7, 0xffff0000, v136
    v_mul_f32 v132, v6, v6
    v_mul_f32 v133, v7, v7
    v_fmaak_f32 v132, v132, v15, 0xc0135761
    v_fmaak_f32 v133, v133, v15, 0xc0135761
    v_mul_f32 v132, v132, v6
    v_mul_f32 v133, v133, v7
    v_exp_f32 v132, v132
    v_exp_f32 v133, v133
    v_add_f32 v132, 1.0, v132
    v_add_f32 v133, 1.0, v133
    v_rcp_f32 v132, v132
    v_rcp_f32 v133, v133
    s_nop 0
    v_mul_f32 v6, v6, v132
    v_mul_f32 v7, v7, v133
    v_cvt_pk_bf16_f32 v136, v6, v7
    s_waitcnt vmcnt(15)
    s_waitcnt lgkmcnt(0)
    v_mfma_f32_16x16x32_bf16 v[20:23], v[108:111], v[68:71], v[20:23]
    ds_read_b128 v[52:55], v19 offset:32768
    ds_read_b128 v[56:59], v19 offset:34816
    ds_read_b128 v[60:63], v19 offset:36864
    ds_read_b128 v[64:67], v19 offset:38912
    ds_read_b128 v[236:239], v10 offset:2656
    ds_read_b128 v[240:243], v10 offset:2592
    v_mfma_f32_16x16x32_bf16 v[24:27], v[112:115], v[68:71], v[24:27]
    v_mfma_f32_16x16x32_bf16 v[28:31], v[108:111], v[72:75], v[28:31]
    s_add_u32 s38, s34, 40960
    buffer_load_dwordx4 v[100:103], v5, s[24:27], s38 offen offset:0 sc0
    v_mfma_f32_16x16x32_bf16 v[32:35], v[112:115], v[72:75], v[32:35]
    v_mfma_f32_16x16x32_bf16 v[36:39], v[108:111], v[76:79], v[36:39]
    s_add_u32 s38, s34, 40960
    buffer_load_dwordx4 v[104:107], v5, s[24:27], s38 offen offset:1024 sc0
    v_mfma_f32_16x16x32_bf16 v[40:43], v[112:115], v[76:79], v[40:43]
    v_mfma_f32_16x16x32_bf16 v[44:47], v[108:111], v[80:83], v[44:47]
    s_lshl_b32 s38, s30, 2
    s_sub_u32 s38, s97, s38
    v_min_u32 v6, 59, v1
    v_lshlrev_b32 v6, 2, v6
    v_add_u32 v6, 18119552, v6
    v_or_b32 v7, 16, v1
    v_lshlrev_b32 v7, 2, v7
    v_add_u32 v7, s38, v7
    v_cmp_gt_u32 vcc, 32, v1
    v_cndmask_b32 v6, v6, v7, vcc
    buffer_load_dword v0, v6, s[24:27], 0 offen sc1
    v_mfma_f32_16x16x32_bf16 v[48:51], v[112:115], v[80:83], v[48:51]
    v_mfma_f32_16x16x32_f16 v[224:227], v[176:179], v[244:247], v[224:227]
    v_mfma_f32_16x16x32_f16 v[224:227], v[180:183], v[248:251], v[224:227]
    s_waitcnt vmcnt(16)
    s_waitcnt lgkmcnt(0)
    s_barrier
    v_mfma_f32_16x16x32_bf16 v[20:23], v[116:119], v[52:55], v[20:23]
    ds_read_b128 v[68:71], v19 offset:40960
    ds_read_b128 v[72:75], v19 offset:43008
    ds_read_b128 v[76:79], v19 offset:45056
    ds_read_b128 v[80:83], v19 offset:47104
    ds_read_b128 v[244:247], v10 offset:2528
    ds_read_b128 v[248:251], v10 offset:1024
    v_mfma_f32_16x16x32_bf16 v[24:27], v[120:123], v[52:55], v[24:27]
    v_mfma_f32_16x16x32_bf16 v[28:31], v[116:119], v[56:59], v[28:31]
    s_add_u32 m0, s75, 24576
    s_add_u32 s39, s67, 1920
    buffer_load_dwordx4 v18, s[20:23], s39 offen lds
    v_mfma_f32_16x16x32_bf16 v[32:35], v[120:123], v[56:59], v[32:35]
    v_mfma_f32_16x16x32_bf16 v[36:39], v[116:119], v[60:63], v[36:39]
    s_add_u32 m0, s75, 32768
    s_add_u32 s39, s67, 2048
    buffer_load_dwordx4 v18, s[20:23], s39 offen lds
    v_mfma_f32_16x16x32_bf16 v[40:43], v[120:123], v[60:63], v[40:43]
    v_mfma_f32_16x16x32_bf16 v[44:47], v[116:119], v[64:67], v[44:47]
    s_add_u32 s38, s34, 45056
    buffer_load_dwordx4 v[108:111], v5, s[24:27], s38 offen offset:0 sc0
    v_mfma_f32_16x16x32_bf16 v[48:51], v[120:123], v[64:67], v[48:51]
    v_mfma_f32_16x16x32_f16 v[224:227], v[184:187], v[236:239], v[224:227]
    s_add_u32 s38, s34, 45056
    buffer_load_dwordx4 v[112:115], v5, s[24:27], s38 offen offset:1024 sc0
    v_mfma_f32_16x16x32_f16 v[224:227], v[188:191], v[240:243], v[224:227]
    v_lshlrev_b32 v6, 16, v137
    v_and_b32 v7, 0xffff0000, v137
    v_mul_f32 v132, v6, v6
    v_mul_f32 v133, v7, v7
    v_fmaak_f32 v132, v132, v15, 0xc0135761
    v_fmaak_f32 v133, v133, v15, 0xc0135761
    v_mul_f32 v132, v132, v6
    v_mul_f32 v133, v133, v7
    v_exp_f32 v132, v132
    v_exp_f32 v133, v133
    v_add_f32 v132, 1.0, v132
    v_add_f32 v133, 1.0, v133
    v_rcp_f32 v132, v132
    v_rcp_f32 v133, v133
    s_nop 0
    v_mul_f32 v6, v6, v132
    v_mul_f32 v7, v7, v133
    v_cvt_pk_bf16_f32 v137, v6, v7
    s_waitcnt vmcnt(18)
    s_waitcnt lgkmcnt(0)
    v_mfma_f32_16x16x32_bf16 v[20:23], v[124:127], v[68:71], v[20:23]
    ds_read_b128 v[52:55], v19 offset:49152
    ds_read_b128 v[56:59], v19 offset:51200
    ds_read_b128 v[60:63], v19 offset:53248
    ds_read_b128 v[64:67], v19 offset:55296
    ds_read_b128 v[236:239], v13 offset:8320
    ds_read_b128 v[240:243], v13 offset:8256
    v_mfma_f32_16x16x32_bf16 v[24:27], v[128:131], v[68:71], v[24:27]
    v_mfma_f32_16x16x32_bf16 v[28:31], v[124:127], v[72:75], v[28:31]
    s_add_u32 s38, s34, 49152
    buffer_load_dwordx4 v[116:119], v5, s[24:27], s38 offen offset:0 sc0
    v_mfma_f32_16x16x32_bf16 v[32:35], v[128:131], v[72:75], v[32:35]
    v_mfma_f32_16x16x32_bf16 v[36:39], v[124:127], v[76:79], v[36:39]
    s_add_u32 s38, s34, 49152
    buffer_load_dwordx4 v[120:123], v5, s[24:27], s38 offen offset:1024 sc0
    v_mfma_f32_16x16x32_bf16 v[40:43], v[128:131], v[76:79], v[40:43]
    v_mfma_f32_16x16x32_bf16 v[44:47], v[124:127], v[80:83], v[44:47]
    v_mfma_f32_16x16x32_bf16 v[48:51], v[128:131], v[80:83], v[48:51]
    v_mfma_f32_16x16x32_f16 v[224:227], v[192:195], v[244:247], v[224:227]
    v_mfma_f32_16x16x32_f16 v[224:227], v[196:199], v[248:251], v[224:227]
    s_waitcnt vmcnt(18)
    s_waitcnt lgkmcnt(0)
    s_barrier
    v_mfma_f32_16x16x32_bf16 v[20:23], v[144:147], v[52:55], v[20:23]
    ds_read_b128 v[68:71], v19 offset:57344
    ds_read_b128 v[72:75], v19 offset:59392
    ds_read_b128 v[76:79], v19 offset:61440
    ds_read_b128 v[80:83], v19 offset:63488
    ds_read_b128 v[244:247], v13 offset:8192
    ds_read_b128 v[248:251], v10 offset:3552
    v_mfma_f32_16x16x32_bf16 v[24:27], v[148:151], v[52:55], v[24:27]
    v_mfma_f32_16x16x32_bf16 v[28:31], v[144:147], v[56:59], v[28:31]
    s_add_u32 m0, s75, 40960
    s_add_u32 s39, s67, 2176
    buffer_load_dwordx4 v18, s[20:23], s39 offen lds
    v_mfma_f32_16x16x32_bf16 v[32:35], v[148:151], v[56:59], v[32:35]
    v_mfma_f32_16x16x32_bf16 v[36:39], v[144:147], v[60:63], v[36:39]
    s_add_u32 m0, s75, 49152
    s_add_u32 s39, s67, 2304
    buffer_load_dwordx4 v18, s[20:23], s39 offen lds
    v_mfma_f32_16x16x32_bf16 v[40:43], v[148:151], v[60:63], v[40:43]
    v_mfma_f32_16x16x32_bf16 v[44:47], v[144:147], v[64:67], v[44:47]
    s_add_u32 s38, s34, 53248
    buffer_load_dwordx4 v[124:127], v5, s[24:27], s38 offen offset:0 sc0
    v_mfma_f32_16x16x32_bf16 v[48:51], v[148:151], v[64:67], v[48:51]
    v_mfma_f32_16x16x32_f16 v[224:227], v[236:239], v[200:203], v[224:227]
    s_add_u32 s38, s34, 53248
    buffer_load_dwordx4 v[128:131], v5, s[24:27], s38 offen offset:1024 sc0
    v_mfma_f32_16x16x32_f16 v[224:227], v[240:243], v[204:207], v[224:227]
    v_lshlrev_b32 v6, 16, v138
    v_and_b32 v7, 0xffff0000, v138
    v_mul_f32 v132, v6, v6
    v_mul_f32 v133, v7, v7
    v_fmaak_f32 v132, v132, v15, 0xc0135761
    v_fmaak_f32 v133, v133, v15, 0xc0135761
    v_mul_f32 v132, v132, v6
    v_mul_f32 v133, v133, v7
    v_exp_f32 v132, v132
    v_exp_f32 v133, v133
    v_add_f32 v132, 1.0, v132
    v_add_f32 v133, 1.0, v133
    v_rcp_f32 v132, v132
    v_rcp_f32 v133, v133
    s_nop 0
    v_mul_f32 v6, v6, v132
    v_mul_f32 v7, v7, v133
    v_cvt_pk_bf16_f32 v138, v6, v7
    s_waitcnt vmcnt(20)
    s_waitcnt lgkmcnt(0)
    v_mfma_f32_16x16x32_bf16 v[20:23], v[152:155], v[68:71], v[20:23]
    ds_read_b128 v[52:55], v135 offset:0
    ds_read_b128 v[56:59], v135 offset:2048
    ds_read_b128 v[60:63], v135 offset:4096
    ds_read_b128 v[64:67], v135 offset:6144
    ds_read_b128 v[236:239], v10 offset:3488
    ds_read_b128 v[240:243], v10 offset:3424
    v_mfma_f32_16x16x32_bf16 v[24:27], v[156:159], v[68:71], v[24:27]
    v_mfma_f32_16x16x32_bf16 v[28:31], v[152:155], v[72:75], v[28:31]
    s_add_u32 s38, s34, 57344
    buffer_load_dwordx4 v[144:147], v5, s[24:27], s38 offen offset:0 sc0
    v_mfma_f32_16x16x32_bf16 v[32:35], v[156:159], v[72:75], v[32:35]
    v_mfma_f32_16x16x32_bf16 v[36:39], v[152:155], v[76:79], v[36:39]
    s_add_u32 s38, s34, 57344
    buffer_load_dwordx4 v[148:151], v5, s[24:27], s38 offen offset:1024 sc0
    v_mfma_f32_16x16x32_bf16 v[40:43], v[156:159], v[76:79], v[40:43]
    v_mfma_f32_16x16x32_bf16 v[44:47], v[152:155], v[80:83], v[44:47]
    v_mfma_f32_16x16x32_bf16 v[48:51], v[156:159], v[80:83], v[48:51]
    v_mfma_f32_16x16x32_f16 v[224:227], v[244:247], v[208:211], v[224:227]
    v_mfma_f32_16x16x32_f16 v[228:231], v[160:163], v[248:251], 0
    s_waitcnt vmcnt(19)
    s_waitcnt lgkmcnt(0)
    s_barrier
    v_mfma_f32_16x16x32_bf16 v[20:23], v[84:87], v[52:55], v[20:23]
    ds_read_b128 v[68:71], v135 offset:8192
    ds_read_b128 v[72:75], v135 offset:10240
    ds_read_b128 v[76:79], v135 offset:12288
    ds_read_b128 v[80:83], v135 offset:14336
    ds_read_b128 v[244:247], v10 offset:3360
    ds_read_b128 v[248:251], v10 offset:3296
    v_mfma_f32_16x16x32_bf16 v[24:27], v[88:91], v[52:55], v[24:27]
    v_mfma_f32_16x16x32_bf16 v[28:31], v[84:87], v[56:59], v[28:31]
    s_add_u32 m0, s75, 57344
    s_add_u32 s39, s67, 2432
    buffer_load_dwordx4 v18, s[20:23], s39 offen lds
    v_mfma_f32_16x16x32_bf16 v[32:35], v[88:91], v[56:59], v[32:35]
    v_mfma_f32_16x16x32_bf16 v[36:39], v[84:87], v[60:63], v[36:39]
    s_add_u32 m0, s75, 65536
    s_add_u32 s39, s67, 2560
    buffer_load_dwordx4 v18, s[20:23], s39 offen lds
    v_mfma_f32_16x16x32_bf16 v[40:43], v[88:91], v[60:63], v[40:43]
    v_mfma_f32_16x16x32_bf16 v[44:47], v[84:87], v[64:67], v[44:47]
    s_add_u32 s38, s34, 61440
    buffer_load_dwordx4 v[152:155], v5, s[24:27], s38 offen offset:0 sc0
    v_mfma_f32_16x16x32_bf16 v[48:51], v[88:91], v[64:67], v[48:51]
    v_mfma_f32_16x16x32_f16 v[228:231], v[164:167], v[236:239], v[228:231]
    s_add_u32 s38, s34, 61440
    buffer_load_dwordx4 v[156:159], v5, s[24:27], s38 offen offset:1024 sc0
    v_mfma_f32_16x16x32_f16 v[228:231], v[168:171], v[240:243], v[228:231]
    v_lshlrev_b32 v6, 16, v139
    v_and_b32 v7, 0xffff0000, v139
    v_mul_f32 v132, v6, v6
    v_mul_f32 v133, v7, v7
    v_fmaak_f32 v132, v132, v15, 0xc0135761
    v_fmaak_f32 v133, v133, v15, 0xc0135761
    v_mul_f32 v132, v132, v6
    v_mul_f32 v133, v133, v7
    v_exp_f32 v132, v132
    v_exp_f32 v133, v133
    v_add_f32 v132, 1.0, v132
    v_add_f32 v133, 1.0, v133
    v_rcp_f32 v132, v132
    v_rcp_f32 v133, v133
    s_nop 0
    v_mul_f32 v6, v6, v132
    v_mul_f32 v7, v7, v133
    v_cvt_pk_bf16_f32 v139, v6, v7
    s_waitcnt vmcnt(19)
    s_waitcnt vmcnt(16)
    v_cmp_eq_u32 vcc, 0, v0
    s_cmp_eq_u64 vcc, 0
    s_cbranch_scc1 fs_18
    s_lshl_b32 s38, s30, 2
    s_sub_u32 s38, s97, s38
    v_min_u32 v6, 59, v1
    v_lshlrev_b32 v6, 2, v6
    v_add_u32 v6, 18119552, v6
    v_or_b32 v7, 16, v1
    v_lshlrev_b32 v7, 2, v7
    v_add_u32 v7, s38, v7
    v_cmp_gt_u32 vcc, 32, v1
    v_cndmask_b32 v6, v6, v7, vcc
    v_mov_b32 v0, 0
    s_mov_b32 s42, 0
ck_19:
    v_cmp_eq_u32 vcc, 0, v0
    s_add_u32 s42, s42, 1
    s_cmp_gt_u32 s42, 30000
    s_cbranch_scc1 ckd_20
    s_cmp_eq_u64 vcc, 0
    s_cbranch_scc1 ckd_20
    s_sleep 2
    buffer_load_dword v0, v6, s[24:27], 0 offen sc1
    s_waitcnt vmcnt(0)
    s_branch ck_19
ckd_20:
fs_18:
    s_waitcnt lgkmcnt(0)
    v_mfma_f32_16x16x32_bf16 v[20:23], v[92:95], v[68:71], v[20:23]
    ds_read_b128 v[52:55], v135 offset:16384
    ds_read_b128 v[56:59], v135 offset:18432
    ds_read_b128 v[60:63], v135 offset:20480
    ds_read_b128 v[64:67], v135 offset:22528
    ds_read_b128 v[236:239], v10 offset:3232
    ds_read_b128 v[240:243], v10 offset:3168
    v_mfma_f32_16x16x32_bf16 v[24:27], v[96:99], v[68:71], v[24:27]
    v_mfma_f32_16x16x32_bf16 v[28:31], v[92:95], v[72:75], v[28:31]
    s_add_u32 s38, s34, 65536
    buffer_load_dwordx4 v[84:87], v5, s[24:27], s38 offen offset:0 sc0
    v_mfma_f32_16x16x32_bf16 v[32:35], v[96:99], v[72:75], v[32:35]
    v_mfma_f32_16x16x32_bf16 v[36:39], v[92:95], v[76:79], v[36:39]
    s_add_u32 s38, s34, 65536
    buffer_load_dwordx4 v[88:91], v5, s[24:27], s38 offen offset:1024 sc0
    v_mfma_f32_16x16x32_bf16 v[40:43], v[96:99], v[76:79], v[40:43]
    v_mfma_f32_16x16x32_bf16 v[44:47], v[92:95], v[80:83], v[44:47]
    v_mfma_f32_16x16x32_bf16 v[48:51], v[96:99], v[80:83], v[48:51]
    v_mfma_f32_16x16x32_f16 v[228:231], v[172:175], v[244:247], v[228:231]
    v_mfma_f32_16x16x32_f16 v[228:231], v[176:179], v[248:251], v[228:231]
    s_waitcnt lgkmcnt(0)
    s_barrier
    v_mfma_f32_16x16x32_bf16 v[20:23], v[100:103], v[52:55], v[20:23]
    ds_read_b128 v[68:71], v135 offset:24576
    ds_read_b128 v[72:75], v135 offset:26624
    ds_read_b128 v[76:79], v135 offset:28672
    ds_read_b128 v[80:83], v135 offset:30720
    ds_read_b128 v[244:247], v10 offset:3104
    ds_read_b128 v[248:251], v10 offset:3040
    v_mfma_f32_16x16x32_bf16 v[24:27], v[104:107], v[52:55], v[24:27]
    v_mfma_f32_16x16x32_bf16 v[28:31], v[100:103], v[56:59], v[28:31]
    s_add_u32 m0, s75, 73728
    s_add_u32 s39, s67, 2688
    buffer_load_dwordx4 v18, s[20:23], s39 offen lds
    v_mfma_f32_16x16x32_bf16 v[32:35], v[104:107], v[56:59], v[32:35]
    v_mfma_f32_16x16x32_bf16 v[36:39], v[100:103], v[60:63], v[36:39]
    s_add_u32 m0, s75, 81920
    s_add_u32 s39, s67, 2816
    buffer_load_dwordx4 v18, s[20:23], s39 offen lds
    v_mfma_f32_16x16x32_bf16 v[40:43], v[104:107], v[60:63], v[40:43]
    v_mfma_f32_16x16x32_bf16 v[44:47], v[100:103], v[64:67], v[44:47]
    s_add_u32 s38, s34, 69632
    buffer_load_dwordx4 v[92:95], v5, s[24:27], s38 offen offset:0 sc0
    v_mfma_f32_16x16x32_bf16 v[48:51], v[104:107], v[64:67], v[48:51]
    v_mfma_f32_16x16x32_f16 v[228:231], v[180:183], v[236:239], v[228:231]
    s_add_u32 s38, s34, 69632
    buffer_load_dwordx4 v[96:99], v5, s[24:27], s38 offen offset:1024 sc0
    v_mfma_f32_16x16x32_f16 v[228:231], v[184:187], v[240:243], v[228:231]
    v_lshlrev_b32 v6, 16, v140
    v_and_b32 v7, 0xffff0000, v140
    v_mul_f32 v132, v6, v6
    v_mul_f32 v133, v7, v7
    v_fmaak_f32 v132, v132, v15, 0xc0135761
    v_fmaak_f32 v133, v133, v15, 0xc0135761
    v_mul_f32 v132, v132, v6
    v_mul_f32 v133, v133, v7
    v_exp_f32 v132, v132
    v_exp_f32 v133, v133
    v_add_f32 v132, 1.0, v132
    v_add_f32 v133, 1.0, v133
    v_rcp_f32 v132, v132
    v_rcp_f32 v133, v133
    s_nop 0
    v_mul_f32 v6, v6, v132
    v_mul_f32 v7, v7, v133
    v_cvt_pk_bf16_f32 v140, v6, v7
    s_waitcnt vmcnt(18)
    s_waitcnt lgkmcnt(0)
    v_mfma_f32_16x16x32_bf16 v[20:23], v[108:111], v[68:71], v[20:23]
    ds_read_b128 v[52:55], v19 offset:0
    ds_read_b128 v[56:59], v19 offset:2048
    ds_read_b128 v[60:63], v19 offset:4096
    ds_read_b128 v[64:67], v19 offset:6144
    ds_read_b128 v[236:239], v10 offset:1536
    ds_read_b128 v[240:243], v13 offset:8384
    v_mfma_f32_16x16x32_bf16 v[24:27], v[112:115], v[68:71], v[24:27]
    v_mfma_f32_16x16x32_bf16 v[28:31], v[108:111], v[72:75], v[28:31]
    s_add_u32 s38, s34, 73728
    buffer_load_dwordx4 v[100:103], v5, s[24:27], s38 offen offset:0 sc0
    v_mfma_f32_16x16x32_bf16 v[32:35], v[112:115], v[72:75], v[32:35]
    v_mfma_f32_16x16x32_bf16 v[36:39], v[108:111], v[76:79], v[36:39]
    s_add_u32 s38, s34, 73728
    buffer_load_dwordx4 v[104:107], v5, s[24:27], s38 offen offset:1024 sc0
    v_mfma_f32_16x16x32_bf16 v[40:43], v[112:115], v[76:79], v[40:43]
    v_mfma_f32_16x16x32_bf16 v[44:47], v[108:111], v[80:83], v[44:47]
    v_mfma_f32_16x16x32_bf16 v[48:51], v[112:115], v[80:83], v[48:51]
    v_mfma_f32_16x16x32_f16 v[228:231], v[188:191], v[244:247], v[228:231]
    v_mfma_f32_16x16x32_f16 v[228:231], v[192:195], v[248:251], v[228:231]
    s_waitcnt vmcnt(18)
    s_waitcnt lgkmcnt(0)
    s_barrier
    v_mfma_f32_16x16x32_bf16 v[20:23], v[116:119], v[52:55], v[20:23]
    ds_read_b128 v[68:71], v19 offset:8192
    ds_read_b128 v[72:75], v19 offset:10240
    ds_read_b128 v[76:79], v19 offset:12288
    ds_read_b128 v[80:83], v19 offset:14336
    ds_read_b128 v[244:247], v13 offset:8320
    ds_read_b128 v[248:251], v13 offset:8256
    v_mfma_f32_16x16x32_bf16 v[24:27], v[120:123], v[52:55], v[24:27]
    v_mfma_f32_16x16x32_bf16 v[28:31], v[116:119], v[56:59], v[28:31]
    s_add_u32 m0, s75, 90112
    s_add_u32 s39, s67, 2944
    buffer_load_dwordx4 v18, s[20:23], s39 offen lds
    v_mfma_f32_16x16x32_bf16 v[32:35], v[120:123], v[56:59], v[32:35]
    v_mfma_f32_16x16x32_bf16 v[36:39], v[116:119], v[60:63], v[36:39]
    s_add_u32 m0, s75, 0
    s_add_u32 s39, s67, 3072
    buffer_load_dwordx4 v18, s[20:23], s39 offen lds
    v_mfma_f32_16x16x32_bf16 v[40:43], v[120:123], v[60:63], v[40:43]
    v_mfma_f32_16x16x32_bf16 v[44:47], v[116:119], v[64:67], v[44:47]
    s_add_u32 s38, s34, 77824
    buffer_load_dwordx4 v[108:111], v5, s[24:27], s38 offen offset:0 sc0
    v_mfma_f32_16x16x32_bf16 v[48:51], v[120:123], v[64:67], v[48:51]
    v_mfma_f32_16x16x32_f16 v[228:231], v[196:199], v[236:239], v[228:231]
    s_add_u32 s38, s34, 77824
    buffer_load_dwordx4 v[112:115], v5, s[24:27], s38 offen offset:1024 sc0
    v_mfma_f32_16x16x32_f16 v[228:231], v[240:243], v[200:203], v[228:231]
    v_lshlrev_b32 v6, 16, v141
    v_and_b32 v7, 0xffff0000, v141
    v_mul_f32 v132, v6, v6
    v_mul_f32 v133, v7, v7
    v_fmaak_f32 v132, v132, v15, 0xc0135761
    v_fmaak_f32 v133, v133, v15, 0xc0135761
    v_mul_f32 v132, v132, v6
    v_mul_f32 v133, v133, v7
    v_exp_f32 v132, v132
    v_exp_f32 v133, v133
    v_add_f32 v132, 1.0, v132
    v_add_f32 v133, 1.0, v133
    v_rcp_f32 v132, v132
    v_rcp_f32 v133, v133
    s_nop 0
    v_mul_f32 v6, v6, v132
    v_mul_f32 v7, v7, v133
    v_cvt_pk_bf16_f32 v141, v6, v7
    s_waitcnt vmcnt(18)
    s_waitcnt lgkmcnt(0)
    v_mfma_f32_16x16x32_bf16 v[20:23], v[124:127], v[68:71], v[20:23]
    ds_read_b128 v[52:55], v19 offset:16384
    ds_read_b128 v[56:59], v19 offset:18432
    ds_read_b128 v[60:63], v19 offset:20480
    ds_read_b128 v[64:67], v19 offset:22528
    ds_read_b128 v[236:239], v13 offset:8192
    ds_read_b128 v[240:243], v10 offset:4064
    v_mfma_f32_16x16x32_bf16 v[24:27], v[128:131], v[68:71], v[24:27]
    v_mfma_f32_16x16x32_bf16 v[28:31], v[124:127], v[72:75], v[28:31]
    s_add_u32 s38, s34, 81920
    buffer_load_dwordx4 v[116:119], v5, s[24:27], s38 offen offset:0 sc0
    v_mfma_f32_16x16x32_bf16 v[32:35], v[128:131], v[72:75], v[32:35]
    v_mfma_f32_16x16x32_bf16 v[36:39], v[124:127], v[76:79], v[36:39]
    s_add_u32 s38, s34, 81920
    buffer_load_dwordx4 v[120:123], v5, s[24:27], s38 offen offset:1024 sc0
    v_mfma_f32_16x16x32_bf16 v[40:43], v[128:131], v[76:79], v[40:43]
    v_mfma_f32_16x16x32_bf16 v[44:47], v[124:127], v[80:83], v[44:47]
    v_mfma_f32_16x16x32_bf16 v[48:51], v[128:131], v[80:83], v[48:51]
    v_mfma_f32_16x16x32_f16 v[228:231], v[244:247], v[204:207], v[228:231]
    v_mfma_f32_16x16x32_f16 v[228:231], v[248:251], v[208:211], v[228:231]
    s_waitcnt vmcnt(18)
    s_waitcnt lgkmcnt(0)
    s_barrier
    v_mfma_f32_16x16x32_bf16 v[20:23], v[144:147], v[52:55], v[20:23]
    ds_read_b128 v[68:71], v19 offset:24576
    ds_read_b128 v[72:75], v19 offset:26624
    ds_read_b128 v[76:79], v19 offset:28672
    ds_read_b128 v[80:83], v19 offset:30720
    ds_read_b128 v[244:247], v10 offset:4000
    ds_read_b128 v[248:251], v10 offset:3936
    v_mfma_f32_16x16x32_bf16 v[24:27], v[148:151], v[52:55], v[24:27]
    v_mfma_f32_16x16x32_bf16 v[28:31], v[144:147], v[56:59], v[28:31]
    s_add_u32 m0, s75, 8192
    s_add_u32 s39, s67, 3200
    buffer_load_dwordx4 v18, s[20:23], s39 offen lds
    v_mfma_f32_16x16x32_bf16 v[32:35], v[148:151], v[56:59], v[32:35]
    v_mfma_f32_16x16x32_bf16 v[36:39], v[144:147], v[60:63], v[36:39]
    s_add_u32 m0, s75, 16384
    s_add_u32 s39, s67, 3328
    buffer_load_dwordx4 v18, s[20:23], s39 offen lds
    v_mfma_f32_16x16x32_bf16 v[40:43], v[148:151], v[60:63], v[40:43]
    v_mfma_f32_16x16x32_bf16 v[44:47], v[144:147], v[64:67], v[44:47]
    s_add_u32 s38, s34, 86016
    buffer_load_dwordx4 v[124:127], v5, s[24:27], s38 offen offset:0 sc0
    v_mfma_f32_16x16x32_bf16 v[48:51], v[148:151], v[64:67], v[48:51]
    v_mfma_f32_16x16x32_f16 v[228:231], v[236:239], v[212:215], v[228:231]
    s_add_u32 s38, s34, 86016
    buffer_load_dwordx4 v[128:131], v5, s[24:27], s38 offen offset:1024 sc0
    v_mfma_f32_16x16x32_f16 v[232:235], v[160:163], v[240:243], 0
    v_lshlrev_b32 v6, 16, v142
    v_and_b32 v7, 0xffff0000, v142
    v_mul_f32 v132, v6, v6
    v_mul_f32 v133, v7, v7
    v_fmaak_f32 v132, v132, v15, 0xc0135761
    v_fmaak_f32 v133, v133, v15, 0xc0135761
    v_mul_f32 v132, v132, v6
    v_mul_f32 v133, v133, v7
    v_exp_f32 v132, v132
    v_exp_f32 v133, v133
    v_add_f32 v132, 1.0, v132
    v_add_f32 v133, 1.0, v133
    v_rcp_f32 v132, v132
    v_rcp_f32 v133, v133
    s_nop 0
    v_mul_f32 v6, v6, v132
    v_mul_f32 v7, v7, v133
    v_cvt_pk_bf16_f32 v142, v6, v7
    s_waitcnt vmcnt(18)
    s_waitcnt lgkmcnt(0)
    v_mfma_f32_16x16x32_bf16 v[20:23], v[152:155], v[68:71], v[20:23]
    ds_read_b128 v[52:55], v19 offset:32768
    ds_read_b128 v[56:59], v19 offset:34816
    ds_read_b128 v[60:63], v19 offset:36864
    ds_read_b128 v[64:67], v19 offset:38912
    ds_read_b128 v[236:239], v10 offset:3872
    ds_read_b128 v[240:243], v10 offset:3808
    v_mfma_f32_16x16x32_bf16 v[24:27], v[156:159], v[68:71], v[24:27]
    v_mfma_f32_16x16x32_bf16 v[28:31], v[152:155], v[72:75], v[28:31]
    s_add_u32 s38, s34, 90112
    buffer_load_dwordx4 v[144:147], v5, s[24:27], s38 offen offset:0 sc0
    v_mfma_f32_16x16x32_bf16 v[32:35], v[156:159], v[72:75], v[32:35]
    v_mfma_f32_16x16x32_bf16 v[36:39], v[152:155], v[76:79], v[36:39]
    s_add_u32 s38, s34, 90112
    buffer_load_dwordx4 v[148:151], v5, s[24:27], s38 offen offset:1024 sc0
    v_mfma_f32_16x16x32_bf16 v[40:43], v[156:159], v[76:79], v[40:43]
    v_mfma_f32_16x16x32_bf16 v[44:47], v[152:155], v[80:83], v[44:47]
    v_mfma_f32_16x16x32_bf16 v[48:51], v[156:159], v[80:83], v[48:51]
    v_mfma_f32_16x16x32_f16 v[232:235], v[164:167], v[244:247], v[232:235]
    v_mfma_f32_16x16x32_f16 v[232:235], v[168:171], v[248:251], v[232:235]
    s_waitcnt vmcnt(18)
    s_waitcnt lgkmcnt(0)
    s_barrier
    v_mfma_f32_16x16x32_bf16 v[20:23], v[84:87], v[52:55], v[20:23]
    ds_read_b128 v[68:71], v19 offset:40960
    ds_read_b128 v[72:75], v19 offset:43008
    ds_read_b128 v[76:79], v19 offset:45056
    ds_read_b128 v[80:83], v19 offset:47104
    ds_read_b128 v[244:247], v10 offset:3744
    ds_read_b128 v[248:251], v10 offset:3680
    v_mfma_f32_16x16x32_bf16 v[24:27], v[88:91], v[52:55], v[24:27]
    v_mfma_f32_16x16x32_bf16 v[28:31], v[84:87], v[56:59], v[28:31]
    s_add_u32 m0, s75, 24576
    s_add_u32 s39, s67, 3456
    buffer_load_dwordx4 v18, s[20:23], s39 offen lds
    v_mfma_f32_16x16x32_bf16 v[32:35], v[88:91], v[56:59], v[32:35]
    v_mfma_f32_16x16x32_bf16 v[36:39], v[84:87], v[60:63], v[36:39]
    s_add_u32 m0, s75, 32768
    s_add_u32 s39, s67, 3584
    buffer_load_dwordx4 v18, s[20:23], s39 offen lds
    v_mfma_f32_16x16x32_bf16 v[40:43], v[88:91], v[60:63], v[40:43]
    v_mfma_f32_16x16x32_bf16 v[44:47], v[84:87], v[64:67], v[44:47]
    s_add_u32 s38, s34, 94208
    buffer_load_dwordx4 v[152:155], v5, s[24:27], s38 offen offset:0 sc0
    v_mfma_f32_16x16x32_bf16 v[48:51], v[88:91], v[64:67], v[48:51]
    v_mfma_f32_16x16x32_f16 v[232:235], v[172:175], v[236:239], v[232:235]
    s_add_u32 s38, s34, 94208
    buffer_load_dwordx4 v[156:159], v5, s[24:27], s38 offen offset:1024 sc0
    v_mfma_f32_16x16x32_f16 v[232:235], v[176:179], v[240:243], v[232:235]
    v_lshlrev_b32 v6, 16, v143
    v_and_b32 v7, 0xffff0000, v143
    v_mul_f32 v132, v6, v6
    v_mul_f32 v133, v7, v7
    v_fmaak_f32 v132, v132, v15, 0xc0135761
    v_fmaak_f32 v133, v133, v15, 0xc0135761
    v_mul_f32 v132, v132, v6
    v_mul_f32 v133, v133, v7
    v_exp_f32 v132, v132
    v_exp_f32 v133, v133
    v_add_f32 v132, 1.0, v132
    v_add_f32 v133, 1.0, v133
    v_rcp_f32 v132, v132
    v_rcp_f32 v133, v133
    s_nop 0
    v_mul_f32 v6, v6, v132
    v_mul_f32 v7, v7, v133
    v_cvt_pk_bf16_f32 v143, v6, v7
    s_waitcnt vmcnt(18)
    s_waitcnt lgkmcnt(0)
    v_mfma_f32_16x16x32_bf16 v[20:23], v[92:95], v[68:71], v[20:23]
    ds_read_b128 v[52:55], v19 offset:49152
    ds_read_b128 v[56:59], v19 offset:51200
    ds_read_b128 v[60:63], v19 offset:53248
    ds_read_b128 v[64:67], v19 offset:55296
    ds_read_b128 v[236:239], v10 offset:3616
    ds_read_b128 v[240:243], v10 offset:3552
    v_mfma_f32_16x16x32_bf16 v[24:27], v[96:99], v[68:71], v[24:27]
    v_mfma_f32_16x16x32_bf16 v[28:31], v[92:95], v[72:75], v[28:31]
    s_add_u32 s38, s34, 98304
    buffer_load_dwordx4 v[84:87], v5, s[24:27], s38 offen offset:0 sc0
    v_mfma_f32_16x16x32_bf16 v[32:35], v[96:99], v[72:75], v[32:35]
    v_mfma_f32_16x16x32_bf16 v[36:39], v[92:95], v[76:79], v[36:39]
    s_add_u32 s38, s34, 98304
    buffer_load_dwordx4 v[88:91], v5, s[24:27], s38 offen offset:1024 sc0
    v_mfma_f32_16x16x32_bf16 v[40:43], v[96:99], v[76:79], v[40:43]
    v_mfma_f32_16x16x32_bf16 v[44:47], v[92:95], v[80:83], v[44:47]
    v_mfma_f32_16x16x32_bf16 v[48:51], v[96:99], v[80:83], v[48:51]
    v_mfma_f32_16x16x32_f16 v[232:235], v[180:183], v[244:247], v[232:235]
    v_mfma_f32_16x16x32_f16 v[232:235], v[184:187], v[248:251], v[232:235]
    s_waitcnt vmcnt(18)
    s_waitcnt lgkmcnt(0)
    s_barrier
    v_mfma_f32_16x16x32_bf16 v[20:23], v[100:103], v[52:55], v[20:23]
    ds_read_b128 v[68:71], v19 offset:57344
    ds_read_b128 v[72:75], v19 offset:59392
    ds_read_b128 v[76:79], v19 offset:61440
    ds_read_b128 v[80:83], v19 offset:63488
    ds_read_b128 v[244:247], v10 offset:2048
    ds_read_b128 v[248:251], v13 offset:8448
    v_mfma_f32_16x16x32_bf16 v[24:27], v[104:107], v[52:55], v[24:27]
    v_mfma_f32_16x16x32_bf16 v[28:31], v[100:103], v[56:59], v[28:31]
    s_add_u32 m0, s75, 40960
    s_add_u32 s39, s67, 3712
    buffer_load_dwordx4 v18, s[20:23], s39 offen lds
    v_mfma_f32_16x16x32_bf16 v[32:35], v[104:107], v[56:59], v[32:35]
    v_mfma_f32_16x16x32_bf16 v[36:39], v[100:103], v[60:63], v[36:39]
    s_add_u32 m0, s75, 49152
    s_add_u32 s39, s67, 3840
    buffer_load_dwordx4 v18, s[20:23], s39 offen lds
    v_mfma_f32_16x16x32_bf16 v[40:43], v[104:107], v[60:63], v[40:43]
    v_mfma_f32_16x16x32_bf16 v[44:47], v[100:103], v[64:67], v[44:47]
    s_add_u32 s38, s34, 102400
    buffer_load_dwordx4 v[92:95], v5, s[24:27], s38 offen offset:0 sc0
    v_mfma_f32_16x16x32_bf16 v[48:51], v[104:107], v[64:67], v[48:51]
    v_mfma_f32_16x16x32_f16 v[232:235], v[188:191], v[236:239], v[232:235]
    s_add_u32 s38, s34, 102400
    buffer_load_dwordx4 v[96:99], v5, s[24:27], s38 offen offset:1024 sc0
    v_mfma_f32_16x16x32_f16 v[232:235], v[192:195], v[240:243], v[232:235]
    s_waitcnt vmcnt(18)
    s_waitcnt lgkmcnt(0)
    v_mfma_f32_16x16x32_bf16 v[20:23], v[108:111], v[68:71], v[20:23]
    ds_read_b128 v[52:55], v135 offset:0
    ds_read_b128 v[56:59], v135 offset:2048
    ds_read_b128 v[60:63], v135 offset:4096
    ds_read_b128 v[64:67], v135 offset:6144
    ds_read_b128 v[236:239], v13 offset:8384
    ds_read_b128 v[240:243], v13 offset:8320
    v_mfma_f32_16x16x32_bf16 v[24:27], v[112:115], v[68:71], v[24:27]
    v_mfma_f32_16x16x32_bf16 v[28:31], v[108:111], v[72:75], v[28:31]
    s_add_u32 s38, s34, 106496
    buffer_load_dwordx4 v[100:103], v5, s[24:27], s38 offen offset:0 sc0
    v_mfma_f32_16x16x32_bf16 v[32:35], v[112:115], v[72:75], v[32:35]
    v_mfma_f32_16x16x32_bf16 v[36:39], v[108:111], v[76:79], v[36:39]
    s_add_u32 s38, s34, 106496
    buffer_load_dwordx4 v[104:107], v5, s[24:27], s38 offen offset:1024 sc0
    v_mfma_f32_16x16x32_bf16 v[40:43], v[112:115], v[76:79], v[40:43]
    v_mfma_f32_16x16x32_bf16 v[44:47], v[108:111], v[80:83], v[44:47]
    v_mfma_f32_16x16x32_bf16 v[48:51], v[112:115], v[80:83], v[48:51]
    v_mfma_f32_16x16x32_f16 v[232:235], v[196:199], v[244:247], v[232:235]
    v_mfma_f32_16x16x32_f16 v[232:235], v[248:251], v[200:203], v[232:235]
    s_waitcnt vmcnt(18)
    s_waitcnt lgkmcnt(0)
    s_barrier
    v_mfma_f32_16x16x32_bf16 v[20:23], v[116:119], v[52:55], v[20:23]
    ds_read_b128 v[68:71], v135 offset:8192
    ds_read_b128 v[72:75], v135 offset:10240
    ds_read_b128 v[76:79], v135 offset:12288
    ds_read_b128 v[80:83], v135 offset:14336
    ds_read_b128 v[244:247], v13 offset:8256
    ds_read_b128 v[248:251], v13 offset:8192
    v_mfma_f32_16x16x32_bf16 v[24:27], v[120:123], v[52:55], v[24:27]
    v_mfma_f32_16x16x32_bf16 v[28:31], v[116:119], v[56:59], v[28:31]
    s_add_u32 m0, s75, 57344
    s_add_u32 s39, s67, 3968
    buffer_load_dwordx4 v18, s[20:23], s39 offen lds
    v_mfma_f32_16x16x32_bf16 v[32:35], v[120:123], v[56:59], v[32:35]
    v_mfma_f32_16x16x32_bf16 v[36:39], v[116:119], v[60:63], v[36:39]
    s_add_u32 s38, s34, 110592
    buffer_load_dwordx4 v[108:111], v5, s[24:27], s38 offen offset:0 sc0
    v_mfma_f32_16x16x32_bf16 v[40:43], v[120:123], v[60:63], v[40:43]
    v_mfma_f32_16x16x32_bf16 v[44:47], v[116:119], v[64:67], v[44:47]
    s_add_u32 s38, s34, 110592
    buffer_load_dwordx4 v[112:115], v5, s[24:27], s38 offen offset:1024 sc0
    v_mfma_f32_16x16x32_bf16 v[48:51], v[120:123], v[64:67], v[48:51]
    v_mfma_f32_16x16x32_f16 v[232:235], v[236:239], v[204:207], v[232:235]
    v_mfma_f32_16x16x32_f16 v[232:235], v[240:243], v[208:211], v[232:235]
    s_waitcnt vmcnt(17)
    s_waitcnt lgkmcnt(0)
    v_mfma_f32_16x16x32_bf16 v[20:23], v[124:127], v[68:71], v[20:23]
    ds_read_b128 v[52:55], v135 offset:16384
    ds_read_b128 v[56:59], v135 offset:18432
    ds_read_b128 v[60:63], v135 offset:20480
    ds_read_b128 v[64:67], v135 offset:22528
    v_mfma_f32_16x16x32_bf16 v[24:27], v[128:131], v[68:71], v[24:27]
    v_mfma_f32_16x16x32_bf16 v[28:31], v[124:127], v[72:75], v[28:31]
    s_add_u32 s38, s34, 114688
    buffer_load_dwordx4 v[116:119], v5, s[24:27], s38 offen offset:0 sc0
    v_mfma_f32_16x16x32_bf16 v[32:35], v[128:131], v[72:75], v[32:35]
    v_mfma_f32_16x16x32_bf16 v[36:39], v[124:127], v[76:79], v[36:39]
    s_add_u32 s38, s34, 114688
    buffer_load_dwordx4 v[120:123], v5, s[24:27], s38 offen offset:1024 sc0
    v_mfma_f32_16x16x32_bf16 v[40:43], v[128:131], v[76:79], v[40:43]
    v_mfma_f32_16x16x32_bf16 v[44:47], v[124:127], v[80:83], v[44:47]
    v_mfma_f32_16x16x32_bf16 v[48:51], v[128:131], v[80:83], v[48:51]
    v_mfma_f32_16x16x32_f16 v[232:235], v[244:247], v[212:215], v[232:235]
    v_mfma_f32_16x16x32_f16 v[232:235], v[248:251], v[216:219], v[232:235]
    s_waitcnt vmcnt(17)
    s_waitcnt lgkmcnt(0)
    s_barrier
    v_mfma_f32_16x16x32_bf16 v[20:23], v[144:147], v[52:55], v[20:23]
    ds_read_b128 v[68:71], v135 offset:24576
    ds_read_b128 v[72:75], v135 offset:26624
    ds_read_b128 v[76:79], v135 offset:28672
    ds_read_b128 v[80:83], v135 offset:30720
    ds_write_b128 v12, v[220:223] offset:4096
    ds_write_b128 v12, v[224:227] offset:5120
    ds_write_b128 v12, v[228:231] offset:6144
    ds_write_b128 v12, v[232:235] offset:7168
    v_mfma_f32_16x16x32_bf16 v[24:27], v[148:151], v[52:55], v[24:27]
    v_mfma_f32_16x16x32_bf16 v[28:31], v[144:147], v[56:59], v[28:31]
    s_add_u32 s38, s34, 118784
    buffer_load_dwordx4 v[124:127], v5, s[24:27], s38 offen offset:0 sc0
    v_mfma_f32_16x16x32_bf16 v[32:35], v[148:151], v[56:59], v[32:35]
    v_mfma_f32_16x16x32_bf16 v[36:39], v[144:147], v[60:63], v[36:39]
    s_add_u32 s38, s34, 118784
    buffer_load_dwordx4 v[128:131], v5, s[24:27], s38 offen offset:1024 sc0
    v_mfma_f32_16x16x32_bf16 v[40:43], v[148:151], v[60:63], v[40:43]
    v_mfma_f32_16x16x32_bf16 v[44:47], v[144:147], v[64:67], v[44:47]
    v_mfma_f32_16x16x32_bf16 v[48:51], v[148:151], v[64:67], v[48:51]
    s_waitcnt vmcnt(15)
    s_waitcnt lgkmcnt(0)
    s_barrier
    v_mfma_f32_16x16x32_bf16 v[20:23], v[152:155], v[68:71], v[20:23]
    ds_read_b128 v[52:55], v19 offset:0
    ds_read_b128 v[56:59], v19 offset:2048
    ds_read_b128 v[60:63], v19 offset:4096
    ds_read_b128 v[64:67], v19 offset:6144
    ds_read_b128 v[160:163], v9 offset:0
    ds_read_b128 v[164:167], v9 offset:13568
    ds_read_b128 v[168:171], v9 offset:20800
    ds_read_b128 v[176:179], v9 offset:1024
    ds_read_b128 v[180:183], v9 offset:14592
    ds_read_b128 v[184:187], v9 offset:21824
    v_mfma_f32_16x16x32_bf16 v[24:27], v[156:159], v[68:71], v[24:27]
    v_mfma_f32_16x16x32_bf16 v[28:31], v[152:155], v[72:75], v[28:31]
    s_add_u32 s38, s34, 122880
    buffer_load_dwordx4 v[144:147], v5, s[24:27], s38 offen offset:0 sc0
    v_mfma_f32_16x16x32_bf16 v[32:35], v[156:159], v[72:75], v[32:35]
    v_mfma_f32_16x16x32_bf16 v[36:39], v[152:155], v[76:79], v[36:39]
    s_add_u32 s38, s34, 122880
    buffer_load_dwordx4 v[148:151], v5, s[24:27], s38 offen offset:1024 sc0
    v_mfma_f32_16x16x32_bf16 v[40:43], v[156:159], v[76:79], v[40:43]
    v_mfma_f32_16x16x32_bf16 v[44:47], v[152:155], v[80:83], v[44:47]
    v_mfma_f32_16x16x32_bf16 v[48:51], v[156:159], v[80:83], v[48:51]
    s_waitcnt vmcnt(15)
    s_waitcnt lgkmcnt(0)
    s_barrier
    v_mfma_f32_16x16x32_bf16 v[20:23], v[84:87], v[52:55], v[20:23]
    ds_read_b128 v[68:71], v19 offset:8192
    ds_read_b128 v[72:75], v19 offset:10240
    ds_read_b128 v[76:79], v19 offset:12288
    ds_read_b128 v[80:83], v19 offset:14336
    v_mfma_f32_16x16x32_bf16 v[24:27], v[88:91], v[52:55], v[24:27]
    v_mfma_f32_16x16x32_bf16 v[28:31], v[84:87], v[56:59], v[28:31]
    s_add_u32 s38, s34, 126976
    buffer_load_dwordx4 v[152:155], v5, s[24:27], s38 offen offset:0 sc0
    v_mfma_f32_16x16x32_bf16 v[32:35], v[88:91], v[56:59], v[32:35]
    v_mfma_f32_16x16x32_bf16 v[36:39], v[84:87], v[60:63], v[36:39]
    s_add_u32 s38, s34, 126976
    buffer_load_dwordx4 v[156:159], v5, s[24:27], s38 offen offset:1024 sc0
    v_mfma_f32_16x16x32_bf16 v[40:43], v[88:91], v[60:63], v[40:43]
    v_mfma_f32_16x16x32_bf16 v[44:47], v[84:87], v[64:67], v[44:47]
    v_mfma_f32_16x16x32_bf16 v[48:51], v[88:91], v[64:67], v[48:51]
    v_pk_add_f32 v[164:165], v[164:165], v[168:169]
    v_pk_add_f32 v[160:161], v[160:161], v[164:165]
    v_mul_f32 v160, s74, v160
    v_mul_f32 v161, s74, v161
    v_lshlrev_b32 v192, 16, v252
    v_and_b32 v193, 0xffff0000, v252
    v_mul_f32 v192, s73, v192
    v_mul_f32 v193, s73, v193
    v_cvt_pk_bf16_f32 v252, v192, v193
    v_cvt_pk_bf16_f32 v194, v160, v161
    v_lshlrev_b32 v192, 16, v252
    v_and_b32 v193, 0xffff0000, v252
    v_lshlrev_b32 v160, 16, v194
    v_and_b32 v161, 0xffff0000, v194
    v_pk_add_f32 v[192:193], v[192:193], v[160:161]
    v_cvt_pk_bf16_f32 v252, v192, v193
    v_pk_add_f32 v[166:167], v[166:167], v[170:171]
    v_pk_add_f32 v[162:163], v[162:163], v[166:167]
    v_mul_f32 v162, s74, v162
    v_mul_f32 v163, s74, v163
    v_lshlrev_b32 v196, 16, v253
    v_and_b32 v197, 0xffff0000, v253
    v_mul_f32 v196, s73, v196
    v_mul_f32 v197, s73, v197
    v_cvt_pk_bf16_f32 v253, v196, v197
    v_cvt_pk_bf16_f32 v198, v162, v163
    v_lshlrev_b32 v196, 16, v253
    v_and_b32 v197, 0xffff0000, v253
    v_lshlrev_b32 v162, 16, v198
    v_and_b32 v163, 0xffff0000, v198
    v_pk_add_f32 v[196:197], v[196:197], v[162:163]
    v_cvt_pk_bf16_f32 v253, v196, v197
    buffer_store_dwordx2 v[252:253], v2, s[68:71], 0 offen offset:0 sc1
    s_waitcnt vmcnt(14)
    s_waitcnt lgkmcnt(0)
    v_mfma_f32_16x16x32_bf16 v[20:23], v[92:95], v[68:71], v[20:23]
    ds_read_b128 v[52:55], v19 offset:16384
    ds_read_b128 v[56:59], v19 offset:18432
    ds_read_b128 v[60:63], v19 offset:20480
    ds_read_b128 v[64:67], v19 offset:22528
    v_mfma_f32_16x16x32_bf16 v[24:27], v[96:99], v[68:71], v[24:27]
    v_mfma_f32_16x16x32_bf16 v[28:31], v[92:95], v[72:75], v[28:31]
    v_mfma_f32_16x16x32_bf16 v[32:35], v[96:99], v[72:75], v[32:35]
    v_mfma_f32_16x16x32_bf16 v[36:39], v[92:95], v[76:79], v[36:39]
    v_mfma_f32_16x16x32_bf16 v[40:43], v[96:99], v[76:79], v[40:43]
    v_mfma_f32_16x16x32_bf16 v[44:47], v[92:95], v[80:83], v[44:47]
    v_mfma_f32_16x16x32_bf16 v[48:51], v[96:99], v[80:83], v[48:51]
    v_pk_add_f32 v[180:181], v[180:181], v[184:185]
    v_pk_add_f32 v[176:177], v[176:177], v[180:181]
    v_mul_f32 v176, s74, v176
    v_mul_f32 v177, s74, v177
    v_lshlrev_b32 v200, 16, v254
    v_and_b32 v201, 0xffff0000, v254
    v_mul_f32 v200, s73, v200
    v_mul_f32 v201, s73, v201
    v_cvt_pk_bf16_f32 v254, v200, v201
    v_cvt_pk_bf16_f32 v202, v176, v177
    v_lshlrev_b32 v200, 16, v254
    v_and_b32 v201, 0xffff0000, v254
    v_lshlrev_b32 v176, 16, v202
    v_and_b32 v177, 0xffff0000, v202
    v_pk_add_f32 v[200:201], v[200:201], v[176:177]
    v_cvt_pk_bf16_f32 v254, v200, v201
    v_pk_add_f32 v[182:183], v[182:183], v[186:187]
    v_pk_add_f32 v[178:179], v[178:179], v[182:183]
    v_mul_f32 v178, s74, v178
    v_mul_f32 v179, s74, v179
    v_lshlrev_b32 v204, 16, v255
    v_and_b32 v205, 0xffff0000, v255
    v_mul_f32 v204, s73, v204
    v_mul_f32 v205, s73, v205
    v_cvt_pk_bf16_f32 v255, v204, v205
    v_cvt_pk_bf16_f32 v206, v178, v179
    v_lshlrev_b32 v204, 16, v255
    v_and_b32 v205, 0xffff0000, v255
    v_lshlrev_b32 v178, 16, v206
    v_and_b32 v179, 0xffff0000, v206
    v_pk_add_f32 v[204:205], v[204:205], v[178:179]
    v_cvt_pk_bf16_f32 v255, v204, v205
    buffer_store_dwordx2 v[254:255], v2, s[68:71], 0 offen offset:512 sc1
    s_waitcnt vmcnt(13)
    s_waitcnt lgkmcnt(0)
    s_barrier
    v_mfma_f32_16x16x32_bf16 v[20:23], v[100:103], v[52:55], v[20:23]
    ds_read_b128 v[68:71], v19 offset:24576
    ds_read_b128 v[72:75], v19 offset:26624
    ds_read_b128 v[76:79], v19 offset:28672
    ds_read_b128 v[80:83], v19 offset:30720
    v_mfma_f32_16x16x32_bf16 v[24:27], v[104:107], v[52:55], v[24:27]
    v_mfma_f32_16x16x32_bf16 v[28:31], v[100:103], v[56:59], v[28:31]
    v_mfma_f32_16x16x32_bf16 v[32:35], v[104:107], v[56:59], v[32:35]
    v_mfma_f32_16x16x32_bf16 v[36:39], v[100:103], v[60:63], v[36:39]
    v_mfma_f32_16x16x32_bf16 v[40:43], v[104:107], v[60:63], v[40:43]
    v_mfma_f32_16x16x32_bf16 v[44:47], v[100:103], v[64:67], v[44:47]
    v_mfma_f32_16x16x32_bf16 v[48:51], v[104:107], v[64:67], v[48:51]
    s_waitcnt vmcnt(10)
    s_waitcnt lgkmcnt(0)
    v_mfma_f32_16x16x32_bf16 v[20:23], v[108:111], v[68:71], v[20:23]
    ds_read_b128 v[52:55], v19 offset:32768
    ds_read_b128 v[56:59], v19 offset:34816
    ds_read_b128 v[60:63], v19 offset:36864
    ds_read_b128 v[64:67], v19 offset:38912
    v_mfma_f32_16x16x32_bf16 v[24:27], v[112:115], v[68:71], v[24:27]
    v_mfma_f32_16x16x32_bf16 v[28:31], v[108:111], v[72:75], v[28:31]
    v_mfma_f32_16x16x32_bf16 v[32:35], v[112:115], v[72:75], v[32:35]
    v_mfma_f32_16x16x32_bf16 v[36:39], v[108:111], v[76:79], v[36:39]
    v_mfma_f32_16x16x32_bf16 v[40:43], v[112:115], v[76:79], v[40:43]
    v_mfma_f32_16x16x32_bf16 v[44:47], v[108:111], v[80:83], v[44:47]
    v_mfma_f32_16x16x32_bf16 v[48:51], v[112:115], v[80:83], v[48:51]
    s_waitcnt vmcnt(8)
    s_waitcnt lgkmcnt(0)
    s_barrier
    v_mfma_f32_16x16x32_bf16 v[20:23], v[116:119], v[52:55], v[20:23]
    ds_read_b128 v[68:71], v19 offset:40960
    ds_read_b128 v[72:75], v19 offset:43008
    ds_read_b128 v[76:79], v19 offset:45056
    ds_read_b128 v[80:83], v19 offset:47104
    v_mfma_f32_16x16x32_bf16 v[24:27], v[120:123], v[52:55], v[24:27]
    v_mfma_f32_16x16x32_bf16 v[28:31], v[116:119], v[56:59], v[28:31]
    s_add_u32 s38, s47, 0
    buffer_load_dwordx4 v[160:163], v5, s[24:27], s38 offen offset:0
    v_mfma_f32_16x16x32_bf16 v[32:35], v[120:123], v[56:59], v[32:35]
    v_mfma_f32_16x16x32_bf16 v[36:39], v[116:119], v[60:63], v[36:39]
    s_add_u32 s38, s47, 0
    buffer_load_dwordx4 v[176:179], v5, s[24:27], s38 offen offset:1024
    v_mfma_f32_16x16x32_bf16 v[40:43], v[120:123], v[60:63], v[40:43]
    v_mfma_f32_16x16x32_bf16 v[44:47], v[116:119], v[64:67], v[44:47]
    v_mfma_f32_16x16x32_bf16 v[48:51], v[120:123], v[64:67], v[48:51]
    s_waitcnt vmcnt(8)
    s_waitcnt lgkmcnt(0)
    v_mfma_f32_16x16x32_bf16 v[20:23], v[124:127], v[68:71], v[20:23]
    ds_read_b128 v[52:55], v19 offset:49152
    ds_read_b128 v[56:59], v19 offset:51200
    ds_read_b128 v[60:63], v19 offset:53248
    ds_read_b128 v[64:67], v19 offset:55296
    v_mfma_f32_16x16x32_bf16 v[24:27], v[128:131], v[68:71], v[24:27]
    v_mfma_f32_16x16x32_bf16 v[28:31], v[124:127], v[72:75], v[28:31]
    s_add_u32 s38, s47, 0
    buffer_load_dwordx4 v[192:195], v5, s[24:27], s38 offen offset:2048
    v_mfma_f32_16x16x32_bf16 v[32:35], v[128:131], v[72:75], v[32:35]
    v_mfma_f32_16x16x32_bf16 v[36:39], v[124:127], v[76:79], v[36:39]
    s_add_u32 s38, s47, 0
    buffer_load_dwordx4 v[208:211], v5, s[24:27], s38 offen offset:3072
    v_mfma_f32_16x16x32_bf16 v[40:43], v[128:131], v[76:79], v[40:43]
    v_mfma_f32_16x16x32_bf16 v[44:47], v[124:127], v[80:83], v[44:47]
    v_mfma_f32_16x16x32_bf16 v[48:51], v[128:131], v[80:83], v[48:51]
    s_waitcnt vmcnt(8)
    s_waitcnt lgkmcnt(0)
    s_barrier
    v_mfma_f32_16x16x32_bf16 v[20:23], v[144:147], v[52:55], v[20:23]
    ds_read_b128 v[68:71], v19 offset:57344
    ds_read_b128 v[72:75], v19 offset:59392
    ds_read_b128 v[76:79], v19 offset:61440
    ds_read_b128 v[80:83], v19 offset:63488
    v_mfma_f32_16x16x32_bf16 v[24:27], v[148:151], v[52:55], v[24:27]
    v_mfma_f32_16x16x32_bf16 v[28:31], v[144:147], v[56:59], v[28:31]
    s_add_u32 s38, s47, 28672
    buffer_load_dwordx4 v[164:167], v5, s[24:27], s38 offen offset:0
    v_mfma_f32_16x16x32_bf16 v[32:35], v[148:151], v[56:59], v[32:35]
    v_mfma_f32_16x16x32_bf16 v[36:39], v[144:147], v[60:63], v[36:39]
    s_add_u32 s38, s47, 28672
    buffer_load_dwordx4 v[180:183], v5, s[24:27], s38 offen offset:1024
    v_mfma_f32_16x16x32_bf16 v[40:43], v[148:151], v[60:63], v[40:43]
    v_mfma_f32_16x16x32_bf16 v[44:47], v[144:147], v[64:67], v[44:47]
    v_mfma_f32_16x16x32_bf16 v[48:51], v[148:151], v[64:67], v[48:51]
    s_waitcnt vmcnt(6)
    v_mov_b32 v6, s98
    v_mov_b32 v7, 1
    s_mov_b64 exec, 1
    buffer_store_dword v7, v6, s[24:27], 0 offen sc1
    s_mov_b64 exec, -1
    s_waitcnt lgkmcnt(0)
    v_mfma_f32_16x16x32_bf16 v[20:23], v[152:155], v[68:71], v[20:23]
    v_mfma_f32_16x16x32_bf16 v[24:27], v[156:159], v[68:71], v[24:27]
    v_mfma_f32_16x16x32_bf16 v[28:31], v[152:155], v[72:75], v[28:31]
    s_add_u32 s38, s47, 28672
    buffer_load_dwordx4 v[196:199], v5, s[24:27], s38 offen offset:2048
    v_mfma_f32_16x16x32_bf16 v[32:35], v[156:159], v[72:75], v[32:35]
    v_mfma_f32_16x16x32_bf16 v[36:39], v[152:155], v[76:79], v[36:39]
    s_add_u32 s38, s47, 28672
    buffer_load_dwordx4 v[212:215], v5, s[24:27], s38 offen offset:3072
    v_mfma_f32_16x16x32_bf16 v[40:43], v[156:159], v[76:79], v[40:43]
    v_mfma_f32_16x16x32_bf16 v[44:47], v[152:155], v[80:83], v[44:47]
    v_mfma_f32_16x16x32_bf16 v[48:51], v[156:159], v[80:83], v[48:51]
    s_branch gf_kernel_cd
gf_kernel_c2:
    ds_read2_b32 v[160:161], v11 offset0:160 offset1:161
    ds_read2_b32 v[162:163], v11 offset0:162 offset1:163
    ds_read2_b32 v[164:165], v11 offset0:144 offset1:145
    ds_read2_b32 v[166:167], v11 offset0:146 offset1:147
    ds_read2_b32 v[168:169], v11 offset0:128 offset1:129
    ds_read2_b32 v[170:171], v11 offset0:130 offset1:131
    ds_read2_b32 v[172:173], v11 offset0:112 offset1:113
    ds_read2_b32 v[174:175], v11 offset0:114 offset1:115
    ds_read2_b32 v[176:177], v11 offset0:96 offset1:97
    ds_read2_b32 v[178:179], v11 offset0:98 offset1:99
    v_and_b32 v10, 3, v3
    v_mul_u32_u24 v10, 2064, v10
    v_lshrrev_b32 v14, 2, v3
    v_lshl_add_u32 v10, v14, 6, v10
    v_lshl_add_u32 v10, v4, 4, v10
    v_add_u32 v10, s66, v10
    s_waitcnt vmcnt(3)
    v_cmp_eq_u32 vcc, 0, v0
    s_and_b32 s38, vcc_lo, 0xffff
    s_cbranch_scc1 pb_21
    s_add_u32 s38, s34, 0
    buffer_load_dwordx4 v[84:87], v5, s[24:27], s38 offen offset:0 sc0
    s_add_u32 s38, s34, 0
    buffer_load_dwordx4 v[88:91], v5, s[24:27], s38 offen offset:1024 sc0
    s_add_u32 s38, s34, 4096
    buffer_load_dwordx4 v[92:95], v5, s[24:27], s38 offen offset:0 sc0
    s_add_u32 s38, s34, 4096
    buffer_load_dwordx4 v[96:99], v5, s[24:27], s38 offen offset:1024 sc0
    s_waitcnt lgkmcnt(0)
    ds_read_b128 v[20:23], v10 offset:13568
    ds_read_b128 v[24:27], v10 offset:13824
    ds_read_b128 v[28:31], v10 offset:13760
    ds_read_b128 v[32:35], v10 offset:13696
    ds_read_b128 v[36:39], v10 offset:13632
    ds_read_b128 v[40:43], v10 offset:13568
    ds_read_b128 v[44:47], v10 offset:14080
    ds_read_b128 v[48:51], v10 offset:14016
    ds_read_b128 v[52:55], v10 offset:13952
    ds_read_b128 v[56:59], v10 offset:13888
    s_add_u32 s38, s34, 8192
    buffer_load_dwordx4 v[100:103], v5, s[24:27], s38 offen offset:0 sc0
    s_add_u32 s38, s34, 8192
    buffer_load_dwordx4 v[104:107], v5, s[24:27], s38 offen offset:1024 sc0
    s_waitcnt lgkmcnt(9)
    v_mfma_f32_16x16x32_f16 v[180:183], v[20:23], v[160:163], 0
    s_add_u32 s38, s34, 12288
    buffer_load_dwordx4 v[108:111], v5, s[24:27], s38 offen offset:0 sc0
    s_waitcnt lgkmcnt(8)
    v_mfma_f32_16x16x32_f16 v[184:187], v[24:27], v[160:163], 0
    s_add_u32 s38, s34, 12288
    buffer_load_dwordx4 v[112:115], v5, s[24:27], s38 offen offset:1024 sc0
    s_waitcnt lgkmcnt(7)
    v_mfma_f32_16x16x32_f16 v[184:187], v[28:31], v[164:167], v[184:187]
    s_add_u32 s38, s34, 16384
    buffer_load_dwordx4 v[116:119], v5, s[24:27], s38 offen offset:0 sc0
    s_waitcnt lgkmcnt(6)
    v_mfma_f32_16x16x32_f16 v[184:187], v[32:35], v[168:171], v[184:187]
    s_add_u32 s38, s34, 16384
    buffer_load_dwordx4 v[120:123], v5, s[24:27], s38 offen offset:1024 sc0
    s_waitcnt lgkmcnt(5)
    v_mfma_f32_16x16x32_f16 v[184:187], v[36:39], v[172:175], v[184:187]
    s_add_u32 s38, s34, 20480
    buffer_load_dwordx4 v[124:127], v5, s[24:27], s38 offen offset:0 sc0
    s_waitcnt lgkmcnt(4)
    v_mfma_f32_16x16x32_f16 v[184:187], v[40:43], v[176:179], v[184:187]
    s_add_u32 s38, s34, 20480
    buffer_load_dwordx4 v[128:131], v5, s[24:27], s38 offen offset:1024 sc0
    s_waitcnt lgkmcnt(3)
    v_mfma_f32_16x16x32_f16 v[188:191], v[44:47], v[160:163], 0
    s_add_u32 s38, s34, 24576
    buffer_load_dwordx4 v[144:147], v5, s[24:27], s38 offen offset:0 sc0
    s_waitcnt lgkmcnt(2)
    v_mfma_f32_16x16x32_f16 v[188:191], v[48:51], v[164:167], v[188:191]
    s_add_u32 s38, s34, 24576
    buffer_load_dwordx4 v[148:151], v5, s[24:27], s38 offen offset:1024 sc0
    s_waitcnt lgkmcnt(1)
    v_mfma_f32_16x16x32_f16 v[188:191], v[52:55], v[168:171], v[188:191]
    s_add_u32 s38, s34, 28672
    buffer_load_dwordx4 v[152:155], v5, s[24:27], s38 offen offset:0 sc0
    s_waitcnt lgkmcnt(0)
    v_mfma_f32_16x16x32_f16 v[188:191], v[56:59], v[172:175], v[188:191]
    s_add_u32 s38, s34, 28672
    buffer_load_dwordx4 v[156:159], v5, s[24:27], s38 offen offset:1024 sc0
    s_branch pj_22
pb_21:
    s_waitcnt lgkmcnt(0)
    ds_read_b128 v[20:23], v10 offset:13568
    ds_read_b128 v[24:27], v10 offset:13824
    ds_read_b128 v[28:31], v10 offset:13760
    ds_read_b128 v[32:35], v10 offset:13696
    ds_read_b128 v[36:39], v10 offset:13632
    ds_read_b128 v[40:43], v10 offset:13568
    ds_read_b128 v[44:47], v10 offset:14080
    ds_read_b128 v[48:51], v10 offset:14016
    ds_read_b128 v[52:55], v10 offset:13952
    ds_read_b128 v[56:59], v10 offset:13888
    s_waitcnt lgkmcnt(9)
    v_mfma_f32_16x16x32_f16 v[180:183], v[20:23], v[160:163], 0
    s_waitcnt lgkmcnt(8)
    v_mfma_f32_16x16x32_f16 v[184:187], v[24:27], v[160:163], 0
    s_waitcnt lgkmcnt(7)
    v_mfma_f32_16x16x32_f16 v[184:187], v[28:31], v[164:167], v[184:187]
    s_waitcnt lgkmcnt(6)
    v_mfma_f32_16x16x32_f16 v[184:187], v[32:35], v[168:171], v[184:187]
    s_waitcnt lgkmcnt(5)
    v_mfma_f32_16x16x32_f16 v[184:187], v[36:39], v[172:175], v[184:187]
    s_waitcnt lgkmcnt(4)
    v_mfma_f32_16x16x32_f16 v[184:187], v[40:43], v[176:179], v[184:187]
    s_waitcnt lgkmcnt(3)
    v_mfma_f32_16x16x32_f16 v[188:191], v[44:47], v[160:163], 0
    s_waitcnt lgkmcnt(2)
    v_mfma_f32_16x16x32_f16 v[188:191], v[48:51], v[164:167], v[188:191]
    s_waitcnt lgkmcnt(1)
    v_mfma_f32_16x16x32_f16 v[188:191], v[52:55], v[168:171], v[188:191]
    s_waitcnt vmcnt(0)
    v_cmp_eq_u32 vcc, 0, v134
    s_and_b32 s38, vcc_lo, 0xffff
    s_cbranch_scc0 ef_23
    s_lshl_b32 s38, s30, 2
    s_sub_u32 s38, s97, s38
    v_mul_u32_u24 v6, 4, v1
    s_mov_b32 s42, 0
    s_mov_b32 exec_hi, 0
    s_mov_b32 exec_lo, 0xffff
pf_24:
    buffer_load_dword v7, v6, s[24:27], s38 offen sc1
    s_waitcnt vmcnt(0)
    v_cmp_eq_u32 vcc, 0, v7
    s_add_u32 s42, s42, 1
    s_cmp_gt_u32 s42, 30000
    s_cbranch_scc1 pfd_25
    s_cmp_eq_u64 vcc, 0
    s_cbranch_scc1 pfd_25
    s_sleep 6
    s_branch pf_24
pfd_25:
    s_mov_b64 exec, -1
ef_23:
    s_waitcnt lgkmcnt(0)
    v_mfma_f32_16x16x32_f16 v[188:191], v[56:59], v[172:175], v[188:191]
    s_add_u32 s38, s34, 0
    buffer_load_dwordx4 v[84:87], v5, s[24:27], s38 offen offset:0 sc0
    s_add_u32 s38, s34, 0
    buffer_load_dwordx4 v[88:91], v5, s[24:27], s38 offen offset:1024 sc0
    s_add_u32 s38, s34, 4096
    buffer_load_dwordx4 v[92:95], v5, s[24:27], s38 offen offset:0 sc0
    s_add_u32 s38, s34, 4096
    buffer_load_dwordx4 v[96:99], v5, s[24:27], s38 offen offset:1024 sc0
    s_add_u32 s38, s34, 8192
    buffer_load_dwordx4 v[100:103], v5, s[24:27], s38 offen offset:0 sc0
    s_add_u32 s38, s34, 8192
    buffer_load_dwordx4 v[104:107], v5, s[24:27], s38 offen offset:1024 sc0
    s_add_u32 s38, s34, 12288
    buffer_load_dwordx4 v[108:111], v5, s[24:27], s38 offen offset:0 sc0
    s_add_u32 s38, s34, 12288
    buffer_load_dwordx4 v[112:115], v5, s[24:27], s38 offen offset:1024 sc0
    s_add_u32 s38, s34, 16384
    buffer_load_dwordx4 v[116:119], v5, s[24:27], s38 offen offset:0 sc0
    s_add_u32 s38, s34, 16384
    buffer_load_dwordx4 v[120:123], v5, s[24:27], s38 offen offset:1024 sc0
    s_add_u32 s38, s34, 20480
    buffer_load_dwordx4 v[124:127], v5, s[24:27], s38 offen offset:0 sc0
    s_add_u32 s38, s34, 20480
    buffer_load_dwordx4 v[128:131], v5, s[24:27], s38 offen offset:1024 sc0
    s_add_u32 s38, s34, 24576
    buffer_load_dwordx4 v[144:147], v5, s[24:27], s38 offen offset:0 sc0
    s_add_u32 s38, s34, 24576
    buffer_load_dwordx4 v[148:151], v5, s[24:27], s38 offen offset:1024 sc0
    s_add_u32 s38, s34, 28672
    buffer_load_dwordx4 v[152:155], v5, s[24:27], s38 offen offset:0 sc0
    s_add_u32 s38, s34, 28672
    buffer_load_dwordx4 v[156:159], v5, s[24:27], s38 offen offset:1024 sc0
pj_22:
    s_barrier
    ds_read_b128 v[52:55], v19 offset:0
    ds_read_b128 v[56:59], v19 offset:2048
    ds_read_b128 v[60:63], v19 offset:4096
    ds_read_b128 v[64:67], v19 offset:6144
    ds_read_b128 v[236:239], v10 offset:13824
    ds_read_b128 v[240:243], v10 offset:14336
    v_mov_b32 v15, 0xbdd2d3e8
    s_waitcnt vmcnt(14)
    s_waitcnt lgkmcnt(0)
    s_barrier
    v_mfma_f32_16x16x32_bf16 v[20:23], v[84:87], v[52:55], 0
    ds_read_b128 v[68:71], v19 offset:8192
    ds_read_b128 v[72:75], v19 offset:10240
    ds_read_b128 v[76:79], v19 offset:12288
    ds_read_b128 v[80:83], v19 offset:14336
    ds_read_b128 v[244:247], v10 offset:14272
    ds_read_b128 v[248:251], v10 offset:14208
    v_mfma_f32_16x16x32_bf16 v[24:27], v[88:91], v[52:55], 0
    v_mfma_f32_16x16x32_bf16 v[28:31], v[84:87], v[56:59], 0
    s_add_u32 m0, s75, 0
    s_add_u32 s39, s67, 1536
    buffer_load_dwordx4 v18, s[20:23], s39 offen lds
    v_mfma_f32_16x16x32_bf16 v[32:35], v[88:91], v[56:59], 0
    v_mfma_f32_16x16x32_bf16 v[36:39], v[84:87], v[60:63], 0
    v_mfma_f32_16x16x32_bf16 v[40:43], v[88:91], v[60:63], 0
    v_mfma_f32_16x16x32_bf16 v[44:47], v[84:87], v[64:67], 0
    v_mfma_f32_16x16x32_bf16 v[48:51], v[88:91], v[64:67], 0
    v_mfma_f32_16x16x32_f16 v[188:191], v[236:239], v[176:179], v[188:191]
    v_mfma_f32_16x16x32_f16 v[192:195], v[240:243], v[160:163], 0
    s_waitcnt vmcnt(13)
    s_waitcnt lgkmcnt(0)
    v_mfma_f32_16x16x32_bf16 v[20:23], v[92:95], v[68:71], v[20:23]
    ds_read_b128 v[52:55], v19 offset:16384
    ds_read_b128 v[56:59], v19 offset:18432
    ds_read_b128 v[60:63], v19 offset:20480
    ds_read_b128 v[64:67], v19 offset:22528
    ds_read_b128 v[236:239], v10 offset:14144
    ds_read_b128 v[240:243], v10 offset:14080
    v_mfma_f32_16x16x32_bf16 v[24:27], v[96:99], v[68:71], v[24:27]
    v_mfma_f32_16x16x32_bf16 v[28:31], v[92:95], v[72:75], v[28:31]
    s_add_u32 s38, s34, 32768
    buffer_load_dwordx4 v[84:87], v5, s[24:27], s38 offen offset:0 sc0
    v_mfma_f32_16x16x32_bf16 v[32:35], v[96:99], v[72:75], v[32:35]
    v_mfma_f32_16x16x32_bf16 v[36:39], v[92:95], v[76:79], v[36:39]
    s_add_u32 s38, s34, 32768
    buffer_load_dwordx4 v[88:91], v5, s[24:27], s38 offen offset:1024 sc0
    v_mfma_f32_16x16x32_bf16 v[40:43], v[96:99], v[76:79], v[40:43]
    v_mfma_f32_16x16x32_bf16 v[44:47], v[92:95], v[80:83], v[44:47]
    v_mfma_f32_16x16x32_bf16 v[48:51], v[96:99], v[80:83], v[48:51]
    v_mfma_f32_16x16x32_f16 v[192:195], v[244:247], v[164:167], v[192:195]
    v_mfma_f32_16x16x32_f16 v[192:195], v[248:251], v[168:171], v[192:195]
    s_waitcnt vmcnt(13)
    s_waitcnt lgkmcnt(0)
    s_barrier
    v_mfma_f32_16x16x32_bf16 v[20:23], v[100:103], v[52:55], v[20:23]
    ds_read_b128 v[68:71], v19 offset:24576
    ds_read_b128 v[72:75], v19 offset:26624
    ds_read_b128 v[76:79], v19 offset:28672
    ds_read_b128 v[80:83], v19 offset:30720
    ds_read_b128 v[244:247], v10 offset:14592
    ds_read_b128 v[248:251], v10 offset:14528
    v_mfma_f32_16x16x32_bf16 v[24:27], v[104:107], v[52:55], v[24:27]
    v_mfma_f32_16x16x32_bf16 v[28:31], v[100:103], v[56:59], v[28:31]
    s_add_u32 m0, s75, 8192
    s_add_u32 s39, s67, 1664
    buffer_load_dwordx4 v18, s[20:23], s39 offen lds
    v_mfma_f32_16x16x32_bf16 v[32:35], v[104:107], v[56:59], v[32:35]
    v_mfma_f32_16x16x32_bf16 v[36:39], v[100:103], v[60:63], v[36:39]
    s_add_u32 m0, s75, 16384
    s_add_u32 s39, s67, 1792
    buffer_load_dwordx4 v18, s[20:23], s39 offen lds
    v_mfma_f32_16x16x32_bf16 v[40:43], v[104:107], v[60:63], v[40:43]
    v_mfma_f32_16x16x32_bf16 v[44:47], v[100:103], v[64:67], v[44:47]
    s_add_u32 s38, s34, 36864
    buffer_load_dwordx4 v[92:95], v5, s[24:27], s38 offen offset:0 sc0
    v_mfma_f32_16x16x32_bf16 v[48:51], v[104:107], v[64:67], v[48:51]
    v_mfma_f32_16x16x32_f16 v[192:195], v[236:239], v[172:175], v[192:195]
    s_add_u32 s38, s34, 36864
    buffer_load_dwordx4 v[96:99], v5, s[24:27], s38 offen offset:1024 sc0
    v_mfma_f32_16x16x32_f16 v[192:195], v[240:243], v[176:179], v[192:195]
    v_lshlrev_b32 v6, 16, v136
    v_and_b32 v7, 0xffff0000, v136
    v_mul_f32 v132, v6, v6
    v_mul_f32 v133, v7, v7
    v_fmaak_f32 v132, v132, v15, 0xc0135761
    v_fmaak_f32 v133, v133, v15, 0xc0135761
    v_mul_f32 v132, v132, v6
    v_mul_f32 v133, v133, v7
    v_exp_f32 v132, v132
    v_exp_f32 v133, v133
    v_add_f32 v132, 1.0, v132
    v_add_f32 v133, 1.0, v133
    v_rcp_f32 v132, v132
    v_rcp_f32 v133, v133
    s_nop 0
    v_mul_f32 v6, v6, v132
    v_mul_f32 v7, v7, v133
    v_cvt_pk_bf16_f32 v136, v6, v7
    s_waitcnt vmcnt(15)
    s_waitcnt lgkmcnt(0)
    v_mfma_f32_16x16x32_bf16 v[20:23], v[108:111], v[68:71], v[20:23]
    ds_read_b128 v[52:55], v19 offset:32768
    ds_read_b128 v[56:59], v19 offset:34816
    ds_read_b128 v[60:63], v19 offset:36864
    ds_read_b128 v[64:67], v19 offset:38912
    ds_read_b128 v[236:239], v10 offset:14464
    ds_read_b128 v[240:243], v10 offset:14400
    v_mfma_f32_16x16x32_bf16 v[24:27], v[112:115], v[68:71], v[24:27]
    v_mfma_f32_16x16x32_bf16 v[28:31], v[108:111], v[72:75], v[28:31]
    s_add_u32 s38, s34, 40960
    buffer_load_dwordx4 v[100:103], v5, s[24:27], s38 offen offset:0 sc0
    v_mfma_f32_16x16x32_bf16 v[32:35], v[112:115], v[72:75], v[32:35]
    v_mfma_f32_16x16x32_bf16 v[36:39], v[108:111], v[76:79], v[36:39]
    s_add_u32 s38, s34, 40960
    buffer_load_dwordx4 v[104:107], v5, s[24:27], s38 offen offset:1024 sc0
    v_mfma_f32_16x16x32_bf16 v[40:43], v[112:115], v[76:79], v[40:43]
    v_mfma_f32_16x16x32_bf16 v[44:47], v[108:111], v[80:83], v[44:47]
    s_lshl_b32 s38, s30, 2
    s_sub_u32 s38, s97, s38
    v_min_u32 v6, 59, v1
    v_lshlrev_b32 v6, 2, v6
    v_add_u32 v6, 18119552, v6
    v_or_b32 v7, 16, v1
    v_lshlrev_b32 v7, 2, v7
    v_add_u32 v7, s38, v7
    v_cmp_gt_u32 vcc, 32, v1
    v_cndmask_b32 v6, v6, v7, vcc
    buffer_load_dword v0, v6, s[24:27], 0 offen sc1
    v_mfma_f32_16x16x32_bf16 v[48:51], v[112:115], v[80:83], v[48:51]
    v_mfma_f32_16x16x32_f16 v[196:199], v[244:247], v[160:163], 0
    v_mfma_f32_16x16x32_f16 v[196:199], v[248:251], v[164:167], v[196:199]
    s_waitcnt vmcnt(16)
    s_waitcnt lgkmcnt(0)
    s_barrier
    v_mfma_f32_16x16x32_bf16 v[20:23], v[116:119], v[52:55], v[20:23]
    ds_read_b128 v[68:71], v19 offset:40960
    ds_read_b128 v[72:75], v19 offset:43008
    ds_read_b128 v[76:79], v19 offset:45056
    ds_read_b128 v[80:83], v19 offset:47104
    ds_read_b128 v[244:247], v10 offset:14336
    ds_read_b128 v[248:251], v10 offset:14848
    v_mfma_f32_16x16x32_bf16 v[24:27], v[120:123], v[52:55], v[24:27]
    v_mfma_f32_16x16x32_bf16 v[28:31], v[116:119], v[56:59], v[28:31]
    s_add_u32 m0, s75, 24576
    s_add_u32 s39, s67, 1920
    buffer_load_dwordx4 v18, s[20:23], s39 offen lds
    v_mfma_f32_16x16x32_bf16 v[32:35], v[120:123], v[56:59], v[32:35]
    v_mfma_f32_16x16x32_bf16 v[36:39], v[116:119], v[60:63], v[36:39]
    s_add_u32 m0, s75, 32768
    s_add_u32 s39, s67, 2048
    buffer_load_dwordx4 v18, s[20:23], s39 offen lds
    v_mfma_f32_16x16x32_bf16 v[40:43], v[120:123], v[60:63], v[40:43]
    v_mfma_f32_16x16x32_bf16 v[44:47], v[116:119], v[64:67], v[44:47]
    s_add_u32 s38, s34, 45056
    buffer_load_dwordx4 v[108:111], v5, s[24:27], s38 offen offset:0 sc0
    v_mfma_f32_16x16x32_bf16 v[48:51], v[120:123], v[64:67], v[48:51]
    v_mfma_f32_16x16x32_f16 v[196:199], v[236:239], v[168:171], v[196:199]
    s_add_u32 s38, s34, 45056
    buffer_load_dwordx4 v[112:115], v5, s[24:27], s38 offen offset:1024 sc0
    v_mfma_f32_16x16x32_f16 v[196:199], v[240:243], v[172:175], v[196:199]
    v_lshlrev_b32 v6, 16, v137
    v_and_b32 v7, 0xffff0000, v137
    v_mul_f32 v132, v6, v6
    v_mul_f32 v133, v7, v7
    v_fmaak_f32 v132, v132, v15, 0xc0135761
    v_fmaak_f32 v133, v133, v15, 0xc0135761
    v_mul_f32 v132, v132, v6
    v_mul_f32 v133, v133, v7
    v_exp_f32 v132, v132
    v_exp_f32 v133, v133
    v_add_f32 v132, 1.0, v132
    v_add_f32 v133, 1.0, v133
    v_rcp_f32 v132, v132
    v_rcp_f32 v133, v133
    s_nop 0
    v_mul_f32 v6, v6, v132
    v_mul_f32 v7, v7, v133
    v_cvt_pk_bf16_f32 v137, v6, v7
    s_waitcnt vmcnt(18)
    s_waitcnt lgkmcnt(0)
    v_mfma_f32_16x16x32_bf16 v[20:23], v[124:127], v[68:71], v[20:23]
    ds_read_b128 v[52:55], v19 offset:49152
    ds_read_b128 v[56:59], v19 offset:51200
    ds_read_b128 v[60:63], v19 offset:53248
    ds_read_b128 v[64:67], v19 offset:55296
    ds_read_b128 v[236:239], v10 offset:14784
    ds_read_b128 v[240:243], v10 offset:14720
    v_mfma_f32_16x16x32_bf16 v[24:27], v[128:131], v[68:71], v[24:27]
    v_mfma_f32_16x16x32_bf16 v[28:31], v[124:127], v[72:75], v[28:31]
    s_add_u32 s38, s34, 49152
    buffer_load_dwordx4 v[116:119], v5, s[24:27], s38 offen offset:0 sc0
    v_mfma_f32_16x16x32_bf16 v[32:35], v[128:131], v[72:75], v[32:35]
    v_mfma_f32_16x16x32_bf16 v[36:39], v[124:127], v[76:79], v[36:39]
    s_add_u32 s38, s34, 49152
    buffer_load_dwordx4 v[120:123], v5, s[24:27], s38 offen offset:1024 sc0
    v_mfma_f32_16x16x32_bf16 v[40:43], v[128:131], v[76:79], v[40:43]
    v_mfma_f32_16x16x32_bf16 v[44:47], v[124:127], v[80:83], v[44:47]
    v_mfma_f32_16x16x32_bf16 v[48:51], v[128:131], v[80:83], v[48:51]
    v_mfma_f32_16x16x32_f16 v[196:199], v[244:247], v[176:179], v[196:199]
    v_mfma_f32_16x16x32_f16 v[200:203], v[248:251], v[160:163], 0
    s_waitcnt vmcnt(18)
    s_waitcnt lgkmcnt(0)
    s_barrier
    v_mfma_f32_16x16x32_bf16 v[20:23], v[144:147], v[52:55], v[20:23]
    ds_read_b128 v[68:71], v19 offset:57344
    ds_read_b128 v[72:75], v19 offset:59392
    ds_read_b128 v[76:79], v19 offset:61440
    ds_read_b128 v[80:83], v19 offset:63488
    ds_read_b128 v[244:247], v10 offset:14656
    ds_read_b128 v[248:251], v10 offset:14592
    v_mfma_f32_16x16x32_bf16 v[24:27], v[148:151], v[52:55], v[24:27]
    v_mfma_f32_16x16x32_bf16 v[28:31], v[144:147], v[56:59], v[28:31]
    s_add_u32 m0, s75, 40960
    s_add_u32 s39, s67, 2176
    buffer_load_dwordx4 v18, s[20:23], s39 offen lds
    v_mfma_f32_16x16x32_bf16 v[32:35], v[148:151], v[56:59], v[32:35]
    v_mfma_f32_16x16x32_bf16 v[36:39], v[144:147], v[60:63], v[36:39]
    s_add_u32 m0, s75, 49152
    s_add_u32 s39, s67, 2304
    buffer_load_dwordx4 v18, s[20:23], s39 offen lds
    v_mfma_f32_16x16x32_bf16 v[40:43], v[148:151], v[60:63], v[40:43]
    v_mfma_f32_16x16x32_bf16 v[44:47], v[144:147], v[64:67], v[44:47]
    s_add_u32 s38, s34, 53248
    buffer_load_dwordx4 v[124:127], v5, s[24:27], s38 offen offset:0 sc0
    v_mfma_f32_16x16x32_bf16 v[48:51], v[148:151], v[64:67], v[48:51]
    v_mfma_f32_16x16x32_f16 v[200:203], v[236:239], v[164:167], v[200:203]
    s_add_u32 s38, s34, 53248
    buffer_load_dwordx4 v[128:131], v5, s[24:27], s38 offen offset:1024 sc0
    v_mfma_f32_16x16x32_f16 v[200:203], v[240:243], v[168:171], v[200:203]
    v_lshlrev_b32 v6, 16, v138
    v_and_b32 v7, 0xffff0000, v138
    v_mul_f32 v132, v6, v6
    v_mul_f32 v133, v7, v7
    v_fmaak_f32 v132, v132, v15, 0xc0135761
    v_fmaak_f32 v133, v133, v15, 0xc0135761
    v_mul_f32 v132, v132, v6
    v_mul_f32 v133, v133, v7
    v_exp_f32 v132, v132
    v_exp_f32 v133, v133
    v_add_f32 v132, 1.0, v132
    v_add_f32 v133, 1.0, v133
    v_rcp_f32 v132, v132
    v_rcp_f32 v133, v133
    s_nop 0
    v_mul_f32 v6, v6, v132
    v_mul_f32 v7, v7, v133
    v_cvt_pk_bf16_f32 v138, v6, v7
    s_waitcnt vmcnt(20)
    s_waitcnt lgkmcnt(0)
    v_mfma_f32_16x16x32_bf16 v[20:23], v[152:155], v[68:71], v[20:23]
    ds_read_b128 v[52:55], v135 offset:0
    ds_read_b128 v[56:59], v135 offset:2048
    ds_read_b128 v[60:63], v135 offset:4096
    ds_read_b128 v[64:67], v135 offset:6144
    ds_read_b128 v[236:239], v10 offset:15104
    ds_read_b128 v[240:243], v10 offset:15040
    v_mfma_f32_16x16x32_bf16 v[24:27], v[156:159], v[68:71], v[24:27]
    v_mfma_f32_16x16x32_bf16 v[28:31], v[152:155], v[72:75], v[28:31]
    s_add_u32 s38, s34, 57344
    buffer_load_dwordx4 v[144:147], v5, s[24:27], s38 offen offset:0 sc0
    v_mfma_f32_16x16x32_bf16 v[32:35], v[156:159], v[72:75], v[32:35]
    v_mfma_f32_16x16x32_bf16 v[36:39], v[152:155], v[76:79], v[36:39]
    s_add_u32 s38, s34, 57344
    buffer_load_dwordx4 v[148:151], v5, s[24:27], s38 offen offset:1024 sc0
    v_mfma_f32_16x16x32_bf16 v[40:43], v[156:159], v[76:79], v[40:43]
    v_mfma_f32_16x16x32_bf16 v[44:47], v[152:155], v[80:83], v[44:47]
    v_mfma_f32_16x16x32_bf16 v[48:51], v[156:159], v[80:83], v[48:51]
    v_mfma_f32_16x16x32_f16 v[200:203], v[244:247], v[172:175], v[200:203]
    v_mfma_f32_16x16x32_f16 v[200:203], v[248:251], v[176:179], v[200:203]
    s_waitcnt vmcnt(19)
    s_waitcnt lgkmcnt(0)
    s_barrier
    v_mfma_f32_16x16x32_bf16 v[20:23], v[84:87], v[52:55], v[20:23]
    ds_read_b128 v[68:71], v135 offset:8192
    ds_read_b128 v[72:75], v135 offset:10240
    ds_read_b128 v[76:79], v135 offset:12288
    ds_read_b128 v[80:83], v135 offset:14336
    ds_read_b128 v[244:247], v10 offset:14976
    ds_read_b128 v[248:251], v10 offset:14912
    v_mfma_f32_16x16x32_bf16 v[24:27], v[88:91], v[52:55], v[24:27]
    v_mfma_f32_16x16x32_bf16 v[28:31], v[84:87], v[56:59], v[28:31]
    s_add_u32 m0, s75, 57344
    s_add_u32 s39, s67, 2432
    buffer_load_dwordx4 v18, s[20:23], s39 offen lds
    v_mfma_f32_16x16x32_bf16 v[32:35], v[88:91], v[56:59], v[32:35]
    v_mfma_f32_16x16x32_bf16 v[36:39], v[84:87], v[60:63], v[36:39]
    s_add_u32 m0, s75, 65536
    s_add_u32 s39, s67, 2560
    buffer_load_dwordx4 v18, s[20:23], s39 offen lds
    v_mfma_f32_16x16x32_bf16 v[40:43], v[88:91], v[60:63], v[40:43]
    v_mfma_f32_16x16x32_bf16 v[44:47], v[84:87], v[64:67], v[44:47]
    s_add_u32 s38, s34, 61440
    buffer_load_dwordx4 v[152:155], v5, s[24:27], s38 offen offset:0 sc0
    v_mfma_f32_16x16x32_bf16 v[48:51], v[88:91], v[64:67], v[48:51]
    v_mfma_f32_16x16x32_f16 v[204:207], v[236:239], v[160:163], 0
    s_add_u32 s38, s34, 61440
    buffer_load_dwordx4 v[156:159], v5, s[24:27], s38 offen offset:1024 sc0
    v_mfma_f32_16x16x32_f16 v[204:207], v[240:243], v[164:167], v[204:207]
    v_lshlrev_b32 v6, 16, v139
    v_and_b32 v7, 0xffff0000, v139
    v_mul_f32 v132, v6, v6
    v_mul_f32 v133, v7, v7
    v_fmaak_f32 v132, v132, v15, 0xc0135761
    v_fmaak_f32 v133, v133, v15, 0xc0135761
    v_mul_f32 v132, v132, v6
    v_mul_f32 v133, v133, v7
    v_exp_f32 v132, v132
    v_exp_f32 v133, v133
    v_add_f32 v132, 1.0, v132
    v_add_f32 v133, 1.0, v133
    v_rcp_f32 v132, v132
    v_rcp_f32 v133, v133
    s_nop 0
    v_mul_f32 v6, v6, v132
    v_mul_f32 v7, v7, v133
    v_cvt_pk_bf16_f32 v139, v6, v7
    s_waitcnt vmcnt(19)
    s_waitcnt vmcnt(16)
    v_cmp_eq_u32 vcc, 0, v0
    s_cmp_eq_u64 vcc, 0
    s_cbranch_scc1 fs_26
    s_lshl_b32 s38, s30, 2
    s_sub_u32 s38, s97, s38
    v_min_u32 v6, 59, v1
    v_lshlrev_b32 v6, 2, v6
    v_add_u32 v6, 18119552, v6
    v_or_b32 v7, 16, v1
    v_lshlrev_b32 v7, 2, v7
    v_add_u32 v7, s38, v7
    v_cmp_gt_u32 vcc, 32, v1
    v_cndmask_b32 v6, v6, v7, vcc
    v_mov_b32 v0, 0
    s_mov_b32 s42, 0
ck_27:
    v_cmp_eq_u32 vcc, 0, v0
    s_add_u32 s42, s42, 1
    s_cmp_gt_u32 s42, 30000
    s_cbranch_scc1 ckd_28
    s_cmp_eq_u64 vcc, 0
    s_cbranch_scc1 ckd_28
    s_sleep 2
    buffer_load_dword v0, v6, s[24:27], 0 offen sc1
    s_waitcnt vmcnt(0)
    s_branch ck_27
ckd_28:
fs_26:
    s_waitcnt lgkmcnt(0)
    v_mfma_f32_16x16x32_bf16 v[20:23], v[92:95], v[68:71], v[20:23]
    ds_read_b128 v[52:55], v135 offset:16384
    ds_read_b128 v[56:59], v135 offset:18432
    ds_read_b128 v[60:63], v135 offset:20480
    ds_read_b128 v[64:67], v135 offset:22528
    ds_read_b128 v[236:239], v10 offset:14848
    ds_read_b128 v[240:243], v10 offset:15360
    v_mfma_f32_16x16x32_bf16 v[24:27], v[96:99], v[68:71], v[24:27]
    v_mfma_f32_16x16x32_bf16 v[28:31], v[92:95], v[72:75], v[28:31]
    s_add_u32 s38, s34, 65536
    buffer_load_dwordx4 v[84:87], v5, s[24:27], s38 offen offset:0 sc0
    v_mfma_f32_16x16x32_bf16 v[32:35], v[96:99], v[72:75], v[32:35]
    v_mfma_f32_16x16x32_bf16 v[36:39], v[92:95], v[76:79], v[36:39]
    s_add_u32 s38, s34, 65536
    buffer_load_dwordx4 v[88:91], v5, s[24:27], s38 offen offset:1024 sc0
    v_mfma_f32_16x16x32_bf16 v[40:43], v[96:99], v[76:79], v[40:43]
    v_mfma_f32_16x16x32_bf16 v[44:47], v[92:95], v[80:83], v[44:47]
    v_mfma_f32_16x16x32_bf16 v[48:51], v[96:99], v[80:83], v[48:51]
    v_mfma_f32_16x16x32_f16 v[204:207], v[244:247], v[168:171], v[204:207]
    v_mfma_f32_16x16x32_f16 v[204:207], v[248:251], v[172:175], v[204:207]
    s_waitcnt lgkmcnt(0)
    s_barrier
    v_mfma_f32_16x16x32_bf16 v[20:23], v[100:103], v[52:55], v[20:23]
    ds_read_b128 v[68:71], v135 offset:24576
    ds_read_b128 v[72:75], v135 offset:26624
    ds_read_b128 v[76:79], v135 offset:28672
    ds_read_b128 v[80:83], v135 offset:30720
    ds_read_b128 v[244:247], v10 offset:15296
    ds_read_b128 v[248:251], v10 offset:15232
    v_mfma_f32_16x16x32_bf16 v[24:27], v[104:107], v[52:55], v[24:27]
    v_mfma_f32_16x16x32_bf16 v[28:31], v[100:103], v[56:59], v[28:31]
    s_add_u32 m0, s75, 73728
    s_add_u32 s39, s67, 2688
    buffer_load_dwordx4 v18, s[20:23], s39 offen lds
    v_mfma_f32_16x16x32_bf16 v[32:35], v[104:107], v[56:59], v[32:35]
    v_mfma_f32_16x16x32_bf16 v[36:39], v[100:103], v[60:63], v[36:39]
    s_add_u32 m0, s75, 81920
    s_add_u32 s39, s67, 2816
    buffer_load_dwordx4 v18, s[20:23], s39 offen lds
    v_mfma_f32_16x16x32_bf16 v[40:43], v[104:107], v[60:63], v[40:43]
    v_mfma_f32_16x16x32_bf16 v[44:47], v[100:103], v[64:67], v[44:47]
    s_add_u32 s38, s34, 69632
    buffer_load_dwordx4 v[92:95], v5, s[24:27], s38 offen offset:0 sc0
    v_mfma_f32_16x16x32_bf16 v[48:51], v[104:107], v[64:67], v[48:51]
    v_mfma_f32_16x16x32_f16 v[204:207], v[236:239], v[176:179], v[204:207]
    s_add_u32 s38, s34, 69632
    buffer_load_dwordx4 v[96:99], v5, s[24:27], s38 offen offset:1024 sc0
    v_mfma_f32_16x16x32_f16 v[208:211], v[240:243], v[160:163], 0
    v_lshlrev_b32 v6, 16, v140
    v_and_b32 v7, 0xffff0000, v140
    v_mul_f32 v132, v6, v6
    v_mul_f32 v133, v7, v7
    v_fmaak_f32 v132, v132, v15, 0xc0135761
    v_fmaak_f32 v133, v133, v15, 0xc0135761
    v_mul_f32 v132, v132, v6
    v_mul_f32 v133, v133, v7
    v_exp_f32 v132, v132
    v_exp_f32 v133, v133
    v_add_f32 v132, 1.0, v132
    v_add_f32 v133, 1.0, v133
    v_rcp_f32 v132, v132
    v_rcp_f32 v133, v133
    s_nop 0
    v_mul_f32 v6, v6, v132
    v_mul_f32 v7, v7, v133
    v_cvt_pk_bf16_f32 v140, v6, v7
    s_waitcnt vmcnt(18)
    s_waitcnt lgkmcnt(0)
    v_mfma_f32_16x16x32_bf16 v[20:23], v[108:111], v[68:71], v[20:23]
    ds_read_b128 v[52:55], v19 offset:0
    ds_read_b128 v[56:59], v19 offset:2048
    ds_read_b128 v[60:63], v19 offset:4096
    ds_read_b128 v[64:67], v19 offset:6144
    ds_read_b128 v[236:239], v10 offset:15168
    ds_read_b128 v[240:243], v10 offset:15104
    v_mfma_f32_16x16x32_bf16 v[24:27], v[112:115], v[68:71], v[24:27]
    v_mfma_f32_16x16x32_bf16 v[28:31], v[108:111], v[72:75], v[28:31]
    s_add_u32 s38, s34, 73728
    buffer_load_dwordx4 v[100:103], v5, s[24:27], s38 offen offset:0 sc0
    v_mfma_f32_16x16x32_bf16 v[32:35], v[112:115], v[72:75], v[32:35]
    v_mfma_f32_16x16x32_bf16 v[36:39], v[108:111], v[76:79], v[36:39]
    s_add_u32 s38, s34, 73728
    buffer_load_dwordx4 v[104:107], v5, s[24:27], s38 offen offset:1024 sc0
    v_mfma_f32_16x16x32_bf16 v[40:43], v[112:115], v[76:79], v[40:43]
    v_mfma_f32_16x16x32_bf16 v[44:47], v[108:111], v[80:83], v[44:47]
    v_mfma_f32_16x16x32_bf16 v[48:51], v[112:115], v[80:83], v[48:51]
    v_mfma_f32_16x16x32_f16 v[208:211], v[244:247], v[164:167], v[208:211]
    v_mfma_f32_16x16x32_f16 v[208:211], v[248:251], v[168:171], v[208:211]
    s_waitcnt vmcnt(18)
    s_waitcnt lgkmcnt(0)
    s_barrier
    v_mfma_f32_16x16x32_bf16 v[20:23], v[116:119], v[52:55], v[20:23]
    ds_read_b128 v[68:71], v19 offset:8192
    ds_read_b128 v[72:75], v19 offset:10240
    ds_read_b128 v[76:79], v19 offset:12288
    ds_read_b128 v[80:83], v19 offset:14336
    v_mfma_f32_16x16x32_bf16 v[24:27], v[120:123], v[52:55], v[24:27]
    v_mfma_f32_16x16x32_bf16 v[28:31], v[116:119], v[56:59], v[28:31]
    s_add_u32 m0, s75, 90112
    s_add_u32 s39, s67, 2944
    buffer_load_dwordx4 v18, s[20:23], s39 offen lds
    v_mfma_f32_16x16x32_bf16 v[32:35], v[120:123], v[56:59], v[32:35]
    v_mfma_f32_16x16x32_bf16 v[36:39], v[116:119], v[60:63], v[36:39]
    s_add_u32 m0, s75, 0
    s_add_u32 s39, s67, 3072
    buffer_load_dwordx4 v18, s[20:23], s39 offen lds
    v_mfma_f32_16x16x32_bf16 v[40:43], v[120:123], v[60:63], v[40:43]
    v_mfma_f32_16x16x32_bf16 v[44:47], v[116:119], v[64:67], v[44:47]
    s_add_u32 s38, s34, 77824
    buffer_load_dwordx4 v[108:111], v5, s[24:27], s38 offen offset:0 sc0
    v_mfma_f32_16x16x32_bf16 v[48:51], v[120:123], v[64:67], v[48:51]
    v_mfma_f32_16x16x32_f16 v[208:211], v[236:239], v[172:175], v[208:211]
    s_add_u32 s38, s34, 77824
    buffer_load_dwordx4 v[112:115], v5, s[24:27], s38 offen offset:1024 sc0
    v_mfma_f32_16x16x32_f16 v[208:211], v[240:243], v[176:179], v[208:211]
    v_lshlrev_b32 v6, 16, v141
    v_and_b32 v7, 0xffff0000, v141
    v_mul_f32 v132, v6, v6
    v_mul_f32 v133, v7, v7
    v_fmaak_f32 v132, v132, v15, 0xc0135761
    v_fmaak_f32 v133, v133, v15, 0xc0135761
    v_mul_f32 v132, v132, v6
    v_mul_f32 v133, v133, v7
    v_exp_f32 v132, v132
    v_exp_f32 v133, v133
    v_add_f32 v132, 1.0, v132
    v_add_f32 v133, 1.0, v133
    v_rcp_f32 v132, v132
    v_rcp_f32 v133, v133
    s_nop 0
    v_mul_f32 v6, v6, v132
    v_mul_f32 v7, v7, v133
    v_cvt_pk_bf16_f32 v141, v6, v7
    s_waitcnt vmcnt(18)
    s_waitcnt lgkmcnt(0)
    v_mfma_f32_16x16x32_bf16 v[20:23], v[124:127], v[68:71], v[20:23]
    ds_read_b128 v[52:55], v19 offset:16384
    ds_read_b128 v[56:59], v19 offset:18432
    ds_read_b128 v[60:63], v19 offset:20480
    ds_read_b128 v[64:67], v19 offset:22528
    v_mfma_f32_16x16x32_bf16 v[24:27], v[128:131], v[68:71], v[24:27]
    v_mfma_f32_16x16x32_bf16 v[28:31], v[124:127], v[72:75], v[28:31]
    s_add_u32 s38, s34, 81920
    buffer_load_dwordx4 v[116:119], v5, s[24:27], s38 offen offset:0 sc0
    v_mfma_f32_16x16x32_bf16 v[32:35], v[128:131], v[72:75], v[32:35]
    v_mfma_f32_16x16x32_bf16 v[36:39], v[124:127], v[76:79], v[36:39]
    s_add_u32 s38, s34, 81920
    buffer_load_dwordx4 v[120:123], v5, s[24:27], s38 offen offset:1024 sc0
    v_mfma_f32_16x16x32_bf16 v[40:43], v[128:131], v[76:79], v[40:43]
    v_mfma_f32_16x16x32_bf16 v[44:47], v[124:127], v[80:83], v[44:47]
    v_mfma_f32_16x16x32_bf16 v[48:51], v[128:131], v[80:83], v[48:51]
    s_waitcnt vmcnt(18)
    s_waitcnt lgkmcnt(0)
    s_barrier
    v_mfma_f32_16x16x32_bf16 v[20:23], v[144:147], v[52:55], v[20:23]
    ds_read_b128 v[68:71], v19 offset:24576
    ds_read_b128 v[72:75], v19 offset:26624
    ds_read_b128 v[76:79], v19 offset:28672
    ds_read_b128 v[80:83], v19 offset:30720
    v_mfma_f32_16x16x32_bf16 v[24:27], v[148:151], v[52:55], v[24:27]
    v_mfma_f32_16x16x32_bf16 v[28:31], v[144:147], v[56:59], v[28:31]
    s_add_u32 m0, s75, 8192
    s_add_u32 s39, s67, 3200
    buffer_load_dwordx4 v18, s[20:23], s39 offen lds
    v_mfma_f32_16x16x32_bf16 v[32:35], v[148:151], v[56:59], v[32:35]
    v_mfma_f32_16x16x32_bf16 v[36:39], v[144:147], v[60:63], v[36:39]
    s_add_u32 m0, s75, 16384
    s_add_u32 s39, s67, 3328
    buffer_load_dwordx4 v18, s[20:23], s39 offen lds
    v_mfma_f32_16x16x32_bf16 v[40:43], v[148:151], v[60:63], v[40:43]
    v_mfma_f32_16x16x32_bf16 v[44:47], v[144:147], v[64:67], v[44:47]
    s_add_u32 s38, s34, 86016
    buffer_load_dwordx4 v[124:127], v5, s[24:27], s38 offen offset:0 sc0
    v_mfma_f32_16x16x32_bf16 v[48:51], v[148:151], v[64:67], v[48:51]
    s_add_u32 s38, s34, 86016
    buffer_load_dwordx4 v[128:131], v5, s[24:27], s38 offen offset:1024 sc0
    v_lshlrev_b32 v6, 16, v142
    v_and_b32 v7, 0xffff0000, v142
    v_mul_f32 v132, v6, v6
    v_mul_f32 v133, v7, v7
    v_fmaak_f32 v132, v132, v15, 0xc0135761
    v_fmaak_f32 v133, v133, v15, 0xc0135761
    v_mul_f32 v132, v132, v6
    v_mul_f32 v133, v133, v7
    v_exp_f32 v132, v132
    v_exp_f32 v133, v133
    v_add_f32 v132, 1.0, v132
    v_add_f32 v133, 1.0, v133
    v_rcp_f32 v132, v132
    v_rcp_f32 v133, v133
    s_nop 0
    v_mul_f32 v6, v6, v132
    v_mul_f32 v7, v7, v133
    v_cvt_pk_bf16_f32 v142, v6, v7
    s_waitcnt vmcnt(18)
    s_waitcnt lgkmcnt(0)
    v_mfma_f32_16x16x32_bf16 v[20:23], v[152:155], v[68:71], v[20:23]
    ds_read_b128 v[52:55], v19 offset:32768
    ds_read_b128 v[56:59], v19 offset:34816
    ds_read_b128 v[60:63], v19 offset:36864
    ds_read_b128 v[64:67], v19 offset:38912
    v_mfma_f32_16x16x32_bf16 v[24:27], v[156:159], v[68:71], v[24:27]
    v_mfma_f32_16x16x32_bf16 v[28:31], v[152:155], v[72:75], v[28:31]
    s_add_u32 s38, s34, 90112
    buffer_load_dwordx4 v[144:147], v5, s[24:27], s38 offen offset:0 sc0
    v_mfma_f32_16x16x32_bf16 v[32:35], v[156:159], v[72:75], v[32:35]
    v_mfma_f32_16x16x32_bf16 v[36:39], v[152:155], v[76:79], v[36:39]
    s_add_u32 s38, s34, 90112
    buffer_load_dwordx4 v[148:151], v5, s[24:27], s38 offen offset:1024 sc0
    v_mfma_f32_16x16x32_bf16 v[40:43], v[156:159], v[76:79], v[40:43]
    v_mfma_f32_16x16x32_bf16 v[44:47], v[152:155], v[80:83], v[44:47]
    v_mfma_f32_16x16x32_bf16 v[48:51], v[156:159], v[80:83], v[48:51]
    s_waitcnt vmcnt(18)
    s_waitcnt lgkmcnt(0)
    s_barrier
    v_mfma_f32_16x16x32_bf16 v[20:23], v[84:87], v[52:55], v[20:23]
    ds_read_b128 v[68:71], v19 offset:40960
    ds_read_b128 v[72:75], v19 offset:43008
    ds_read_b128 v[76:79], v19 offset:45056
    ds_read_b128 v[80:83], v19 offset:47104
    v_mfma_f32_16x16x32_bf16 v[24:27], v[88:91], v[52:55], v[24:27]
    v_mfma_f32_16x16x32_bf16 v[28:31], v[84:87], v[56:59], v[28:31]
    s_add_u32 m0, s75, 24576
    s_add_u32 s39, s67, 3456
    buffer_load_dwordx4 v18, s[20:23], s39 offen lds
    v_mfma_f32_16x16x32_bf16 v[32:35], v[88:91], v[56:59], v[32:35]
    v_mfma_f32_16x16x32_bf16 v[36:39], v[84:87], v[60:63], v[36:39]
    s_add_u32 m0, s75, 32768
    s_add_u32 s39, s67, 3584
    buffer_load_dwordx4 v18, s[20:23], s39 offen lds
    v_mfma_f32_16x16x32_bf16 v[40:43], v[88:91], v[60:63], v[40:43]
    v_mfma_f32_16x16x32_bf16 v[44:47], v[84:87], v[64:67], v[44:47]
    s_add_u32 s38, s34, 94208
    buffer_load_dwordx4 v[152:155], v5, s[24:27], s38 offen offset:0 sc0
    v_mfma_f32_16x16x32_bf16 v[48:51], v[88:91], v[64:67], v[48:51]
    s_add_u32 s38, s34, 94208
    buffer_load_dwordx4 v[156:159], v5, s[24:27], s38 offen offset:1024 sc0
    v_lshlrev_b32 v6, 16, v143
    v_and_b32 v7, 0xffff0000, v143
    v_mul_f32 v132, v6, v6
    v_mul_f32 v133, v7, v7
    v_fmaak_f32 v132, v132, v15, 0xc0135761
    v_fmaak_f32 v133, v133, v15, 0xc0135761
    v_mul_f32 v132, v132, v6
    v_mul_f32 v133, v133, v7
    v_exp_f32 v132, v132
    v_exp_f32 v133, v133
    v_add_f32 v132, 1.0, v132
    v_add_f32 v133, 1.0, v133
    v_rcp_f32 v132, v132
    v_rcp_f32 v133, v133
    s_nop 0
    v_mul_f32 v6, v6, v132
    v_mul_f32 v7, v7, v133
    v_cvt_pk_bf16_f32 v143, v6, v7
    s_waitcnt vmcnt(18)
    s_waitcnt lgkmcnt(0)
    v_mfma_f32_16x16x32_bf16 v[20:23], v[92:95], v[68:71], v[20:23]
    ds_read_b128 v[52:55], v19 offset:49152
    ds_read_b128 v[56:59], v19 offset:51200
    ds_read_b128 v[60:63], v19 offset:53248
    ds_read_b128 v[64:67], v19 offset:55296
    v_mfma_f32_16x16x32_bf16 v[24:27], v[96:99], v[68:71], v[24:27]
    v_mfma_f32_16x16x32_bf16 v[28:31], v[92:95], v[72:75], v[28:31]
    s_add_u32 s38, s34, 98304
    buffer_load_dwordx4 v[84:87], v5, s[24:27], s38 offen offset:0 sc0
    v_mfma_f32_16x16x32_bf16 v[32:35], v[96:99], v[72:75], v[32:35]
    v_mfma_f32_16x16x32_bf16 v[36:39], v[92:95], v[76:79], v[36:39]
    s_add_u32 s38, s34, 98304
    buffer_load_dwordx4 v[88:91], v5, s[24:27], s38 offen offset:1024 sc0
    v_mfma_f32_16x16x32_bf16 v[40:43], v[96:99], v[76:79], v[40:43]
    v_mfma_f32_16x16x32_bf16 v[44:47], v[92:95], v[80:83], v[44:47]
    v_mfma_f32_16x16x32_bf16 v[48:51], v[96:99], v[80:83], v[48:51]
    s_waitcnt vmcnt(18)
    s_waitcnt lgkmcnt(0)
    s_barrier
    v_mfma_f32_16x16x32_bf16 v[20:23], v[100:103], v[52:55], v[20:23]
    ds_read_b128 v[68:71], v19 offset:57344
    ds_read_b128 v[72:75], v19 offset:59392
    ds_read_b128 v[76:79], v19 offset:61440
    ds_read_b128 v[80:83], v19 offset:63488
    v_mfma_f32_16x16x32_bf16 v[24:27], v[104:107], v[52:55], v[24:27]
    v_mfma_f32_16x16x32_bf16 v[28:31], v[100:103], v[56:59], v[28:31]
    s_add_u32 m0, s75, 40960
    s_add_u32 s39, s67, 3712
    buffer_load_dwordx4 v18, s[20:23], s39 offen lds
    v_mfma_f32_16x16x32_bf16 v[32:35], v[104:107], v[56:59], v[32:35]
    v_mfma_f32_16x16x32_bf16 v[36:39], v[100:103], v[60:63], v[36:39]
    s_add_u32 m0, s75, 49152
    s_add_u32 s39, s67, 3840
    buffer_load_dwordx4 v18, s[20:23], s39 offen lds
    v_mfma_f32_16x16x32_bf16 v[40:43], v[104:107], v[60:63], v[40:43]
    v_mfma_f32_16x16x32_bf16 v[44:47], v[100:103], v[64:67], v[44:47]
    s_add_u32 s38, s34, 102400
    buffer_load_dwordx4 v[92:95], v5, s[24:27], s38 offen offset:0 sc0
    v_mfma_f32_16x16x32_bf16 v[48:51], v[104:107], v[64:67], v[48:51]
    s_add_u32 s38, s34, 102400
    buffer_load_dwordx4 v[96:99], v5, s[24:27], s38 offen offset:1024 sc0
    s_waitcnt vmcnt(18)
    s_waitcnt lgkmcnt(0)
    v_mfma_f32_16x16x32_bf16 v[20:23], v[108:111], v[68:71], v[20:23]
    ds_read_b128 v[52:55], v135 offset:0
    ds_read_b128 v[56:59], v135 offset:2048
    ds_read_b128 v[60:63], v135 offset:4096
    ds_read_b128 v[64:67], v135 offset:6144
    v_mfma_f32_16x16x32_bf16 v[24:27], v[112:115], v[68:71], v[24:27]
    v_mfma_f32_16x16x32_bf16 v[28:31], v[108:111], v[72:75], v[28:31]
    s_add_u32 s38, s34, 106496
    buffer_load_dwordx4 v[100:103], v5, s[24:27], s38 offen offset:0 sc0
    v_mfma_f32_16x16x32_bf16 v[32:35], v[112:115], v[72:75], v[32:35]
    v_mfma_f32_16x16x32_bf16 v[36:39], v[108:111], v[76:79], v[36:39]
    s_add_u32 s38, s34, 106496
    buffer_load_dwordx4 v[104:107], v5, s[24:27], s38 offen offset:1024 sc0
    v_mfma_f32_16x16x32_bf16 v[40:43], v[112:115], v[76:79], v[40:43]
    v_mfma_f32_16x16x32_bf16 v[44:47], v[108:111], v[80:83], v[44:47]
    v_mfma_f32_16x16x32_bf16 v[48:51], v[112:115], v[80:83], v[48:51]
    s_waitcnt vmcnt(18)
    s_waitcnt lgkmcnt(0)
    s_barrier
    v_mfma_f32_16x16x32_bf16 v[20:23], v[116:119], v[52:55], v[20:23]
    ds_read_b128 v[68:71], v135 offset:8192
    ds_read_b128 v[72:75], v135 offset:10240
    ds_read_b128 v[76:79], v135 offset:12288
    ds_read_b128 v[80:83], v135 offset:14336
    v_mfma_f32_16x16x32_bf16 v[24:27], v[120:123], v[52:55], v[24:27]
    v_mfma_f32_16x16x32_bf16 v[28:31], v[116:119], v[56:59], v[28:31]
    s_add_u32 m0, s75, 57344
    s_add_u32 s39, s67, 3968
    buffer_load_dwordx4 v18, s[20:23], s39 offen lds
    v_mfma_f32_16x16x32_bf16 v[32:35], v[120:123], v[56:59], v[32:35]
    v_mfma_f32_16x16x32_bf16 v[36:39], v[116:119], v[60:63], v[36:39]
    s_add_u32 s38, s34, 110592
    buffer_load_dwordx4 v[108:111], v5, s[24:27], s38 offen offset:0 sc0
    v_mfma_f32_16x16x32_bf16 v[40:43], v[120:123], v[60:63], v[40:43]
    v_mfma_f32_16x16x32_bf16 v[44:47], v[116:119], v[64:67], v[44:47]
    s_add_u32 s38, s34, 110592
    buffer_load_dwordx4 v[112:115], v5, s[24:27], s38 offen offset:1024 sc0
    v_mfma_f32_16x16x32_bf16 v[48:51], v[120:123], v[64:67], v[48:51]
    s_waitcnt vmcnt(17)
    s_waitcnt lgkmcnt(0)
    v_mfma_f32_16x16x32_bf16 v[20:23], v[124:127], v[68:71], v[20:23]
    ds_read_b128 v[52:55], v135 offset:16384
    ds_read_b128 v[56:59], v135 offset:18432
    ds_read_b128 v[60:63], v135 offset:20480
    ds_read_b128 v[64:67], v135 offset:22528
    v_mfma_f32_16x16x32_bf16 v[24:27], v[128:131], v[68:71], v[24:27]
    v_mfma_f32_16x16x32_bf16 v[28:31], v[124:127], v[72:75], v[28:31]
    s_add_u32 s38, s34, 114688
    buffer_load_dwordx4 v[116:119], v5, s[24:27], s38 offen offset:0 sc0
    v_mfma_f32_16x16x32_bf16 v[32:35], v[128:131], v[72:75], v[32:35]
    v_mfma_f32_16x16x32_bf16 v[36:39], v[124:127], v[76:79], v[36:39]
    s_add_u32 s38, s34, 114688
    buffer_load_dwordx4 v[120:123], v5, s[24:27], s38 offen offset:1024 sc0
    v_mfma_f32_16x16x32_bf16 v[40:43], v[128:131], v[76:79], v[40:43]
    v_mfma_f32_16x16x32_bf16 v[44:47], v[124:127], v[80:83], v[44:47]
    v_mfma_f32_16x16x32_bf16 v[48:51], v[128:131], v[80:83], v[48:51]
    s_waitcnt vmcnt(17)
    s_waitcnt lgkmcnt(0)
    s_barrier
    v_mfma_f32_16x16x32_bf16 v[20:23], v[144:147], v[52:55], v[20:23]
    ds_read_b128 v[68:71], v135 offset:24576
    ds_read_b128 v[72:75], v135 offset:26624
    ds_read_b128 v[76:79], v135 offset:28672
    ds_read_b128 v[80:83], v135 offset:30720
    ds_write_b128 v8, v[180:183] offset:13568
    ds_write_b128 v8, v[184:187] offset:14592
    ds_write_b128 v8, v[188:191] offset:15616
    ds_write_b128 v8, v[192:195] offset:16640
    ds_write_b128 v8, v[196:199] offset:17664
    ds_write_b128 v8, v[200:203] offset:18688
    ds_write_b128 v8, v[204:207] offset:19712
    ds_write_b128 v8, v[208:211] offset:20736
    v_mfma_f32_16x16x32_bf16 v[24:27], v[148:151], v[52:55], v[24:27]
    v_mfma_f32_16x16x32_bf16 v[28:31], v[144:147], v[56:59], v[28:31]
    s_add_u32 s38, s34, 118784
    buffer_load_dwordx4 v[124:127], v5, s[24:27], s38 offen offset:0 sc0
    v_mfma_f32_16x16x32_bf16 v[32:35], v[148:151], v[56:59], v[32:35]
    v_mfma_f32_16x16x32_bf16 v[36:39], v[144:147], v[60:63], v[36:39]
    s_add_u32 s38, s34, 118784
    buffer_load_dwordx4 v[128:131], v5, s[24:27], s38 offen offset:1024 sc0
    v_mfma_f32_16x16x32_bf16 v[40:43], v[148:151], v[60:63], v[40:43]
    v_mfma_f32_16x16x32_bf16 v[44:47], v[144:147], v[64:67], v[44:47]
    v_mfma_f32_16x16x32_bf16 v[48:51], v[148:151], v[64:67], v[48:51]
    s_waitcnt vmcnt(15)
    s_waitcnt lgkmcnt(0)
    s_barrier
    v_mfma_f32_16x16x32_bf16 v[20:23], v[152:155], v[68:71], v[20:23]
    ds_read_b128 v[52:55], v19 offset:0
    ds_read_b128 v[56:59], v19 offset:2048
    ds_read_b128 v[60:63], v19 offset:4096
    ds_read_b128 v[64:67], v19 offset:6144
    ds_read_b128 v[160:163], v9 offset:0
    ds_read_b128 v[164:167], v9 offset:13568
    ds_read_b128 v[168:171], v9 offset:20800
    ds_read_b128 v[176:179], v9 offset:1024
    ds_read_b128 v[180:183], v9 offset:14592
    ds_read_b128 v[184:187], v9 offset:21824
    v_mfma_f32_16x16x32_bf16 v[24:27], v[156:159], v[68:71], v[24:27]
    v_mfma_f32_16x16x32_bf16 v[28:31], v[152:155], v[72:75], v[28:31]
    s_add_u32 s38, s34, 122880
    buffer_load_dwordx4 v[144:147], v5, s[24:27], s38 offen offset:0 sc0
    v_mfma_f32_16x16x32_bf16 v[32:35], v[156:159], v[72:75], v[32:35]
    v_mfma_f32_16x16x32_bf16 v[36:39], v[152:155], v[76:79], v[36:39]
    s_add_u32 s38, s34, 122880
    buffer_load_dwordx4 v[148:151], v5, s[24:27], s38 offen offset:1024 sc0
    v_mfma_f32_16x16x32_bf16 v[40:43], v[156:159], v[76:79], v[40:43]
    v_mfma_f32_16x16x32_bf16 v[44:47], v[152:155], v[80:83], v[44:47]
    v_mfma_f32_16x16x32_bf16 v[48:51], v[156:159], v[80:83], v[48:51]
    s_waitcnt vmcnt(15)
    s_waitcnt lgkmcnt(0)
    s_barrier
    v_mfma_f32_16x16x32_bf16 v[20:23], v[84:87], v[52:55], v[20:23]
    ds_read_b128 v[68:71], v19 offset:8192
    ds_read_b128 v[72:75], v19 offset:10240
    ds_read_b128 v[76:79], v19 offset:12288
    ds_read_b128 v[80:83], v19 offset:14336
    v_mfma_f32_16x16x32_bf16 v[24:27], v[88:91], v[52:55], v[24:27]
    v_mfma_f32_16x16x32_bf16 v[28:31], v[84:87], v[56:59], v[28:31]
    s_add_u32 s38, s34, 126976
    buffer_load_dwordx4 v[152:155], v5, s[24:27], s38 offen offset:0 sc0
    v_mfma_f32_16x16x32_bf16 v[32:35], v[88:91], v[56:59], v[32:35]
    v_mfma_f32_16x16x32_bf16 v[36:39], v[84:87], v[60:63], v[36:39]
    s_add_u32 s38, s34, 126976
    buffer_load_dwordx4 v[156:159], v5, s[24:27], s38 offen offset:1024 sc0
    v_mfma_f32_16x16x32_bf16 v[40:43], v[88:91], v[60:63], v[40:43]
    v_mfma_f32_16x16x32_bf16 v[44:47], v[84:87], v[64:67], v[44:47]
    v_mfma_f32_16x16x32_bf16 v[48:51], v[88:91], v[64:67], v[48:51]
    v_pk_add_f32 v[164:165], v[164:165], v[168:169]
    v_pk_add_f32 v[160:161], v[160:161], v[164:165]
    v_mul_f32 v160, s74, v160
    v_mul_f32 v161, s74, v161
    v_lshlrev_b32 v192, 16, v252
    v_and_b32 v193, 0xffff0000, v252
    v_mul_f32 v192, s73, v192
    v_mul_f32 v193, s73, v193
    v_cvt_pk_bf16_f32 v252, v192, v193
    v_cvt_pk_bf16_f32 v194, v160, v161
    v_lshlrev_b32 v192, 16, v252
    v_and_b32 v193, 0xffff0000, v252
    v_lshlrev_b32 v160, 16, v194
    v_and_b32 v161, 0xffff0000, v194
    v_pk_add_f32 v[192:193], v[192:193], v[160:161]
    v_cvt_pk_bf16_f32 v252, v192, v193
    v_pk_add_f32 v[166:167], v[166:167], v[170:171]
    v_pk_add_f32 v[162:163], v[162:163], v[166:167]
    v_mul_f32 v162, s74, v162
    v_mul_f32 v163, s74, v163
    v_lshlrev_b32 v196, 16, v253
    v_and_b32 v197, 0xffff0000, v253
    v_mul_f32 v196, s73, v196
    v_mul_f32 v197, s73, v197
    v_cvt_pk_bf16_f32 v253, v196, v197
    v_cvt_pk_bf16_f32 v198, v162, v163
    v_lshlrev_b32 v196, 16, v253
    v_and_b32 v197, 0xffff0000, v253
    v_lshlrev_b32 v162, 16, v198
    v_and_b32 v163, 0xffff0000, v198
    v_pk_add_f32 v[196:197], v[196:197], v[162:163]
    v_cvt_pk_bf16_f32 v253, v196, v197
    buffer_store_dwordx2 v[252:253], v2, s[68:71], 0 offen offset:0 sc1
    s_waitcnt vmcnt(14)
    s_waitcnt lgkmcnt(0)
    v_mfma_f32_16x16x32_bf16 v[20:23], v[92:95], v[68:71], v[20:23]
    ds_read_b128 v[52:55], v19 offset:16384
    ds_read_b128 v[56:59], v19 offset:18432
    ds_read_b128 v[60:63], v19 offset:20480
    ds_read_b128 v[64:67], v19 offset:22528
    v_mfma_f32_16x16x32_bf16 v[24:27], v[96:99], v[68:71], v[24:27]
    v_mfma_f32_16x16x32_bf16 v[28:31], v[92:95], v[72:75], v[28:31]
    v_mfma_f32_16x16x32_bf16 v[32:35], v[96:99], v[72:75], v[32:35]
    v_mfma_f32_16x16x32_bf16 v[36:39], v[92:95], v[76:79], v[36:39]
    v_mfma_f32_16x16x32_bf16 v[40:43], v[96:99], v[76:79], v[40:43]
    v_mfma_f32_16x16x32_bf16 v[44:47], v[92:95], v[80:83], v[44:47]
    v_mfma_f32_16x16x32_bf16 v[48:51], v[96:99], v[80:83], v[48:51]
    v_pk_add_f32 v[180:181], v[180:181], v[184:185]
    v_pk_add_f32 v[176:177], v[176:177], v[180:181]
    v_mul_f32 v176, s74, v176
    v_mul_f32 v177, s74, v177
    v_lshlrev_b32 v200, 16, v254
    v_and_b32 v201, 0xffff0000, v254
    v_mul_f32 v200, s73, v200
    v_mul_f32 v201, s73, v201
    v_cvt_pk_bf16_f32 v254, v200, v201
    v_cvt_pk_bf16_f32 v202, v176, v177
    v_lshlrev_b32 v200, 16, v254
    v_and_b32 v201, 0xffff0000, v254
    v_lshlrev_b32 v176, 16, v202
    v_and_b32 v177, 0xffff0000, v202
    v_pk_add_f32 v[200:201], v[200:201], v[176:177]
    v_cvt_pk_bf16_f32 v254, v200, v201
    v_pk_add_f32 v[182:183], v[182:183], v[186:187]
    v_pk_add_f32 v[178:179], v[178:179], v[182:183]
    v_mul_f32 v178, s74, v178
    v_mul_f32 v179, s74, v179
    v_lshlrev_b32 v204, 16, v255
    v_and_b32 v205, 0xffff0000, v255
    v_mul_f32 v204, s73, v204
    v_mul_f32 v205, s73, v205
    v_cvt_pk_bf16_f32 v255, v204, v205
    v_cvt_pk_bf16_f32 v206, v178, v179
    v_lshlrev_b32 v204, 16, v255
    v_and_b32 v205, 0xffff0000, v255
    v_lshlrev_b32 v178, 16, v206
    v_and_b32 v179, 0xffff0000, v206
    v_pk_add_f32 v[204:205], v[204:205], v[178:179]
    v_cvt_pk_bf16_f32 v255, v204, v205
    buffer_store_dwordx2 v[254:255], v2, s[68:71], 0 offen offset:512 sc1
    s_waitcnt vmcnt(13)
    s_waitcnt lgkmcnt(0)
    s_barrier
    v_mfma_f32_16x16x32_bf16 v[20:23], v[100:103], v[52:55], v[20:23]
    ds_read_b128 v[68:71], v19 offset:24576
    ds_read_b128 v[72:75], v19 offset:26624
    ds_read_b128 v[76:79], v19 offset:28672
    ds_read_b128 v[80:83], v19 offset:30720
    v_mfma_f32_16x16x32_bf16 v[24:27], v[104:107], v[52:55], v[24:27]
    v_mfma_f32_16x16x32_bf16 v[28:31], v[100:103], v[56:59], v[28:31]
    v_mfma_f32_16x16x32_bf16 v[32:35], v[104:107], v[56:59], v[32:35]
    v_mfma_f32_16x16x32_bf16 v[36:39], v[100:103], v[60:63], v[36:39]
    v_mfma_f32_16x16x32_bf16 v[40:43], v[104:107], v[60:63], v[40:43]
    v_mfma_f32_16x16x32_bf16 v[44:47], v[100:103], v[64:67], v[44:47]
    v_mfma_f32_16x16x32_bf16 v[48:51], v[104:107], v[64:67], v[48:51]
    s_waitcnt vmcnt(10)
    s_waitcnt lgkmcnt(0)
    v_mfma_f32_16x16x32_bf16 v[20:23], v[108:111], v[68:71], v[20:23]
    ds_read_b128 v[52:55], v19 offset:32768
    ds_read_b128 v[56:59], v19 offset:34816
    ds_read_b128 v[60:63], v19 offset:36864
    ds_read_b128 v[64:67], v19 offset:38912
    v_mfma_f32_16x16x32_bf16 v[24:27], v[112:115], v[68:71], v[24:27]
    v_mfma_f32_16x16x32_bf16 v[28:31], v[108:111], v[72:75], v[28:31]
    v_mfma_f32_16x16x32_bf16 v[32:35], v[112:115], v[72:75], v[32:35]
    v_mfma_f32_16x16x32_bf16 v[36:39], v[108:111], v[76:79], v[36:39]
    v_mfma_f32_16x16x32_bf16 v[40:43], v[112:115], v[76:79], v[40:43]
    v_mfma_f32_16x16x32_bf16 v[44:47], v[108:111], v[80:83], v[44:47]
    v_mfma_f32_16x16x32_bf16 v[48:51], v[112:115], v[80:83], v[48:51]
    s_waitcnt vmcnt(8)
    s_waitcnt lgkmcnt(0)
    s_barrier
    v_mfma_f32_16x16x32_bf16 v[20:23], v[116:119], v[52:55], v[20:23]
    ds_read_b128 v[68:71], v19 offset:40960
    ds_read_b128 v[72:75], v19 offset:43008
    ds_read_b128 v[76:79], v19 offset:45056
    ds_read_b128 v[80:83], v19 offset:47104
    v_mfma_f32_16x16x32_bf16 v[24:27], v[120:123], v[52:55], v[24:27]
    v_mfma_f32_16x16x32_bf16 v[28:31], v[116:119], v[56:59], v[28:31]
    s_add_u32 s38, s47, 0
    buffer_load_dwordx4 v[160:163], v5, s[24:27], s38 offen offset:0
    v_mfma_f32_16x16x32_bf16 v[32:35], v[120:123], v[56:59], v[32:35]
    v_mfma_f32_16x16x32_bf16 v[36:39], v[116:119], v[60:63], v[36:39]
    s_add_u32 s38, s47, 0
    buffer_load_dwordx4 v[176:179], v5, s[24:27], s38 offen offset:1024
    v_mfma_f32_16x16x32_bf16 v[40:43], v[120:123], v[60:63], v[40:43]
    v_mfma_f32_16x16x32_bf16 v[44:47], v[116:119], v[64:67], v[44:47]
    v_mfma_f32_16x16x32_bf16 v[48:51], v[120:123], v[64:67], v[48:51]
    s_waitcnt vmcnt(8)
    s_waitcnt lgkmcnt(0)
    v_mfma_f32_16x16x32_bf16 v[20:23], v[124:127], v[68:71], v[20:23]
    ds_read_b128 v[52:55], v19 offset:49152
    ds_read_b128 v[56:59], v19 offset:51200
    ds_read_b128 v[60:63], v19 offset:53248
    ds_read_b128 v[64:67], v19 offset:55296
    v_mfma_f32_16x16x32_bf16 v[24:27], v[128:131], v[68:71], v[24:27]
    v_mfma_f32_16x16x32_bf16 v[28:31], v[124:127], v[72:75], v[28:31]
    s_add_u32 s38, s47, 0
    buffer_load_dwordx4 v[192:195], v5, s[24:27], s38 offen offset:2048
    v_mfma_f32_16x16x32_bf16 v[32:35], v[128:131], v[72:75], v[32:35]
    v_mfma_f32_16x16x32_bf16 v[36:39], v[124:127], v[76:79], v[36:39]
    s_add_u32 s38, s47, 0
    buffer_load_dwordx4 v[208:211], v5, s[24:27], s38 offen offset:3072
    v_mfma_f32_16x16x32_bf16 v[40:43], v[128:131], v[76:79], v[40:43]
    v_mfma_f32_16x16x32_bf16 v[44:47], v[124:127], v[80:83], v[44:47]
    v_mfma_f32_16x16x32_bf16 v[48:51], v[128:131], v[80:83], v[48:51]
    s_waitcnt vmcnt(8)
    s_waitcnt lgkmcnt(0)
    s_barrier
    v_mfma_f32_16x16x32_bf16 v[20:23], v[144:147], v[52:55], v[20:23]
    ds_read_b128 v[68:71], v19 offset:57344
    ds_read_b128 v[72:75], v19 offset:59392
    ds_read_b128 v[76:79], v19 offset:61440
    ds_read_b128 v[80:83], v19 offset:63488
    v_mfma_f32_16x16x32_bf16 v[24:27], v[148:151], v[52:55], v[24:27]
    v_mfma_f32_16x16x32_bf16 v[28:31], v[144:147], v[56:59], v[28:31]
    s_add_u32 s38, s47, 28672
    buffer_load_dwordx4 v[164:167], v5, s[24:27], s38 offen offset:0
    v_mfma_f32_16x16x32_bf16 v[32:35], v[148:151], v[56:59], v[32:35]
    v_mfma_f32_16x16x32_bf16 v[36:39], v[144:147], v[60:63], v[36:39]
    s_add_u32 s38, s47, 28672
    buffer_load_dwordx4 v[180:183], v5, s[24:27], s38 offen offset:1024
    v_mfma_f32_16x16x32_bf16 v[40:43], v[148:151], v[60:63], v[40:43]
    v_mfma_f32_16x16x32_bf16 v[44:47], v[144:147], v[64:67], v[44:47]
    v_mfma_f32_16x16x32_bf16 v[48:51], v[148:151], v[64:67], v[48:51]
    s_waitcnt vmcnt(6)
    v_mov_b32 v6, s98
    v_mov_b32 v7, 1
    s_mov_b64 exec, 1
    buffer_store_dword v7, v6, s[24:27], 0 offen sc1
    s_mov_b64 exec, -1
    s_waitcnt lgkmcnt(0)
    v_mfma_f32_16x16x32_bf16 v[20:23], v[152:155], v[68:71], v[20:23]
    v_mfma_f32_16x16x32_bf16 v[24:27], v[156:159], v[68:71], v[24:27]
    v_mfma_f32_16x16x32_bf16 v[28:31], v[152:155], v[72:75], v[28:31]
    s_add_u32 s38, s47, 28672
    buffer_load_dwordx4 v[196:199], v5, s[24:27], s38 offen offset:2048
    v_mfma_f32_16x16x32_bf16 v[32:35], v[156:159], v[72:75], v[32:35]
    v_mfma_f32_16x16x32_bf16 v[36:39], v[152:155], v[76:79], v[36:39]
    s_add_u32 s38, s47, 28672
    buffer_load_dwordx4 v[212:215], v5, s[24:27], s38 offen offset:3072
    v_mfma_f32_16x16x32_bf16 v[40:43], v[156:159], v[76:79], v[40:43]
    v_mfma_f32_16x16x32_bf16 v[44:47], v[152:155], v[80:83], v[44:47]
    v_mfma_f32_16x16x32_bf16 v[48:51], v[156:159], v[80:83], v[48:51]
    s_branch gf_kernel_cd
gf_kernel_c3:
    v_add_u32 v14, 768, v11
    ds_read2_b32 v[160:161], v14 offset0:64 offset1:65
    ds_read2_b32 v[162:163], v14 offset0:66 offset1:67
    ds_read2_b32 v[164:165], v14 offset0:48 offset1:49
    ds_read2_b32 v[166:167], v14 offset0:50 offset1:51
    ds_read2_b32 v[168:169], v14 offset0:32 offset1:33
    ds_read2_b32 v[170:171], v14 offset0:34 offset1:35
    ds_read2_b32 v[172:173], v14 offset0:16 offset1:17
    ds_read2_b32 v[174:175], v14 offset0:18 offset1:19
    ds_read2_b32 v[176:177], v14 offset0:0 offset1:1
    ds_read2_b32 v[178:179], v14 offset0:2 offset1:3
    v_and_b32 v10, 7, v3
    v_mul_u32_u24 v10, 912, v10
    v_lshrrev_b32 v14, 3, v3
    v_lshl_add_u32 v10, v14, 6, v10
    v_lshl_add_u32 v10, v4, 4, v10
    v_add_u32 v10, s66, v10
    v_lshrrev_b32 v14, 1, v4
    v_lshlrev_b32 v14, 9, v14
    v_lshl_add_u32 v14, v3, 5, v14
    v_and_b32 v15, 1, v4
    v_lshl_add_u32 v14, v15, 4, v14
    v_add_u32 v14, s66, v14
    s_waitcnt vmcnt(3)
    v_cmp_eq_u32 vcc, 0, v0
    s_and_b32 s38, vcc_lo, 0xffff
    s_cbranch_scc1 pb_29
    s_add_u32 s38, s34, 0
    buffer_load_dwordx4 v[84:87], v5, s[24:27], s38 offen offset:0 sc0
    s_add_u32 s38, s34, 0
    buffer_load_dwordx4 v[88:91], v5, s[24:27], s38 offen offset:1024 sc0
    s_add_u32 s38, s34, 4096
    buffer_load_dwordx4 v[92:95], v5, s[24:27], s38 offen offset:0 sc0
    s_add_u32 s38, s34, 4096
    buffer_load_dwordx4 v[96:99], v5, s[24:27], s38 offen offset:1024 sc0
    s_waitcnt lgkmcnt(0)
    ds_read_b128 v[20:23], v10 offset:21824
    ds_read_b128 v[24:27], v10 offset:21952
    ds_read_b128 v[28:31], v10 offset:21888
    ds_read_b128 v[32:35], v10 offset:21824
    ds_read_b128 v[36:39], v10 offset:22080
    ds_read_b128 v[40:43], v10 offset:22016
    ds_read_b128 v[44:47], v10 offset:21952
    ds_read_b128 v[48:51], v10 offset:21888
    ds_read_b128 v[52:55], v10 offset:21824
    ds_read_b128 v[56:59], v10 offset:22208
    s_add_u32 s38, s34, 8192
    buffer_load_dwordx4 v[100:103], v5, s[24:27], s38 offen offset:0 sc0
    s_add_u32 s38, s34, 8192
    buffer_load_dwordx4 v[104:107], v5, s[24:27], s38 offen offset:1024 sc0
    s_waitcnt lgkmcnt(9)
    v_mfma_f32_16x16x32_f16 v[180:183], v[20:23], v[160:163], 0
    s_add_u32 s38, s34, 12288
    buffer_load_dwordx4 v[108:111], v5, s[24:27], s38 offen offset:0 sc0
    s_waitcnt lgkmcnt(8)
    v_mfma_f32_16x16x32_f16 v[184:187], v[24:27], v[160:163], 0
    s_add_u32 s38, s34, 12288
    buffer_load_dwordx4 v[112:115], v5, s[24:27], s38 offen offset:1024 sc0
    s_waitcnt lgkmcnt(7)
    v_mfma_f32_16x16x32_f16 v[184:187], v[28:31], v[164:167], v[184:187]
    s_add_u32 s38, s34, 16384
    buffer_load_dwordx4 v[116:119], v5, s[24:27], s38 offen offset:0 sc0
    s_waitcnt lgkmcnt(6)
    v_mfma_f32_16x16x32_f16 v[184:187], v[32:35], v[168:171], v[184:187]
    s_add_u32 s38, s34, 16384
    buffer_load_dwordx4 v[120:123], v5, s[24:27], s38 offen offset:1024 sc0
    s_waitcnt lgkmcnt(5)
    v_mfma_f32_16x16x32_f16 v[188:191], v[36:39], v[160:163], 0
    s_add_u32 s38, s34, 20480
    buffer_load_dwordx4 v[124:127], v5, s[24:27], s38 offen offset:0 sc0
    s_waitcnt lgkmcnt(4)
    v_mfma_f32_16x16x32_f16 v[188:191], v[40:43], v[164:167], v[188:191]
    s_add_u32 s38, s34, 20480
    buffer_load_dwordx4 v[128:131], v5, s[24:27], s38 offen offset:1024 sc0
    s_waitcnt lgkmcnt(3)
    v_mfma_f32_16x16x32_f16 v[188:191], v[44:47], v[168:171], v[188:191]
    s_add_u32 s38, s34, 24576
    buffer_load_dwordx4 v[144:147], v5, s[24:27], s38 offen offset:0 sc0
    s_waitcnt lgkmcnt(2)
    v_mfma_f32_16x16x32_f16 v[188:191], v[48:51], v[172:175], v[188:191]
    s_add_u32 s38, s34, 24576
    buffer_load_dwordx4 v[148:151], v5, s[24:27], s38 offen offset:1024 sc0
    s_waitcnt lgkmcnt(1)
    v_mfma_f32_16x16x32_f16 v[188:191], v[52:55], v[176:179], v[188:191]
    s_add_u32 s38, s34, 28672
    buffer_load_dwordx4 v[152:155], v5, s[24:27], s38 offen offset:0 sc0
    s_waitcnt lgkmcnt(0)
    v_mfma_f32_16x16x32_f16 v[192:195], v[56:59], v[160:163], 0
    s_add_u32 s38, s34, 28672
    buffer_load_dwordx4 v[156:159], v5, s[24:27], s38 offen offset:1024 sc0
    s_branch pj_30
pb_29:
    s_waitcnt lgkmcnt(0)
    ds_read_b128 v[20:23], v10 offset:21824
    ds_read_b128 v[24:27], v10 offset:21952
    ds_read_b128 v[28:31], v10 offset:21888
    ds_read_b128 v[32:35], v10 offset:21824
    ds_read_b128 v[36:39], v10 offset:22080
    ds_read_b128 v[40:43], v10 offset:22016
    ds_read_b128 v[44:47], v10 offset:21952
    ds_read_b128 v[48:51], v10 offset:21888
    ds_read_b128 v[52:55], v10 offset:21824
    ds_read_b128 v[56:59], v10 offset:22208
    s_waitcnt lgkmcnt(9)
    v_mfma_f32_16x16x32_f16 v[180:183], v[20:23], v[160:163], 0
    s_waitcnt lgkmcnt(8)
    v_mfma_f32_16x16x32_f16 v[184:187], v[24:27], v[160:163], 0
    s_waitcnt lgkmcnt(7)
    v_mfma_f32_16x16x32_f16 v[184:187], v[28:31], v[164:167], v[184:187]
    s_waitcnt lgkmcnt(6)
    v_mfma_f32_16x16x32_f16 v[184:187], v[32:35], v[168:171], v[184:187]
    s_waitcnt lgkmcnt(5)
    v_mfma_f32_16x16x32_f16 v[188:191], v[36:39], v[160:163], 0
    s_waitcnt lgkmcnt(4)
    v_mfma_f32_16x16x32_f16 v[188:191], v[40:43], v[164:167], v[188:191]
    s_waitcnt lgkmcnt(3)
    v_mfma_f32_16x16x32_f16 v[188:191], v[44:47], v[168:171], v[188:191]
    s_waitcnt lgkmcnt(2)
    v_mfma_f32_16x16x32_f16 v[188:191], v[48:51], v[172:175], v[188:191]
    s_waitcnt lgkmcnt(1)
    v_mfma_f32_16x16x32_f16 v[188:191], v[52:55], v[176:179], v[188:191]
    s_waitcnt vmcnt(0)
    v_cmp_eq_u32 vcc, 0, v134
    s_and_b32 s38, vcc_lo, 0xffff
    s_cbranch_scc0 ef_31
    s_lshl_b32 s38, s30, 2
    s_sub_u32 s38, s97, s38
    v_mul_u32_u24 v6, 4, v1
    s_mov_b32 s42, 0
    s_mov_b32 exec_hi, 0
    s_mov_b32 exec_lo, 0xffff
pf_32:
    buffer_load_dword v7, v6, s[24:27], s38 offen sc1
    s_waitcnt vmcnt(0)
    v_cmp_eq_u32 vcc, 0, v7
    s_add_u32 s42, s42, 1
    s_cmp_gt_u32 s42, 30000
    s_cbranch_scc1 pfd_33
    s_cmp_eq_u64 vcc, 0
    s_cbranch_scc1 pfd_33
    s_sleep 6
    s_branch pf_32
pfd_33:
    s_mov_b64 exec, -1
ef_31:
    s_waitcnt lgkmcnt(0)
    v_mfma_f32_16x16x32_f16 v[192:195], v[56:59], v[160:163], 0
    s_add_u32 s38, s34, 0
    buffer_load_dwordx4 v[84:87], v5, s[24:27], s38 offen offset:0 sc0
    s_add_u32 s38, s34, 0
    buffer_load_dwordx4 v[88:91], v5, s[24:27], s38 offen offset:1024 sc0
    s_add_u32 s38, s34, 4096
    buffer_load_dwordx4 v[92:95], v5, s[24:27], s38 offen offset:0 sc0
    s_add_u32 s38, s34, 4096
    buffer_load_dwordx4 v[96:99], v5, s[24:27], s38 offen offset:1024 sc0
    s_add_u32 s38, s34, 8192
    buffer_load_dwordx4 v[100:103], v5, s[24:27], s38 offen offset:0 sc0
    s_add_u32 s38, s34, 8192
    buffer_load_dwordx4 v[104:107], v5, s[24:27], s38 offen offset:1024 sc0
    s_add_u32 s38, s34, 12288
    buffer_load_dwordx4 v[108:111], v5, s[24:27], s38 offen offset:0 sc0
    s_add_u32 s38, s34, 12288
    buffer_load_dwordx4 v[112:115], v5, s[24:27], s38 offen offset:1024 sc0
    s_add_u32 s38, s34, 16384
    buffer_load_dwordx4 v[116:119], v5, s[24:27], s38 offen offset:0 sc0
    s_add_u32 s38, s34, 16384
    buffer_load_dwordx4 v[120:123], v5, s[24:27], s38 offen offset:1024 sc0
    s_add_u32 s38, s34, 20480
    buffer_load_dwordx4 v[124:127], v5, s[24:27], s38 offen offset:0 sc0
    s_add_u32 s38, s34, 20480
    buffer_load_dwordx4 v[128:131], v5, s[24:27], s38 offen offset:1024 sc0
    s_add_u32 s38, s34, 24576
    buffer_load_dwordx4 v[144:147], v5, s[24:27], s38 offen offset:0 sc0
    s_add_u32 s38, s34, 24576
    buffer_load_dwordx4 v[148:151], v5, s[24:27], s38 offen offset:1024 sc0
    s_add_u32 s38, s34, 28672
    buffer_load_dwordx4 v[152:155], v5, s[24:27], s38 offen offset:0 sc0
    s_add_u32 s38, s34, 28672
    buffer_load_dwordx4 v[156:159], v5, s[24:27], s38 offen offset:1024 sc0
pj_30:
    s_barrier
    ds_read_b128 v[52:55], v19 offset:0
    ds_read_b128 v[56:59], v19 offset:2048
    ds_read_b128 v[60:63], v19 offset:4096
    ds_read_b128 v[64:67], v19 offset:6144
    ds_read_b128 v[236:239], v10 offset:22144
    ds_read_b128 v[240:243], v10 offset:22080
    v_mov_b32 v15, 0xbdd2d3e8
    s_waitcnt vmcnt(14)
    s_waitcnt lgkmcnt(0)
    s_barrier
    v_mfma_f32_16x16x32_bf16 v[20:23], v[84:87], v[52:55], 0
    ds_read_b128 v[68:71], v19 offset:8192
    ds_read_b128 v[72:75], v19 offset:10240
    ds_read_b128 v[76:79], v19 offset:12288
    ds_read_b128 v[80:83], v19 offset:14336
    ds_read_b128 v[244:247], v10 offset:22016
    ds_read_b128 v[248:251], v10 offset:21952
    v_mfma_f32_16x16x32_bf16 v[24:27], v[88:91], v[52:55], 0
    v_mfma_f32_16x16x32_bf16 v[28:31], v[84:87], v[56:59], 0
    s_add_u32 m0, s75, 0
    s_add_u32 s39, s67, 1536
    buffer_load_dwordx4 v18, s[20:23], s39 offen lds
    v_mfma_f32_16x16x32_bf16 v[32:35], v[88:91], v[56:59], 0
    v_mfma_f32_16x16x32_bf16 v[36:39], v[84:87], v[60:63], 0
    v_mfma_f32_16x16x32_bf16 v[40:43], v[88:91], v[60:63], 0
    v_mfma_f32_16x16x32_bf16 v[44:47], v[84:87], v[64:67], 0
    v_mfma_f32_16x16x32_bf16 v[48:51], v[88:91], v[64:67], 0
    v_mfma_f32_16x16x32_f16 v[192:195], v[236:239], v[164:167], v[192:195]
    v_mfma_f32_16x16x32_f16 v[192:195], v[240:243], v[168:171], v[192:195]
    s_waitcnt vmcnt(13)
    s_waitcnt lgkmcnt(0)
    v_mfma_f32_16x16x32_bf16 v[20:23], v[92:95], v[68:71], v[20:23]
    ds_read_b128 v[52:55], v19 offset:16384
    ds_read_b128 v[56:59], v19 offset:18432
    ds_read_b128 v[60:63], v19 offset:20480
    ds_read_b128 v[64:67], v19 offset:22528
    ds_read_b128 v[236:239], v10 offset:22336
    ds_read_b128 v[240:243], v10 offset:22272
    v_mfma_f32_16x16x32_bf16 v[24:27], v[96:99], v[68:71], v[24:27]
    v_mfma_f32_16x16x32_bf16 v[28:31], v[92:95], v[72:75], v[28:31]
    s_add_u32 s38, s34, 32768
    buffer_load_dwordx4 v[84:87], v5, s[24:27], s38 offen offset:0 sc0
    v_mfma_f32_16x16x32_bf16 v[32:35], v[96:99], v[72:75], v[32:35]
    v_mfma_f32_16x16x32_bf16 v[36:39], v[92:95], v[76:79], v[36:39]
    s_add_u32 s38, s34, 32768
    buffer_load_dwordx4 v[88:91], v5, s[24:27], s38 offen offset:1024 sc0
    v_mfma_f32_16x16x32_bf16 v[40:43], v[96:99], v[76:79], v[40:43]
    v_mfma_f32_16x16x32_bf16 v[44:47], v[92:95], v[80:83], v[44:47]
    v_mfma_f32_16x16x32_bf16 v[48:51], v[96:99], v[80:83], v[48:51]
    v_mfma_f32_16x16x32_f16 v[192:195], v[244:247], v[172:175], v[192:195]
    v_mfma_f32_16x16x32_f16 v[192:195], v[248:251], v[176:179], v[192:195]
    s_waitcnt vmcnt(13)
    s_waitcnt lgkmcnt(0)
    s_barrier
    v_mfma_f32_16x16x32_bf16 v[20:23], v[100:103], v[52:55], v[20:23]
    ds_read_b128 v[68:71], v19 offset:24576
    ds_read_b128 v[72:75], v19 offset:26624
    ds_read_b128 v[76:79], v19 offset:28672
    ds_read_b128 v[80:83], v19 offset:30720
    ds_read_b128 v[244:247], v10 offset:22208
    ds_read_b128 v[248:251], v10 offset:22144
    v_mfma_f32_16x16x32_bf16 v[24:27], v[104:107], v[52:55], v[24:27]
    v_mfma_f32_16x16x32_bf16 v[28:31], v[100:103], v[56:59], v[28:31]
    s_add_u32 m0, s75, 8192
    s_add_u32 s39, s67, 1664
    buffer_load_dwordx4 v18, s[20:23], s39 offen lds
    v_mfma_f32_16x16x32_bf16 v[32:35], v[104:107], v[56:59], v[32:35]
    v_mfma_f32_16x16x32_bf16 v[36:39], v[100:103], v[60:63], v[36:39]
    s_add_u32 m0, s75, 16384
    s_add_u32 s39, s67, 1792
    buffer_load_dwordx4 v18, s[20:23], s39 offen lds
    v_mfma_f32_16x16x32_bf16 v[40:43], v[104:107], v[60:63], v[40:43]
    v_mfma_f32_16x16x32_bf16 v[44:47], v[100:103], v[64:67], v[44:47]
    s_add_u32 s38, s34, 36864
    buffer_load_dwordx4 v[92:95], v5, s[24:27], s38 offen offset:0 sc0
    v_mfma_f32_16x16x32_bf16 v[48:51], v[104:107], v[64:67], v[48:51]
    v_mfma_f32_16x16x32_f16 v[196:199], v[236:239], v[160:163], 0
    s_add_u32 s38, s34, 36864
    buffer_load_dwordx4 v[96:99], v5, s[24:27], s38 offen offset:1024 sc0
    v_mfma_f32_16x16x32_f16 v[196:199], v[240:243], v[164:167], v[196:199]
    v_lshlrev_b32 v6, 16, v136
    v_and_b32 v7, 0xffff0000, v136
    v_mul_f32 v132, v6, v6
    v_mul_f32 v133, v7, v7
    v_fmaak_f32 v132, v132, v15, 0xc0135761
    v_fmaak_f32 v133, v133, v15, 0xc0135761
    v_mul_f32 v132, v132, v6
    v_mul_f32 v133, v133, v7
    v_exp_f32 v132, v132
    v_exp_f32 v133, v133
    v_add_f32 v132, 1.0, v132
    v_add_f32 v133, 1.0, v133
    v_rcp_f32 v132, v132
    v_rcp_f32 v133, v133
    s_nop 0
    v_mul_f32 v6, v6, v132
    v_mul_f32 v7, v7, v133
    v_cvt_pk_bf16_f32 v136, v6, v7
    s_waitcnt vmcnt(15)
    s_waitcnt lgkmcnt(0)
    v_mfma_f32_16x16x32_bf16 v[20:23], v[108:111], v[68:71], v[20:23]
    ds_read_b128 v[52:55], v19 offset:32768
    ds_read_b128 v[56:59], v19 offset:34816
    ds_read_b128 v[60:63], v19 offset:36864
    ds_read_b128 v[64:67], v19 offset:38912
    ds_read_b128 v[236:239], v10 offset:22080
    ds_read_b128 v[240:243], v10 offset:22464
    v_mfma_f32_16x16x32_bf16 v[24:27], v[112:115], v[68:71], v[24:27]
    v_mfma_f32_16x16x32_bf16 v[28:31], v[108:111], v[72:75], v[28:31]
    s_add_u32 s38, s34, 40960
    buffer_load_dwordx4 v[100:103], v5, s[24:27], s38 offen offset:0 sc0
    v_mfma_f32_16x16x32_bf16 v[32:35], v[112:115], v[72:75], v[32:35]
    v_mfma_f32_16x16x32_bf16 v[36:39], v[108:111], v[76:79], v[36:39]
    s_add_u32 s38, s34, 40960
    buffer_load_dwordx4 v[104:107], v5, s[24:27], s38 offen offset:1024 sc0
    v_mfma_f32_16x16x32_bf16 v[40:43], v[112:115], v[76:79], v[40:43]
    v_mfma_f32_16x16x32_bf16 v[44:47], v[108:111], v[80:83], v[44:47]
    s_lshl_b32 s38, s30, 2
    s_sub_u32 s38, s97, s38
    v_min_u32 v6, 59, v1
    v_lshlrev_b32 v6, 2, v6
    v_add_u32 v6, 18119552, v6
    v_or_b32 v7, 16, v1
    v_lshlrev_b32 v7, 2, v7
    v_add_u32 v7, s38, v7
    v_cmp_gt_u32 vcc, 32, v1
    v_cndmask_b32 v6, v6, v7, vcc
    buffer_load_dword v0, v6, s[24:27], 0 offen sc1
    v_mfma_f32_16x16x32_bf16 v[48:51], v[112:115], v[80:83], v[48:51]
    v_mfma_f32_16x16x32_f16 v[196:199], v[244:247], v[168:171], v[196:199]
    v_mfma_f32_16x16x32_f16 v[196:199], v[248:251], v[172:175], v[196:199]
    s_waitcnt vmcnt(16)
    s_waitcnt lgkmcnt(0)
    s_barrier
    v_mfma_f32_16x16x32_bf16 v[20:23], v[116:119], v[52:55], v[20:23]
    ds_read_b128 v[68:71], v19 offset:40960
    ds_read_b128 v[72:75], v19 offset:43008
    ds_read_b128 v[76:79], v19 offset:45056
    ds_read_b128 v[80:83], v19 offset:47104
    ds_read_b128 v[244:247], v10 offset:22400
    ds_read_b128 v[248:251], v10 offset:22336
    v_mfma_f32_16x16x32_bf16 v[24:27], v[120:123], v[52:55], v[24:27]
    v_mfma_f32_16x16x32_bf16 v[28:31], v[116:119], v[56:59], v[28:31]
    s_add_u32 m0, s75, 24576
    s_add_u32 s39, s67, 1920
    buffer_load_dwordx4 v18, s[20:23], s39 offen lds
    v_mfma_f32_16x16x32_bf16 v[32:35], v[120:123], v[56:59], v[32:35]
    v_mfma_f32_16x16x32_bf16 v[36:39], v[116:119], v[60:63], v[36:39]
    s_add_u32 m0, s75, 32768
    s_add_u32 s39, s67, 2048
    buffer_load_dwordx4 v18, s[20:23], s39 offen lds
    v_mfma_f32_16x16x32_bf16 v[40:43], v[120:123], v[60:63], v[40:43]
    v_mfma_f32_16x16x32_bf16 v[44:47], v[116:119], v[64:67], v[44:47]
    s_add_u32 s38, s34, 45056
    buffer_load_dwordx4 v[108:111], v5, s[24:27], s38 offen offset:0 sc0
    v_mfma_f32_16x16x32_bf16 v[48:51], v[120:123], v[64:67], v[48:51]
    v_mfma_f32_16x16x32_f16 v[196:199], v[236:239], v[176:179], v[196:199]
    s_add_u32 s38, s34, 45056
    buffer_load_dwordx4 v[112:115], v5, s[24:27], s38 offen offset:1024 sc0
    v_mfma_f32_16x16x32_f16 v[200:203], v[240:243], v[160:163], 0
    v_lshlrev_b32 v6, 16, v137
    v_and_b32 v7, 0xffff0000, v137
    v_mul_f32 v132, v6, v6
    v_mul_f32 v133, v7, v7
    v_fmaak_f32 v132, v132, v15, 0xc0135761
    v_fmaak_f32 v133, v133, v15, 0xc0135761
    v_mul_f32 v132, v132, v6
    v_mul_f32 v133, v133, v7
    v_exp_f32 v132, v132
    v_exp_f32 v133, v133
    v_add_f32 v132, 1.0, v132
    v_add_f32 v133, 1.0, v133
    v_rcp_f32 v132, v132
    v_rcp_f32 v133, v133
    s_nop 0
    v_mul_f32 v6, v6, v132
    v_mul_f32 v7, v7, v133
    v_cvt_pk_bf16_f32 v137, v6, v7
    s_waitcnt vmcnt(18)
    s_waitcnt lgkmcnt(0)
    v_mfma_f32_16x16x32_bf16 v[20:23], v[124:127], v[68:71], v[20:23]
    ds_read_b128 v[52:55], v19 offset:49152
    ds_read_b128 v[56:59], v19 offset:51200
    ds_read_b128 v[60:63], v19 offset:53248
    ds_read_b128 v[64:67], v19 offset:55296
    ds_read_b128 v[236:239], v10 offset:22272
    ds_read_b128 v[240:243], v10 offset:22208
    v_mfma_f32_16x16x32_bf16 v[24:27], v[128:131], v[68:71], v[24:27]
    v_mfma_f32_16x16x32_bf16 v[28:31], v[124:127], v[72:75], v[28:31]
    s_add_u32 s38, s34, 49152
    buffer_load_dwordx4 v[116:119], v5, s[24:27], s38 offen offset:0 sc0
    v_mfma_f32_16x16x32_bf16 v[32:35], v[128:131], v[72:75], v[32:35]
    v_mfma_f32_16x16x32_bf16 v[36:39], v[124:127], v[76:79], v[36:39]
    s_add_u32 s38, s34, 49152
    buffer_load_dwordx4 v[120:123], v5, s[24:27], s38 offen offset:1024 sc0
    v_mfma_f32_16x16x32_bf16 v[40:43], v[128:131], v[76:79], v[40:43]
    v_mfma_f32_16x16x32_bf16 v[44:47], v[124:127], v[80:83], v[44:47]
    v_mfma_f32_16x16x32_bf16 v[48:51], v[128:131], v[80:83], v[48:51]
    v_mfma_f32_16x16x32_f16 v[200:203], v[244:247], v[164:167], v[200:203]
    v_mfma_f32_16x16x32_f16 v[200:203], v[248:251], v[168:171], v[200:203]
    s_waitcnt vmcnt(18)
    s_waitcnt lgkmcnt(0)
    s_barrier
    v_mfma_f32_16x16x32_bf16 v[20:23], v[144:147], v[52:55], v[20:23]
    ds_read_b128 v[68:71], v19 offset:57344
    ds_read_b128 v[72:75], v19 offset:59392
    ds_read_b128 v[76:79], v19 offset:61440
    ds_read_b128 v[80:83], v19 offset:63488
    ds_read_b128 v[244:247], v10 offset:22592
    ds_read_b128 v[248:251], v10 offset:22528
    v_mfma_f32_16x16x32_bf16 v[24:27], v[148:151], v[52:55], v[24:27]
    v_mfma_f32_16x16x32_bf16 v[28:31], v[144:147], v[56:59], v[28:31]
    s_add_u32 m0, s75, 40960
    s_add_u32 s39, s67, 2176
    buffer_load_dwordx4 v18, s[20:23], s39 offen lds
    v_mfma_f32_16x16x32_bf16 v[32:35], v[148:151], v[56:59], v[32:35]
    v_mfma_f32_16x16x32_bf16 v[36:39], v[144:147], v[60:63], v[36:39]
    s_add_u32 m0, s75, 49152
    s_add_u32 s39, s67, 2304
    buffer_load_dwordx4 v18, s[20:23], s39 offen lds
    v_mfma_f32_16x16x32_bf16 v[40:43], v[148:151], v[60:63], v[40:43]
    v_mfma_f32_16x16x32_bf16 v[44:47], v[144:147], v[64:67], v[44:47]
    s_add_u32 s38, s34, 53248
    buffer_load_dwordx4 v[124:127], v5, s[24:27], s38 offen offset:0 sc0
    v_mfma_f32_16x16x32_bf16 v[48:51], v[148:151], v[64:67], v[48:51]
    v_mfma_f32_16x16x32_f16 v[200:203], v[236:239], v[172:175], v[200:203]
    s_add_u32 s38, s34, 53248
    buffer_load_dwordx4 v[128:131], v5, s[24:27], s38 offen offset:1024 sc0
    v_mfma_f32_16x16x32_f16 v[200:203], v[240:243], v[176:179], v[200:203]
    v_lshlrev_b32 v6, 16, v138
    v_and_b32 v7, 0xffff0000, v138
    v_mul_f32 v132, v6, v6
    v_mul_f32 v133, v7, v7
    v_fmaak_f32 v132, v132, v15, 0xc0135761
    v_fmaak_f32 v133, v133, v15, 0xc0135761
    v_mul_f32 v132, v132, v6
    v_mul_f32 v133, v133, v7
    v_exp_f32 v132, v132
    v_exp_f32 v133, v133
    v_add_f32 v132, 1.0, v132
    v_add_f32 v133, 1.0, v133
    v_rcp_f32 v132, v132
    v_rcp_f32 v133, v133
    s_nop 0
    v_mul_f32 v6, v6, v132
    v_mul_f32 v7, v7, v133
    v_cvt_pk_bf16_f32 v138, v6, v7
    s_waitcnt vmcnt(20)
    s_waitcnt lgkmcnt(0)
    v_mfma_f32_16x16x32_bf16 v[20:23], v[152:155], v[68:71], v[20:23]
    ds_read_b128 v[52:55], v135 offset:0
    ds_read_b128 v[56:59], v135 offset:2048
    ds_read_b128 v[60:63], v135 offset:4096
    ds_read_b128 v[64:67], v135 offset:6144
    ds_read_b128 v[236:239], v10 offset:22464
    ds_read_b128 v[240:243], v10 offset:22400
    v_mfma_f32_16x16x32_bf16 v[24:27], v[156:159], v[68:71], v[24:27]
    v_mfma_f32_16x16x32_bf16 v[28:31], v[152:155], v[72:75], v[28:31]
    s_add_u32 s38, s34, 57344
    buffer_load_dwordx4 v[144:147], v5, s[24:27], s38 offen offset:0 sc0
    v_mfma_f32_16x16x32_bf16 v[32:35], v[156:159], v[72:75], v[32:35]
    v_mfma_f32_16x16x32_bf16 v[36:39], v[152:155], v[76:79], v[36:39]
    s_add_u32 s38, s34, 57344
    buffer_load_dwordx4 v[148:151], v5, s[24:27], s38 offen offset:1024 sc0
    v_mfma_f32_16x16x32_bf16 v[40:43], v[156:159], v[76:79], v[40:43]
    v_mfma_f32_16x16x32_bf16 v[44:47], v[152:155], v[80:83], v[44:47]
    v_mfma_f32_16x16x32_bf16 v[48:51], v[156:159], v[80:83], v[48:51]
    v_mfma_f32_16x16x32_f16 v[204:207], v[244:247], v[160:163], 0
    v_mfma_f32_16x16x32_f16 v[204:207], v[248:251], v[164:167], v[204:207]
    s_waitcnt vmcnt(19)
    s_waitcnt lgkmcnt(0)
    s_barrier
    v_mfma_f32_16x16x32_bf16 v[20:23], v[84:87], v[52:55], v[20:23]
    ds_read_b128 v[68:71], v135 offset:8192
    ds_read_b128 v[72:75], v135 offset:10240
    ds_read_b128 v[76:79], v135 offset:12288
    ds_read_b128 v[80:83], v135 offset:14336
    ds_read_b128 v[244:247], v10 offset:22336
    v_mfma_f32_16x16x32_bf16 v[24:27], v[88:91], v[52:55], v[24:27]
    v_mfma_f32_16x16x32_bf16 v[28:31], v[84:87], v[56:59], v[28:31]
    s_add_u32 m0, s75, 57344
    s_add_u32 s39, s67, 2432
    buffer_load_dwordx4 v18, s[20:23], s39 offen lds
    v_mfma_f32_16x16x32_bf16 v[32:35], v[88:91], v[56:59], v[32:35]
    v_mfma_f32_16x16x32_bf16 v[36:39], v[84:87], v[60:63], v[36:39]
    s_add_u32 m0, s75, 65536
    s_add_u32 s39, s67, 2560
    buffer_load_dwordx4 v18, s[20:23], s39 offen lds
    v_mfma_f32_16x16x32_bf16 v[40:43], v[88:91], v[60:63], v[40:43]
    v_mfma_f32_16x16x32_bf16 v[44:47], v[84:87], v[64:67], v[44:47]
    s_add_u32 s38, s34, 61440
    buffer_load_dwordx4 v[152:155], v5, s[24:27], s38 offen offset:0 sc0
    v_mfma_f32_16x16x32_bf16 v[48:51], v[88:91], v[64:67], v[48:51]
    v_mfma_f32_16x16x32_f16 v[204:207], v[236:239], v[168:171], v[204:207]
    s_add_u32 s38, s34, 61440
    buffer_load_dwordx4 v[156:159], v5, s[24:27], s38 offen offset:1024 sc0
    v_mfma_f32_16x16x32_f16 v[204:207], v[240:243], v[172:175], v[204:207]
    v_lshlrev_b32 v6, 16, v139
    v_and_b32 v7, 0xffff0000, v139
    v_mul_f32 v132, v6, v6
    v_mul_f32 v133, v7, v7
    v_fmaak_f32 v132, v132, v15, 0xc0135761
    v_fmaak_f32 v133, v133, v15, 0xc0135761
    v_mul_f32 v132, v132, v6
    v_mul_f32 v133, v133, v7
    v_exp_f32 v132, v132
    v_exp_f32 v133, v133
    v_add_f32 v132, 1.0, v132
    v_add_f32 v133, 1.0, v133
    v_rcp_f32 v132, v132
    v_rcp_f32 v133, v133
    s_nop 0
    v_mul_f32 v6, v6, v132
    v_mul_f32 v7, v7, v133
    v_cvt_pk_bf16_f32 v139, v6, v7
    s_waitcnt vmcnt(19)
    s_waitcnt vmcnt(16)
    v_cmp_eq_u32 vcc, 0, v0
    s_cmp_eq_u64 vcc, 0
    s_cbranch_scc1 fs_34
    s_lshl_b32 s38, s30, 2
    s_sub_u32 s38, s97, s38
    v_min_u32 v6, 59, v1
    v_lshlrev_b32 v6, 2, v6
    v_add_u32 v6, 18119552, v6
    v_or_b32 v7, 16, v1
    v_lshlrev_b32 v7, 2, v7
    v_add_u32 v7, s38, v7
    v_cmp_gt_u32 vcc, 32, v1
    v_cndmask_b32 v6, v6, v7, vcc
    v_mov_b32 v0, 0
    s_mov_b32 s42, 0
ck_35:
    v_cmp_eq_u32 vcc, 0, v0
    s_add_u32 s42, s42, 1
    s_cmp_gt_u32 s42, 30000
    s_cbranch_scc1 ckd_36
    s_cmp_eq_u64 vcc, 0
    s_cbranch_scc1 ckd_36
    s_sleep 2
    buffer_load_dword v0, v6, s[24:27], 0 offen sc1
    s_waitcnt vmcnt(0)
    s_branch ck_35
ckd_36:
fs_34:
    s_waitcnt lgkmcnt(0)
    v_mfma_f32_16x16x32_bf16 v[20:23], v[92:95], v[68:71], v[20:23]
    ds_read_b128 v[52:55], v135 offset:16384
    ds_read_b128 v[56:59], v135 offset:18432
    ds_read_b128 v[60:63], v135 offset:20480
    ds_read_b128 v[64:67], v135 offset:22528
    v_mfma_f32_16x16x32_bf16 v[24:27], v[96:99], v[68:71], v[24:27]
    v_mfma_f32_16x16x32_bf16 v[28:31], v[92:95], v[72:75], v[28:31]
    s_add_u32 s38, s34, 65536
    buffer_load_dwordx4 v[84:87], v5, s[24:27], s38 offen offset:0 sc0
    v_mfma_f32_16x16x32_bf16 v[32:35], v[96:99], v[72:75], v[32:35]
    v_mfma_f32_16x16x32_bf16 v[36:39], v[92:95], v[76:79], v[36:39]
    s_add_u32 s38, s34, 65536
    buffer_load_dwordx4 v[88:91], v5, s[24:27], s38 offen offset:1024 sc0
    v_mfma_f32_16x16x32_bf16 v[40:43], v[96:99], v[76:79], v[40:43]
    v_mfma_f32_16x16x32_bf16 v[44:47], v[92:95], v[80:83], v[44:47]
    v_mfma_f32_16x16x32_bf16 v[48:51], v[96:99], v[80:83], v[48:51]
    v_mfma_f32_16x16x32_f16 v[204:207], v[244:247], v[176:179], v[204:207]
    s_waitcnt lgkmcnt(0)
    s_barrier
    v_mfma_f32_16x16x32_bf16 v[20:23], v[100:103], v[52:55], v[20:23]
    ds_read_b128 v[68:71], v135 offset:24576
    ds_read_b128 v[72:75], v135 offset:26624
    ds_read_b128 v[76:79], v135 offset:28672
    ds_read_b128 v[80:83], v135 offset:30720
    v_mfma_f32_16x16x32_bf16 v[24:27], v[104:107], v[52:55], v[24:27]
    v_mfma_f32_16x16x32_bf16 v[28:31], v[100:103], v[56:59], v[28:31]
    s_add_u32 m0, s75, 73728
    s_add_u32 s39, s67, 2688
    buffer_load_dwordx4 v18, s[20:23], s39 offen lds
    v_mfma_f32_16x16x32_bf16 v[32:35], v[104:107], v[56:59], v[32:35]
    v_mfma_f32_16x16x32_bf16 v[36:39], v[100:103], v[60:63], v[36:39]
    s_add_u32 m0, s75, 81920
    s_add_u32 s39, s67, 2816
    buffer_load_dwordx4 v18, s[20:23], s39 offen lds
    v_mfma_f32_16x16x32_bf16 v[40:43], v[104:107], v[60:63], v[40:43]
    v_mfma_f32_16x16x32_bf16 v[44:47], v[100:103], v[64:67], v[44:47]
    s_add_u32 s38, s34, 69632
    buffer_load_dwordx4 v[92:95], v5, s[24:27], s38 offen offset:0 sc0
    v_mfma_f32_16x16x32_bf16 v[48:51], v[104:107], v[64:67], v[48:51]
    s_add_u32 s38, s34, 69632
    buffer_load_dwordx4 v[96:99], v5, s[24:27], s38 offen offset:1024 sc0
    v_lshlrev_b32 v6, 16, v140
    v_and_b32 v7, 0xffff0000, v140
    v_mul_f32 v132, v6, v6
    v_mul_f32 v133, v7, v7
    v_fmaak_f32 v132, v132, v15, 0xc0135761
    v_fmaak_f32 v133, v133, v15, 0xc0135761
    v_mul_f32 v132, v132, v6
    v_mul_f32 v133, v133, v7
    v_exp_f32 v132, v132
    v_exp_f32 v133, v133
    v_add_f32 v132, 1.0, v132
    v_add_f32 v133, 1.0, v133
    v_rcp_f32 v132, v132
    v_rcp_f32 v133, v133
    s_nop 0
    v_mul_f32 v6, v6, v132
    v_mul_f32 v7, v7, v133
    v_cvt_pk_bf16_f32 v140, v6, v7
    s_waitcnt vmcnt(18)
    s_waitcnt lgkmcnt(0)
    v_mfma_f32_16x16x32_bf16 v[20:23], v[108:111], v[68:71], v[20:23]
    ds_read_b128 v[52:55], v19 offset:0
    ds_read_b128 v[56:59], v19 offset:2048
    ds_read_b128 v[60:63], v19 offset:4096
    ds_read_b128 v[64:67], v19 offset:6144
    v_mfma_f32_16x16x32_bf16 v[24:27], v[112:115], v[68:71], v[24:27]
    v_mfma_f32_16x16x32_bf16 v[28:31], v[108:111], v[72:75], v[28:31]
    s_add_u32 s38, s34, 73728
    buffer_load_dwordx4 v[100:103], v5, s[24:27], s38 offen offset:0 sc0
    v_mfma_f32_16x16x32_bf16 v[32:35], v[112:115], v[72:75], v[32:35]
    v_mfma_f32_16x16x32_bf16 v[36:39], v[108:111], v[76:79], v[36:39]
    s_add_u32 s38, s34, 73728
    buffer_load_dwordx4 v[104:107], v5, s[24:27], s38 offen offset:1024 sc0
    v_mfma_f32_16x16x32_bf16 v[40:43], v[112:115], v[76:79], v[40:43]
    v_mfma_f32_16x16x32_bf16 v[44:47], v[108:111], v[80:83], v[44:47]
    v_mfma_f32_16x16x32_bf16 v[48:51], v[112:115], v[80:83], v[48:51]
    s_waitcnt vmcnt(18)
    s_waitcnt lgkmcnt(0)
    s_barrier
    v_mfma_f32_16x16x32_bf16 v[20:23], v[116:119], v[52:55], v[20:23]
    ds_read_b128 v[68:71], v19 offset:8192
    ds_read_b128 v[72:75], v19 offset:10240
    ds_read_b128 v[76:79], v19 offset:12288
    ds_read_b128 v[80:83], v19 offset:14336
    v_mfma_f32_16x16x32_bf16 v[24:27], v[120:123], v[52:55], v[24:27]
    v_mfma_f32_16x16x32_bf16 v[28:31], v[116:119], v[56:59], v[28:31]
    s_add_u32 m0, s75, 90112
    s_add_u32 s39, s67, 2944
    buffer_load_dwordx4 v18, s[20:23], s39 offen lds
    v_mfma_f32_16x16x32_bf16 v[32:35], v[120:123], v[56:59], v[32:35]
    v_mfma_f32_16x16x32_bf16 v[36:39], v[116:119], v[60:63], v[36:39]
    s_add_u32 m0, s75, 0
    s_add_u32 s39, s67, 3072
    buffer_load_dwordx4 v18, s[20:23], s39 offen lds
    v_mfma_f32_16x16x32_bf16 v[40:43], v[120:123], v[60:63], v[40:43]
    v_mfma_f32_16x16x32_bf16 v[44:47], v[116:119], v[64:67], v[44:47]
    s_add_u32 s38, s34, 77824
    buffer_load_dwordx4 v[108:111], v5, s[24:27], s38 offen offset:0 sc0
    v_mfma_f32_16x16x32_bf16 v[48:51], v[120:123], v[64:67], v[48:51]
    s_add_u32 s38, s34, 77824
    buffer_load_dwordx4 v[112:115], v5, s[24:27], s38 offen offset:1024 sc0
    v_lshlrev_b32 v6, 16, v141
    v_and_b32 v7, 0xffff0000, v141
    v_mul_f32 v132, v6, v6
    v_mul_f32 v133, v7, v7
    v_fmaak_f32 v132, v132, v15, 0xc0135761
    v_fmaak_f32 v133, v133, v15, 0xc0135761
    v_mul_f32 v132, v132, v6
    v_mul_f32 v133, v133, v7
    v_exp_f32 v132, v132
    v_exp_f32 v133, v133
    v_add_f32 v132, 1.0, v132
    v_add_f32 v133, 1.0, v133
    v_rcp_f32 v132, v132
    v_rcp_f32 v133, v133
    s_nop 0
    v_mul_f32 v6, v6, v132
    v_mul_f32 v7, v7, v133
    v_cvt_pk_bf16_f32 v141, v6, v7
    s_waitcnt vmcnt(18)
    s_waitcnt lgkmcnt(0)
    v_mfma_f32_16x16x32_bf16 v[20:23], v[124:127], v[68:71], v[20:23]
    ds_read_b128 v[52:55], v19 offset:16384
    ds_read_b128 v[56:59], v19 offset:18432
    ds_read_b128 v[60:63], v19 offset:20480
    ds_read_b128 v[64:67], v19 offset:22528
    v_mfma_f32_16x16x32_bf16 v[24:27], v[128:131], v[68:71], v[24:27]
    v_mfma_f32_16x16x32_bf16 v[28:31], v[124:127], v[72:75], v[28:31]
    s_add_u32 s38, s34, 81920
    buffer_load_dwordx4 v[116:119], v5, s[24:27], s38 offen offset:0 sc0
    v_mfma_f32_16x16x32_bf16 v[32:35], v[128:131], v[72:75], v[32:35]
    v_mfma_f32_16x16x32_bf16 v[36:39], v[124:127], v[76:79], v[36:39]
    s_add_u32 s38, s34, 81920
    buffer_load_dwordx4 v[120:123], v5, s[24:27], s38 offen offset:1024 sc0
    v_mfma_f32_16x16x32_bf16 v[40:43], v[128:131], v[76:79], v[40:43]
    v_mfma_f32_16x16x32_bf16 v[44:47], v[124:127], v[80:83], v[44:47]
    v_mfma_f32_16x16x32_bf16 v[48:51], v[128:131], v[80:83], v[48:51]
    s_waitcnt vmcnt(18)
    s_waitcnt lgkmcnt(0)
    s_barrier
    v_mfma_f32_16x16x32_bf16 v[20:23], v[144:147], v[52:55], v[20:23]
    ds_read_b128 v[68:71], v19 offset:24576
    ds_read_b128 v[72:75], v19 offset:26624
    ds_read_b128 v[76:79], v19 offset:28672
    ds_read_b128 v[80:83], v19 offset:30720
    v_mfma_f32_16x16x32_bf16 v[24:27], v[148:151], v[52:55], v[24:27]
    v_mfma_f32_16x16x32_bf16 v[28:31], v[144:147], v[56:59], v[28:31]
    s_add_u32 m0, s75, 8192
    s_add_u32 s39, s67, 3200
    buffer_load_dwordx4 v18, s[20:23], s39 offen lds
    v_mfma_f32_16x16x32_bf16 v[32:35], v[148:151], v[56:59], v[32:35]
    v_mfma_f32_16x16x32_bf16 v[36:39], v[144:147], v[60:63], v[36:39]
    s_add_u32 m0, s75, 16384
    s_add_u32 s39, s67, 3328
    buffer_load_dwordx4 v18, s[20:23], s39 offen lds
    v_mfma_f32_16x16x32_bf16 v[40:43], v[148:151], v[60:63], v[40:43]
    v_mfma_f32_16x16x32_bf16 v[44:47], v[144:147], v[64:67], v[44:47]
    s_add_u32 s38, s34, 86016
    buffer_load_dwordx4 v[124:127], v5, s[24:27], s38 offen offset:0 sc0
    v_mfma_f32_16x16x32_bf16 v[48:51], v[148:151], v[64:67], v[48:51]
    s_add_u32 s38, s34, 86016
    buffer_load_dwordx4 v[128:131], v5, s[24:27], s38 offen offset:1024 sc0
    v_lshlrev_b32 v6, 16, v142
    v_and_b32 v7, 0xffff0000, v142
    v_mul_f32 v132, v6, v6
    v_mul_f32 v133, v7, v7
    v_fmaak_f32 v132, v132, v15, 0xc0135761
    v_fmaak_f32 v133, v133, v15, 0xc0135761
    v_mul_f32 v132, v132, v6
    v_mul_f32 v133, v133, v7
    v_exp_f32 v132, v132
    v_exp_f32 v133, v133
    v_add_f32 v132, 1.0, v132
    v_add_f32 v133, 1.0, v133
    v_rcp_f32 v132, v132
    v_rcp_f32 v133, v133
    s_nop 0
    v_mul_f32 v6, v6, v132
    v_mul_f32 v7, v7, v133
    v_cvt_pk_bf16_f32 v142, v6, v7
    s_waitcnt vmcnt(18)
    s_waitcnt lgkmcnt(0)
    v_mfma_f32_16x16x32_bf16 v[20:23], v[152:155], v[68:71], v[20:23]
    ds_read_b128 v[52:55], v19 offset:32768
    ds_read_b128 v[56:59], v19 offset:34816
    ds_read_b128 v[60:63], v19 offset:36864
    ds_read_b128 v[64:67], v19 offset:38912
    v_mfma_f32_16x16x32_bf16 v[24:27], v[156:159], v[68:71], v[24:27]
    v_mfma_f32_16x16x32_bf16 v[28:31], v[152:155], v[72:75], v[28:31]
    s_add_u32 s38, s34, 90112
    buffer_load_dwordx4 v[144:147], v5, s[24:27], s38 offen offset:0 sc0
    v_mfma_f32_16x16x32_bf16 v[32:35], v[156:159], v[72:75], v[32:35]
    v_mfma_f32_16x16x32_bf16 v[36:39], v[152:155], v[76:79], v[36:39]
    s_add_u32 s38, s34, 90112
    buffer_load_dwordx4 v[148:151], v5, s[24:27], s38 offen offset:1024 sc0
    v_mfma_f32_16x16x32_bf16 v[40:43], v[156:159], v[76:79], v[40:43]
    v_mfma_f32_16x16x32_bf16 v[44:47], v[152:155], v[80:83], v[44:47]
    v_mfma_f32_16x16x32_bf16 v[48:51], v[156:159], v[80:83], v[48:51]
    s_waitcnt vmcnt(18)
    s_waitcnt lgkmcnt(0)
    s_barrier
    v_mfma_f32_16x16x32_bf16 v[20:23], v[84:87], v[52:55], v[20:23]
    ds_read_b128 v[68:71], v19 offset:40960
    ds_read_b128 v[72:75], v19 offset:43008
    ds_read_b128 v[76:79], v19 offset:45056
    ds_read_b128 v[80:83], v19 offset:47104
    v_mfma_f32_16x16x32_bf16 v[24:27], v[88:91], v[52:55], v[24:27]
    v_mfma_f32_16x16x32_bf16 v[28:31], v[84:87], v[56:59], v[28:31]
    s_add_u32 m0, s75, 24576
    s_add_u32 s39, s67, 3456
    buffer_load_dwordx4 v18, s[20:23], s39 offen lds
    v_mfma_f32_16x16x32_bf16 v[32:35], v[88:91], v[56:59], v[32:35]
    v_mfma_f32_16x16x32_bf16 v[36:39], v[84:87], v[60:63], v[36:39]
    s_add_u32 m0, s75, 32768
    s_add_u32 s39, s67, 3584
    buffer_load_dwordx4 v18, s[20:23], s39 offen lds
    v_mfma_f32_16x16x32_bf16 v[40:43], v[88:91], v[60:63], v[40:43]
    v_mfma_f32_16x16x32_bf16 v[44:47], v[84:87], v[64:67], v[44:47]
    s_add_u32 s38, s34, 94208
    buffer_load_dwordx4 v[152:155], v5, s[24:27], s38 offen offset:0 sc0
    v_mfma_f32_16x16x32_bf16 v[48:51], v[88:91], v[64:67], v[48:51]
    s_add_u32 s38, s34, 94208
    buffer_load_dwordx4 v[156:159], v5, s[24:27], s38 offen offset:1024 sc0
    v_lshlrev_b32 v6, 16, v143
    v_and_b32 v7, 0xffff0000, v143
    v_mul_f32 v132, v6, v6
    v_mul_f32 v133, v7, v7
    v_fmaak_f32 v132, v132, v15, 0xc0135761
    v_fmaak_f32 v133, v133, v15, 0xc0135761
    v_mul_f32 v132, v132, v6
    v_mul_f32 v133, v133, v7
    v_exp_f32 v132, v132
    v_exp_f32 v133, v133
    v_add_f32 v132, 1.0, v132
    v_add_f32 v133, 1.0, v133
    v_rcp_f32 v132, v132
    v_rcp_f32 v133, v133
    s_nop 0
    v_mul_f32 v6, v6, v132
    v_mul_f32 v7, v7, v133
    v_cvt_pk_bf16_f32 v143, v6, v7
    s_waitcnt vmcnt(18)
    s_waitcnt lgkmcnt(0)
    v_mfma_f32_16x16x32_bf16 v[20:23], v[92:95], v[68:71], v[20:23]
    ds_read_b128 v[52:55], v19 offset:49152
    ds_read_b128 v[56:59], v19 offset:51200
    ds_read_b128 v[60:63], v19 offset:53248
    ds_read_b128 v[64:67], v19 offset:55296
    v_mfma_f32_16x16x32_bf16 v[24:27], v[96:99], v[68:71], v[24:27]
    v_mfma_f32_16x16x32_bf16 v[28:31], v[92:95], v[72:75], v[28:31]
    s_add_u32 s38, s34, 98304
    buffer_load_dwordx4 v[84:87], v5, s[24:27], s38 offen offset:0 sc0
    v_mfma_f32_16x16x32_bf16 v[32:35], v[96:99], v[72:75], v[32:35]
    v_mfma_f32_16x16x32_bf16 v[36:39], v[92:95], v[76:79], v[36:39]
    s_add_u32 s38, s34, 98304
    buffer_load_dwordx4 v[88:91], v5, s[24:27], s38 offen offset:1024 sc0
    v_mfma_f32_16x16x32_bf16 v[40:43], v[96:99], v[76:79], v[40:43]
    v_mfma_f32_16x16x32_bf16 v[44:47], v[92:95], v[80:83], v[44:47]
    v_mfma_f32_16x16x32_bf16 v[48:51], v[96:99], v[80:83], v[48:51]
    s_waitcnt vmcnt(18)
    s_waitcnt lgkmcnt(0)
    s_barrier
    v_mfma_f32_16x16x32_bf16 v[20:23], v[100:103], v[52:55], v[20:23]
    ds_read_b128 v[68:71], v19 offset:57344
    ds_read_b128 v[72:75], v19 offset:59392
    ds_read_b128 v[76:79], v19 offset:61440
    ds_read_b128 v[80:83], v19 offset:63488
    v_mfma_f32_16x16x32_bf16 v[24:27], v[104:107], v[52:55], v[24:27]
    v_mfma_f32_16x16x32_bf16 v[28:31], v[100:103], v[56:59], v[28:31]
    s_add_u32 m0, s75, 40960
    s_add_u32 s39, s67, 3712
    buffer_load_dwordx4 v18, s[20:23], s39 offen lds
    v_mfma_f32_16x16x32_bf16 v[32:35], v[104:107], v[56:59], v[32:35]
    v_mfma_f32_16x16x32_bf16 v[36:39], v[100:103], v[60:63], v[36:39]
    s_add_u32 m0, s75, 49152
    s_add_u32 s39, s67, 3840
    buffer_load_dwordx4 v18, s[20:23], s39 offen lds
    v_mfma_f32_16x16x32_bf16 v[40:43], v[104:107], v[60:63], v[40:43]
    v_mfma_f32_16x16x32_bf16 v[44:47], v[100:103], v[64:67], v[44:47]
    s_add_u32 s38, s34, 102400
    buffer_load_dwordx4 v[92:95], v5, s[24:27], s38 offen offset:0 sc0
    v_mfma_f32_16x16x32_bf16 v[48:51], v[104:107], v[64:67], v[48:51]
    s_add_u32 s38, s34, 102400
    buffer_load_dwordx4 v[96:99], v5, s[24:27], s38 offen offset:1024 sc0
    s_waitcnt vmcnt(18)
    s_waitcnt lgkmcnt(0)
    v_mfma_f32_16x16x32_bf16 v[20:23], v[108:111], v[68:71], v[20:23]
    ds_read_b128 v[52:55], v135 offset:0
    ds_read_b128 v[56:59], v135 offset:2048
    ds_read_b128 v[60:63], v135 offset:4096
    ds_read_b128 v[64:67], v135 offset:6144
    v_mfma_f32_16x16x32_bf16 v[24:27], v[112:115], v[68:71], v[24:27]
    v_mfma_f32_16x16x32_bf16 v[28:31], v[108:111], v[72:75], v[28:31]
    s_add_u32 s38, s34, 106496
    buffer_load_dwordx4 v[100:103], v5, s[24:27], s38 offen offset:0 sc0
    v_mfma_f32_16x16x32_bf16 v[32:35], v[112:115], v[72:75], v[32:35]
    v_mfma_f32_16x16x32_bf16 v[36:39], v[108:111], v[76:79], v[36:39]
    s_add_u32 s38, s34, 106496
    buffer_load_dwordx4 v[104:107], v5, s[24:27], s38 offen offset:1024 sc0
    v_mfma_f32_16x16x32_bf16 v[40:43], v[112:115], v[76:79], v[40:43]
    v_mfma_f32_16x16x32_bf16 v[44:47], v[108:111], v[80:83], v[44:47]
    v_mfma_f32_16x16x32_bf16 v[48:51], v[112:115], v[80:83], v[48:51]
    s_waitcnt vmcnt(18)
    s_waitcnt lgkmcnt(0)
    s_barrier
    v_mfma_f32_16x16x32_bf16 v[20:23], v[116:119], v[52:55], v[20:23]
    ds_read_b128 v[68:71], v135 offset:8192
    ds_read_b128 v[72:75], v135 offset:10240
    ds_read_b128 v[76:79], v135 offset:12288
    ds_read_b128 v[80:83], v135 offset:14336
    v_mfma_f32_16x16x32_bf16 v[24:27], v[120:123], v[52:55], v[24:27]
    v_mfma_f32_16x16x32_bf16 v[28:31], v[116:119], v[56:59], v[28:31]
    s_add_u32 m0, s75, 57344
    s_add_u32 s39, s67, 3968
    buffer_load_dwordx4 v18, s[20:23], s39 offen lds
    v_mfma_f32_16x16x32_bf16 v[32:35], v[120:123], v[56:59], v[32:35]
    v_mfma_f32_16x16x32_bf16 v[36:39], v[116:119], v[60:63], v[36:39]
    s_add_u32 s38, s34, 110592
    buffer_load_dwordx4 v[108:111], v5, s[24:27], s38 offen offset:0 sc0
    v_mfma_f32_16x16x32_bf16 v[40:43], v[120:123], v[60:63], v[40:43]
    v_mfma_f32_16x16x32_bf16 v[44:47], v[116:119], v[64:67], v[44:47]
    s_add_u32 s38, s34, 110592
    buffer_load_dwordx4 v[112:115], v5, s[24:27], s38 offen offset:1024 sc0
    v_mfma_f32_16x16x32_bf16 v[48:51], v[120:123], v[64:67], v[48:51]
    s_waitcnt vmcnt(17)
    s_waitcnt lgkmcnt(0)
    v_mfma_f32_16x16x32_bf16 v[20:23], v[124:127], v[68:71], v[20:23]
    ds_read_b128 v[52:55], v135 offset:16384
    ds_read_b128 v[56:59], v135 offset:18432
    ds_read_b128 v[60:63], v135 offset:20480
    ds_read_b128 v[64:67], v135 offset:22528
    v_mfma_f32_16x16x32_bf16 v[24:27], v[128:131], v[68:71], v[24:27]
    v_mfma_f32_16x16x32_bf16 v[28:31], v[124:127], v[72:75], v[28:31]
    s_add_u32 s38, s34, 114688
    buffer_load_dwordx4 v[116:119], v5, s[24:27], s38 offen offset:0 sc0
    v_mfma_f32_16x16x32_bf16 v[32:35], v[128:131], v[72:75], v[32:35]
    v_mfma_f32_16x16x32_bf16 v[36:39], v[124:127], v[76:79], v[36:39]
    s_add_u32 s38, s34, 114688
    buffer_load_dwordx4 v[120:123], v5, s[24:27], s38 offen offset:1024 sc0
    v_mfma_f32_16x16x32_bf16 v[40:43], v[128:131], v[76:79], v[40:43]
    v_mfma_f32_16x16x32_bf16 v[44:47], v[124:127], v[80:83], v[44:47]
    v_mfma_f32_16x16x32_bf16 v[48:51], v[128:131], v[80:83], v[48:51]
    s_waitcnt vmcnt(17)
    s_waitcnt lgkmcnt(0)
    s_barrier
    v_mfma_f32_16x16x32_bf16 v[20:23], v[144:147], v[52:55], v[20:23]
    ds_read_b128 v[68:71], v135 offset:24576
    ds_read_b128 v[72:75], v135 offset:26624
    ds_read_b128 v[76:79], v135 offset:28672
    ds_read_b128 v[80:83], v135 offset:30720
    ds_write_b128 v14, v[180:183] offset:21824
    ds_write_b128 v14, v[184:187] offset:22848
    ds_write_b128 v14, v[188:191] offset:23872
    ds_write_b128 v14, v[192:195] offset:24896
    ds_write_b128 v14, v[196:199] offset:25920
    ds_write_b128 v14, v[200:203] offset:26944
    ds_write_b128 v14, v[204:207] offset:27968
    v_mfma_f32_16x16x32_bf16 v[24:27], v[148:151], v[52:55], v[24:27]
    v_mfma_f32_16x16x32_bf16 v[28:31], v[144:147], v[56:59], v[28:31]
    s_add_u32 s38, s34, 118784
    buffer_load_dwordx4 v[124:127], v5, s[24:27], s38 offen offset:0 sc0
    v_mfma_f32_16x16x32_bf16 v[32:35], v[148:151], v[56:59], v[32:35]
    v_mfma_f32_16x16x32_bf16 v[36:39], v[144:147], v[60:63], v[36:39]
    s_add_u32 s38, s34, 118784
    buffer_load_dwordx4 v[128:131], v5, s[24:27], s38 offen offset:1024 sc0
    v_mfma_f32_16x16x32_bf16 v[40:43], v[148:151], v[60:63], v[40:43]
    v_mfma_f32_16x16x32_bf16 v[44:47], v[144:147], v[64:67], v[44:47]
    v_mfma_f32_16x16x32_bf16 v[48:51], v[148:151], v[64:67], v[48:51]
    s_waitcnt vmcnt(15)
    s_waitcnt lgkmcnt(0)
    s_barrier
    v_mfma_f32_16x16x32_bf16 v[20:23], v[152:155], v[68:71], v[20:23]
    ds_read_b128 v[52:55], v19 offset:0
    ds_read_b128 v[56:59], v19 offset:2048
    ds_read_b128 v[60:63], v19 offset:4096
    ds_read_b128 v[64:67], v19 offset:6144
    ds_read_b128 v[160:163], v9 offset:0
    ds_read_b128 v[164:167], v9 offset:13568
    ds_read_b128 v[168:171], v9 offset:20800
    ds_read_b128 v[176:179], v9 offset:1024
    ds_read_b128 v[180:183], v9 offset:14592
    ds_read_b128 v[184:187], v9 offset:21824
    v_mfma_f32_16x16x32_bf16 v[24:27], v[156:159], v[68:71], v[24:27]
    v_mfma_f32_16x16x32_bf16 v[28:31], v[152:155], v[72:75], v[28:31]
    s_add_u32 s38, s34, 122880
    buffer_load_dwordx4 v[144:147], v5, s[24:27], s38 offen offset:0 sc0
    v_mfma_f32_16x16x32_bf16 v[32:35], v[156:159], v[72:75], v[32:35]
    v_mfma_f32_16x16x32_bf16 v[36:39], v[152:155], v[76:79], v[36:39]
    s_add_u32 s38, s34, 122880
    buffer_load_dwordx4 v[148:151], v5, s[24:27], s38 offen offset:1024 sc0
    v_mfma_f32_16x16x32_bf16 v[40:43], v[156:159], v[76:79], v[40:43]
    v_mfma_f32_16x16x32_bf16 v[44:47], v[152:155], v[80:83], v[44:47]
    v_mfma_f32_16x16x32_bf16 v[48:51], v[156:159], v[80:83], v[48:51]
    s_waitcnt vmcnt(15)
    s_waitcnt lgkmcnt(0)
    s_barrier
    v_mfma_f32_16x16x32_bf16 v[20:23], v[84:87], v[52:55], v[20:23]
    ds_read_b128 v[68:71], v19 offset:8192
    ds_read_b128 v[72:75], v19 offset:10240
    ds_read_b128 v[76:79], v19 offset:12288
    ds_read_b128 v[80:83], v19 offset:14336
    v_mfma_f32_16x16x32_bf16 v[24:27], v[88:91], v[52:55], v[24:27]
    v_mfma_f32_16x16x32_bf16 v[28:31], v[84:87], v[56:59], v[28:31]
    s_add_u32 s38, s34, 126976
    buffer_load_dwordx4 v[152:155], v5, s[24:27], s38 offen offset:0 sc0
    v_mfma_f32_16x16x32_bf16 v[32:35], v[88:91], v[56:59], v[32:35]
    v_mfma_f32_16x16x32_bf16 v[36:39], v[84:87], v[60:63], v[36:39]
    s_add_u32 s38, s34, 126976
    buffer_load_dwordx4 v[156:159], v5, s[24:27], s38 offen offset:1024 sc0
    v_mfma_f32_16x16x32_bf16 v[40:43], v[88:91], v[60:63], v[40:43]
    v_mfma_f32_16x16x32_bf16 v[44:47], v[84:87], v[64:67], v[44:47]
    v_mfma_f32_16x16x32_bf16 v[48:51], v[88:91], v[64:67], v[48:51]
    v_pk_add_f32 v[164:165], v[164:165], v[168:169]
    v_pk_add_f32 v[160:161], v[160:161], v[164:165]
    v_mul_f32 v160, s74, v160
    v_mul_f32 v161, s74, v161
    v_lshlrev_b32 v192, 16, v252
    v_and_b32 v193, 0xffff0000, v252
    v_mul_f32 v192, s73, v192
    v_mul_f32 v193, s73, v193
    v_cvt_pk_bf16_f32 v252, v192, v193
    v_cvt_pk_bf16_f32 v194, v160, v161
    v_lshlrev_b32 v192, 16, v252
    v_and_b32 v193, 0xffff0000, v252
    v_lshlrev_b32 v160, 16, v194
    v_and_b32 v161, 0xffff0000, v194
    v_pk_add_f32 v[192:193], v[192:193], v[160:161]
    v_cvt_pk_bf16_f32 v252, v192, v193
    v_pk_add_f32 v[166:167], v[166:167], v[170:171]
    v_pk_add_f32 v[162:163], v[162:163], v[166:167]
    v_mul_f32 v162, s74, v162
    v_mul_f32 v163, s74, v163
    v_lshlrev_b32 v196, 16, v253
    v_and_b32 v197, 0xffff0000, v253
    v_mul_f32 v196, s73, v196
    v_mul_f32 v197, s73, v197
    v_cvt_pk_bf16_f32 v253, v196, v197
    v_cvt_pk_bf16_f32 v198, v162, v163
    v_lshlrev_b32 v196, 16, v253
    v_and_b32 v197, 0xffff0000, v253
    v_lshlrev_b32 v162, 16, v198
    v_and_b32 v163, 0xffff0000, v198
    v_pk_add_f32 v[196:197], v[196:197], v[162:163]
    v_cvt_pk_bf16_f32 v253, v196, v197
    buffer_store_dwordx2 v[252:253], v2, s[68:71], 0 offen offset:0 sc1
    s_waitcnt vmcnt(14)
    s_waitcnt lgkmcnt(0)
    v_mfma_f32_16x16x32_bf16 v[20:23], v[92:95], v[68:71], v[20:23]
    ds_read_b128 v[52:55], v19 offset:16384
    ds_read_b128 v[56:59], v19 offset:18432
    ds_read_b128 v[60:63], v19 offset:20480
    ds_read_b128 v[64:67], v19 offset:22528
    v_mfma_f32_16x16x32_bf16 v[24:27], v[96:99], v[68:71], v[24:27]
    v_mfma_f32_16x16x32_bf16 v[28:31], v[92:95], v[72:75], v[28:31]
    v_mfma_f32_16x16x32_bf16 v[32:35], v[96:99], v[72:75], v[32:35]
    v_mfma_f32_16x16x32_bf16 v[36:39], v[92:95], v[76:79], v[36:39]
    v_mfma_f32_16x16x32_bf16 v[40:43], v[96:99], v[76:79], v[40:43]
    v_mfma_f32_16x16x32_bf16 v[44:47], v[92:95], v[80:83], v[44:47]
    v_mfma_f32_16x16x32_bf16 v[48:51], v[96:99], v[80:83], v[48:51]
    v_pk_add_f32 v[180:181], v[180:181], v[184:185]
    v_pk_add_f32 v[176:177], v[176:177], v[180:181]
    v_mul_f32 v176, s74, v176
    v_mul_f32 v177, s74, v177
    v_lshlrev_b32 v200, 16, v254
    v_and_b32 v201, 0xffff0000, v254
    v_mul_f32 v200, s73, v200
    v_mul_f32 v201, s73, v201
    v_cvt_pk_bf16_f32 v254, v200, v201
    v_cvt_pk_bf16_f32 v202, v176, v177
    v_lshlrev_b32 v200, 16, v254
    v_and_b32 v201, 0xffff0000, v254
    v_lshlrev_b32 v176, 16, v202
    v_and_b32 v177, 0xffff0000, v202
    v_pk_add_f32 v[200:201], v[200:201], v[176:177]
    v_cvt_pk_bf16_f32 v254, v200, v201
    v_pk_add_f32 v[182:183], v[182:183], v[186:187]
    v_pk_add_f32 v[178:179], v[178:179], v[182:183]
    v_mul_f32 v178, s74, v178
    v_mul_f32 v179, s74, v179
    v_lshlrev_b32 v204, 16, v255
    v_and_b32 v205, 0xffff0000, v255
    v_mul_f32 v204, s73, v204
    v_mul_f32 v205, s73, v205
    v_cvt_pk_bf16_f32 v255, v204, v205
    v_cvt_pk_bf16_f32 v206, v178, v179
    v_lshlrev_b32 v204, 16, v255
    v_and_b32 v205, 0xffff0000, v255
    v_lshlrev_b32 v178, 16, v206
    v_and_b32 v179, 0xffff0000, v206
    v_pk_add_f32 v[204:205], v[204:205], v[178:179]
    v_cvt_pk_bf16_f32 v255, v204, v205
    buffer_store_dwordx2 v[254:255], v2, s[68:71], 0 offen offset:512 sc1
    s_waitcnt vmcnt(13)
    s_waitcnt lgkmcnt(0)
    s_barrier
    v_mfma_f32_16x16x32_bf16 v[20:23], v[100:103], v[52:55], v[20:23]
    ds_read_b128 v[68:71], v19 offset:24576
    ds_read_b128 v[72:75], v19 offset:26624
    ds_read_b128 v[76:79], v19 offset:28672
    ds_read_b128 v[80:83], v19 offset:30720
    v_mfma_f32_16x16x32_bf16 v[24:27], v[104:107], v[52:55], v[24:27]
    v_mfma_f32_16x16x32_bf16 v[28:31], v[100:103], v[56:59], v[28:31]
    v_mfma_f32_16x16x32_bf16 v[32:35], v[104:107], v[56:59], v[32:35]
    v_mfma_f32_16x16x32_bf16 v[36:39], v[100:103], v[60:63], v[36:39]
    v_mfma_f32_16x16x32_bf16 v[40:43], v[104:107], v[60:63], v[40:43]
    v_mfma_f32_16x16x32_bf16 v[44:47], v[100:103], v[64:67], v[44:47]
    v_mfma_f32_16x16x32_bf16 v[48:51], v[104:107], v[64:67], v[48:51]
    s_waitcnt vmcnt(10)
    s_waitcnt lgkmcnt(0)
    v_mfma_f32_16x16x32_bf16 v[20:23], v[108:111], v[68:71], v[20:23]
    ds_read_b128 v[52:55], v19 offset:32768
    ds_read_b128 v[56:59], v19 offset:34816
    ds_read_b128 v[60:63], v19 offset:36864
    ds_read_b128 v[64:67], v19 offset:38912
    v_mfma_f32_16x16x32_bf16 v[24:27], v[112:115], v[68:71], v[24:27]
    v_mfma_f32_16x16x32_bf16 v[28:31], v[108:111], v[72:75], v[28:31]
    v_mfma_f32_16x16x32_bf16 v[32:35], v[112:115], v[72:75], v[32:35]
    v_mfma_f32_16x16x32_bf16 v[36:39], v[108:111], v[76:79], v[36:39]
    v_mfma_f32_16x16x32_bf16 v[40:43], v[112:115], v[76:79], v[40:43]
    v_mfma_f32_16x16x32_bf16 v[44:47], v[108:111], v[80:83], v[44:47]
    v_mfma_f32_16x16x32_bf16 v[48:51], v[112:115], v[80:83], v[48:51]
    s_waitcnt vmcnt(8)
    s_waitcnt lgkmcnt(0)
    s_barrier
    v_mfma_f32_16x16x32_bf16 v[20:23], v[116:119], v[52:55], v[20:23]
    ds_read_b128 v[68:71], v19 offset:40960
    ds_read_b128 v[72:75], v19 offset:43008
    ds_read_b128 v[76:79], v19 offset:45056
    ds_read_b128 v[80:83], v19 offset:47104
    v_mfma_f32_16x16x32_bf16 v[24:27], v[120:123], v[52:55], v[24:27]
    v_mfma_f32_16x16x32_bf16 v[28:31], v[116:119], v[56:59], v[28:31]
    s_add_u32 s38, s47, 0
    buffer_load_dwordx4 v[160:163], v5, s[24:27], s38 offen offset:0
    v_mfma_f32_16x16x32_bf16 v[32:35], v[120:123], v[56:59], v[32:35]
    v_mfma_f32_16x16x32_bf16 v[36:39], v[116:119], v[60:63], v[36:39]
    s_add_u32 s38, s47, 0
    buffer_load_dwordx4 v[176:179], v5, s[24:27], s38 offen offset:1024
    v_mfma_f32_16x16x32_bf16 v[40:43], v[120:123], v[60:63], v[40:43]
    v_mfma_f32_16x16x32_bf16 v[44:47], v[116:119], v[64:67], v[44:47]
    v_mfma_f32_16x16x32_bf16 v[48:51], v[120:123], v[64:67], v[48:51]
    s_waitcnt vmcnt(8)
    s_waitcnt lgkmcnt(0)
    v_mfma_f32_16x16x32_bf16 v[20:23], v[124:127], v[68:71], v[20:23]
    ds_read_b128 v[52:55], v19 offset:49152
    ds_read_b128 v[56:59], v19 offset:51200
    ds_read_b128 v[60:63], v19 offset:53248
    ds_read_b128 v[64:67], v19 offset:55296
    v_mfma_f32_16x16x32_bf16 v[24:27], v[128:131], v[68:71], v[24:27]
    v_mfma_f32_16x16x32_bf16 v[28:31], v[124:127], v[72:75], v[28:31]
    s_add_u32 s38, s47, 0
    buffer_load_dwordx4 v[192:195], v5, s[24:27], s38 offen offset:2048
    v_mfma_f32_16x16x32_bf16 v[32:35], v[128:131], v[72:75], v[32:35]
    v_mfma_f32_16x16x32_bf16 v[36:39], v[124:127], v[76:79], v[36:39]
    s_add_u32 s38, s47, 0
    buffer_load_dwordx4 v[208:211], v5, s[24:27], s38 offen offset:3072
    v_mfma_f32_16x16x32_bf16 v[40:43], v[128:131], v[76:79], v[40:43]
    v_mfma_f32_16x16x32_bf16 v[44:47], v[124:127], v[80:83], v[44:47]
    v_mfma_f32_16x16x32_bf16 v[48:51], v[128:131], v[80:83], v[48:51]
    s_waitcnt vmcnt(8)
    s_waitcnt lgkmcnt(0)
    s_barrier
    v_mfma_f32_16x16x32_bf16 v[20:23], v[144:147], v[52:55], v[20:23]
    ds_read_b128 v[68:71], v19 offset:57344
    ds_read_b128 v[72:75], v19 offset:59392
    ds_read_b128 v[76:79], v19 offset:61440
    ds_read_b128 v[80:83], v19 offset:63488
    v_mfma_f32_16x16x32_bf16 v[24:27], v[148:151], v[52:55], v[24:27]
    v_mfma_f32_16x16x32_bf16 v[28:31], v[144:147], v[56:59], v[28:31]
    s_add_u32 s38, s47, 28672
    buffer_load_dwordx4 v[164:167], v5, s[24:27], s38 offen offset:0
    v_mfma_f32_16x16x32_bf16 v[32:35], v[148:151], v[56:59], v[32:35]
    v_mfma_f32_16x16x32_bf16 v[36:39], v[144:147], v[60:63], v[36:39]
    s_add_u32 s38, s47, 28672
    buffer_load_dwordx4 v[180:183], v5, s[24:27], s38 offen offset:1024
    v_mfma_f32_16x16x32_bf16 v[40:43], v[148:151], v[60:63], v[40:43]
    v_mfma_f32_16x16x32_bf16 v[44:47], v[144:147], v[64:67], v[44:47]
    v_mfma_f32_16x16x32_bf16 v[48:51], v[148:151], v[64:67], v[48:51]
    s_waitcnt vmcnt(6)
    v_mov_b32 v6, s98
    v_mov_b32 v7, 1
    s_mov_b64 exec, 1
    buffer_store_dword v7, v6, s[24:27], 0 offen sc1
    s_mov_b64 exec, -1
    s_waitcnt lgkmcnt(0)
    v_mfma_f32_16x16x32_bf16 v[20:23], v[152:155], v[68:71], v[20:23]
    v_mfma_f32_16x16x32_bf16 v[24:27], v[156:159], v[68:71], v[24:27]
    v_mfma_f32_16x16x32_bf16 v[28:31], v[152:155], v[72:75], v[28:31]
    s_add_u32 s38, s47, 28672
    buffer_load_dwordx4 v[196:199], v5, s[24:27], s38 offen offset:2048
    v_mfma_f32_16x16x32_bf16 v[32:35], v[156:159], v[72:75], v[32:35]
    v_mfma_f32_16x16x32_bf16 v[36:39], v[152:155], v[76:79], v[36:39]
    s_add_u32 s38, s47, 28672
    buffer_load_dwordx4 v[212:215], v5, s[24:27], s38 offen offset:3072
    v_mfma_f32_16x16x32_bf16 v[40:43], v[156:159], v[76:79], v[40:43]
    v_mfma_f32_16x16x32_bf16 v[44:47], v[152:155], v[80:83], v[44:47]
    v_mfma_f32_16x16x32_bf16 v[48:51], v[156:159], v[80:83], v[48:51]
gf_kernel_cd:
    v_lshlrev_b32 v16, 16, v16
    v_lshlrev_b32 v17, 16, v17
    s_lshl_b32 s38, s3, 12
    v_add_u32 v6, s38, v5
    s_nop 7
    s_nop 3
    s_cmp_eq_u32 s36, 0
    s_cbranch_scc1 x0_37
    ds_write_b128 v6, v[20:23] offset:0
    ds_write_b128 v6, v[24:27] offset:1024
    ds_write_b128 v6, v[28:31] offset:2048
    ds_write_b128 v6, v[32:35] offset:3072
    v_mov_b32 v20, v36
    v_mov_b32 v21, v37
    v_mov_b32 v22, v38
    v_mov_b32 v23, v39
    v_mov_b32 v24, v40
    v_mov_b32 v25, v41
    v_mov_b32 v26, v42
    v_mov_b32 v27, v43
    v_mov_b32 v28, v44
    v_mov_b32 v29, v45
    v_mov_b32 v30, v46
    v_mov_b32 v31, v47
    v_mov_b32 v32, v48
    v_mov_b32 v33, v49
    v_mov_b32 v34, v50
    v_mov_b32 v35, v51
    s_branch x1_38
x0_37:
    ds_write_b128 v6, v[36:39] offset:0
    ds_write_b128 v6, v[40:43] offset:1024
    ds_write_b128 v6, v[44:47] offset:2048
    ds_write_b128 v6, v[48:51] offset:3072
x1_38:
    s_xor_b32 s38, s3, 4
    s_lshl_b32 s38, s38, 12
    v_add_u32 v7, s38, v5
    s_waitcnt lgkmcnt(0)
    s_barrier
    ds_read_b128 v[36:39], v7 offset:0
    ds_read_b128 v[40:43], v7 offset:1024
    ds_read_b128 v[44:47], v7 offset:2048
    ds_read_b128 v[48:51], v7 offset:3072
    s_lshl_b32 s39, s30, 2
    s_lshl_b32 s38, s36, 1
    s_add_u32 s39, s39, s38
    s_mul_i32 s39, s39, 28
    s_add_u32 s38, s39, s35
    s_lshl_b32 s38, s38, 10
    s_add_u32 s38, s38, 10485760
    s_add_u32 s33, s38, 28672
    s_waitcnt lgkmcnt(0)
    v_pk_add_f32 v[20:21], v[20:21], v[36:37]
    v_pk_add_f32 v[22:23], v[22:23], v[38:39]
    v_pk_add_f32 v[24:25], v[24:25], v[40:41]
    v_pk_add_f32 v[26:27], v[26:27], v[42:43]
    v_pk_add_f32 v[28:29], v[28:29], v[44:45]
    v_pk_add_f32 v[30:31], v[30:31], v[46:47]
    v_pk_add_f32 v[32:33], v[32:33], v[48:49]
    v_pk_add_f32 v[34:35], v[34:35], v[50:51]
    v_cvt_pk_bf16_f32 v52, v20, v21
    v_cvt_pk_bf16_f32 v53, v22, v23
    v_lshlrev_b32 v20, 16, v52
    v_and_b32 v21, 0xffff0000, v52
    v_lshlrev_b32 v22, 16, v53
    v_and_b32 v23, 0xffff0000, v53
    v_add_f32 v20, v20, v16
    v_add_f32 v21, v21, v16
    v_add_f32 v22, v22, v16
    v_add_f32 v23, v23, v16
    v_cvt_pk_bf16_f32 v52, v20, v21
    v_cvt_pk_bf16_f32 v53, v22, v23
    v_lshlrev_b32 v20, 16, v52
    v_and_b32 v21, 0xffff0000, v52
    v_lshlrev_b32 v22, 16, v53
    v_and_b32 v23, 0xffff0000, v53
    v_lshlrev_b32 v54, 16, v136
    v_and_b32 v55, 0xffff0000, v136
    v_lshlrev_b32 v56, 16, v137
    v_and_b32 v57, 0xffff0000, v137
    v_mul_f32 v20, v20, v54
    v_mul_f32 v21, v21, v55
    v_mul_f32 v22, v22, v56
    v_mul_f32 v23, v23, v57
    v_cvt_pk_bf16_f32 v136, v20, v21
    v_cvt_pk_bf16_f32 v137, v22, v23
    v_cvt_pk_bf16_f32 v58, v24, v25
    v_cvt_pk_bf16_f32 v59, v26, v27
    v_lshlrev_b32 v24, 16, v58
    v_and_b32 v25, 0xffff0000, v58
    v_lshlrev_b32 v26, 16, v59
    v_and_b32 v27, 0xffff0000, v59
    v_add_f32 v24, v24, v16
    v_add_f32 v25, v25, v16
    v_add_f32 v26, v26, v16
    v_add_f32 v27, v27, v16
    v_cvt_pk_bf16_f32 v58, v24, v25
    v_cvt_pk_bf16_f32 v59, v26, v27
    v_lshlrev_b32 v24, 16, v58
    v_and_b32 v25, 0xffff0000, v58
    v_lshlrev_b32 v26, 16, v59
    v_and_b32 v27, 0xffff0000, v59
    v_lshlrev_b32 v60, 16, v138
    v_and_b32 v61, 0xffff0000, v138
    v_lshlrev_b32 v62, 16, v139
    v_and_b32 v63, 0xffff0000, v139
    v_mul_f32 v24, v24, v60
    v_mul_f32 v25, v25, v61
    v_mul_f32 v26, v26, v62
    v_mul_f32 v27, v27, v63
    v_cvt_pk_bf16_f32 v138, v24, v25
    v_cvt_pk_bf16_f32 v139, v26, v27
    buffer_store_dwordx4 v[136:139], v5, s[24:27], s38 offen sc1
    v_cvt_pk_bf16_f32 v64, v28, v29
    v_cvt_pk_bf16_f32 v65, v30, v31
    v_lshlrev_b32 v28, 16, v64
    v_and_b32 v29, 0xffff0000, v64
    v_lshlrev_b32 v30, 16, v65
    v_and_b32 v31, 0xffff0000, v65
    v_add_f32 v28, v28, v17
    v_add_f32 v29, v29, v17
    v_add_f32 v30, v30, v17
    v_add_f32 v31, v31, v17
    v_cvt_pk_bf16_f32 v64, v28, v29
    v_cvt_pk_bf16_f32 v65, v30, v31
    v_lshlrev_b32 v28, 16, v64
    v_and_b32 v29, 0xffff0000, v64
    v_lshlrev_b32 v30, 16, v65
    v_and_b32 v31, 0xffff0000, v65
    v_lshlrev_b32 v66, 16, v140
    v_and_b32 v67, 0xffff0000, v140
    v_lshlrev_b32 v68, 16, v141
    v_and_b32 v69, 0xffff0000, v141
    v_mul_f32 v28, v28, v66
    v_mul_f32 v29, v29, v67
    v_mul_f32 v30, v30, v68
    v_mul_f32 v31, v31, v69
    v_cvt_pk_bf16_f32 v140, v28, v29
    v_cvt_pk_bf16_f32 v141, v30, v31
    v_cvt_pk_bf16_f32 v70, v32, v33
    v_cvt_pk_bf16_f32 v71, v34, v35
    v_lshlrev_b32 v32, 16, v70
    v_and_b32 v33, 0xffff0000, v70
    v_lshlrev_b32 v34, 16, v71
    v_and_b32 v35, 0xffff0000, v71
    v_add_f32 v32, v32, v17
    v_add_f32 v33, v33, v17
    v_add_f32 v34, v34, v17
    v_add_f32 v35, v35, v17
    v_cvt_pk_bf16_f32 v70, v32, v33
    v_cvt_pk_bf16_f32 v71, v34, v35
    v_lshlrev_b32 v32, 16, v70
    v_and_b32 v33, 0xffff0000, v70
    v_lshlrev_b32 v34, 16, v71
    v_and_b32 v35, 0xffff0000, v71
    v_lshlrev_b32 v72, 16, v142
    v_and_b32 v73, 0xffff0000, v142
    v_lshlrev_b32 v74, 16, v143
    v_and_b32 v75, 0xffff0000, v143
    v_mul_f32 v32, v32, v72
    v_mul_f32 v33, v33, v73
    v_mul_f32 v34, v34, v74
    v_mul_f32 v35, v35, v75
    v_cvt_pk_bf16_f32 v142, v32, v33
    v_cvt_pk_bf16_f32 v143, v34, v35
    buffer_store_dwordx4 v[140:143], v5, s[24:27], s33 offen sc1
    s_lshr_b32 s32, s3, 1
    s_lshl_b32 s38, s30, 2
    s_add_u32 s38, s38, s32
    s_mul_i32 s67, s38, 14336
    s_lshl_b32 s38, s31, 7
    s_add_u32 s67, s67, s38
    s_and_b32 s38, s3, 1
    s_lshl_b32 s38, s38, 4
    s_add_u32 s67, s67, s38
    v_mul_u32_u24 v18, 896, v3
    v_lshl_add_u32 v18, v4, 5, v18
    buffer_load_dwordx4 v[12:15], v18, s[16:19], s67 offen
    s_cmp_eq_u32 s3, 7
    s_cbranch_scc1 gf_kernel_w7
    s_lshl_b32 s39, s3, 2
    s_add_u32 s38, s47, 57344
    buffer_load_dwordx4 v[168:171], v5, s[24:27], s38 offen offset:0
    s_add_u32 s38, s47, 57344
    buffer_load_dwordx4 v[184:187], v5, s[24:27], s38 offen offset:1024
    s_add_u32 s38, s47, 57344
    buffer_load_dwordx4 v[200:203], v5, s[24:27], s38 offen offset:2048
    s_add_u32 s38, s47, 57344
    buffer_load_dwordx4 v[216:219], v5, s[24:27], s38 offen offset:3072
    s_add_u32 s38, s47, 86016
    buffer_load_dwordx4 v[172:175], v5, s[24:27], s38 offen offset:0
    s_add_u32 s38, s47, 86016
    buffer_load_dwordx4 v[188:191], v5, s[24:27], s38 offen offset:1024
    s_add_u32 s38, s47, 86016
    buffer_load_dwordx4 v[204:207], v5, s[24:27], s38 offen offset:2048
    s_add_u32 s38, s47, 86016
    buffer_load_dwordx4 v[220:223], v5, s[24:27], s38 offen offset:3072
    s_barrier
    s_lshl_b32 s38, s30, 8
    s_lshl_b32 s33, s3, 5
    s_add_u32 s38, s38, s33
    s_add_u32 s38, s38, 18087936
    s_sleep 8
    s_mul_i32 s38, s30, 112
    s_add_u32 s38, s38, s39
    s_lshl_b32 s38, s38, 10
    s_add_u32 s38, s38, 10485760
    s_add_u32 s33, s38, 28672
    s_add_u32 s34, s38, 57344
    s_add_u32 s35, s38, 86016
    s_mov_b32 s42, 0
    buffer_load_dwordx4 v[52:55], v5, s[24:27], s38 offen offset:0
    buffer_load_dwordx4 v[56:59], v5, s[24:27], s33 offen offset:0
    buffer_load_dwordx4 v[60:63], v5, s[24:27], s34 offen offset:0
    buffer_load_dwordx4 v[64:67], v5, s[24:27], s35 offen offset:0
    buffer_load_dwordx4 v[68:71], v5, s[24:27], s38 offen offset:1024
    buffer_load_dwordx4 v[72:75], v5, s[24:27], s33 offen offset:1024
    buffer_load_dwordx4 v[76:79], v5, s[24:27], s34 offen offset:1024
    buffer_load_dwordx4 v[80:83], v5, s[24:27], s35 offen offset:1024
    buffer_load_dwordx4 v[84:87], v5, s[24:27], s38 offen offset:2048
    buffer_load_dwordx4 v[88:91], v5, s[24:27], s33 offen offset:2048
    buffer_load_dwordx4 v[92:95], v5, s[24:27], s34 offen offset:2048
    buffer_load_dwordx4 v[96:99], v5, s[24:27], s35 offen offset:2048
    buffer_load_dwordx4 v[100:103], v5, s[24:27], s38 offen offset:3072
    buffer_load_dwordx4 v[104:107], v5, s[24:27], s33 offen offset:3072
    buffer_load_dwordx4 v[108:111], v5, s[24:27], s34 offen offset:3072
    buffer_load_dwordx4 v[112:115], v5, s[24:27], s35 offen offset:3072
    v_mov_b32 v6, 0
    s_waitcnt vmcnt(15)
    v_mfma_f32_16x16x32_bf16 v[20:23], v[160:163], v[52:55], 0
    v_max3_u32 v6, v6, v52, v53
    v_mfma_f32_16x16x32_bf16 v[24:27], v[164:167], v[52:55], 0
    v_max3_u32 v6, v6, v54, v55
    v_mfma_f32_16x16x32_bf16 v[28:31], v[168:171], v[52:55], 0
    v_mfma_f32_16x16x32_bf16 v[32:35], v[172:175], v[52:55], 0
    s_waitcnt vmcnt(14)
    v_mfma_f32_16x16x32_bf16 v[36:39], v[160:163], v[56:59], 0
    v_max3_u32 v6, v6, v56, v57
    v_mfma_f32_16x16x32_bf16 v[40:43], v[164:167], v[56:59], 0
    v_max3_u32 v6, v6, v58, v59
    v_mfma_f32_16x16x32_bf16 v[44:47], v[168:171], v[56:59], 0
    v_mfma_f32_16x16x32_bf16 v[48:51], v[172:175], v[56:59], 0
    s_waitcnt vmcnt(13)
    v_mfma_f32_16x16x32_bf16 v[224:227], v[160:163], v[60:63], 0
    v_max3_u32 v6, v6, v60, v61
    v_mfma_f32_16x16x32_bf16 v[228:231], v[164:167], v[60:63], 0
    v_max3_u32 v6, v6, v62, v63
    v_mfma_f32_16x16x32_bf16 v[232:235], v[168:171], v[60:63], 0
    v_mfma_f32_16x16x32_bf16 v[236:239], v[172:175], v[60:63], 0
    s_waitcnt vmcnt(12)
    v_mfma_f32_16x16x32_bf16 v[240:243], v[160:163], v[64:67], 0
    v_max3_u32 v6, v6, v64, v65
    v_mfma_f32_16x16x32_bf16 v[244:247], v[164:167], v[64:67], 0
    v_max3_u32 v6, v6, v66, v67
    v_mfma_f32_16x16x32_bf16 v[248:251], v[168:171], v[64:67], 0
    v_mfma_f32_16x16x32_bf16 v[252:255], v[172:175], v[64:67], 0
    v_cmp_eq_u32 vcc, -1, v6
    s_cmp_eq_u64 vcc, 0
    s_cbranch_scc0 gf_kernel_h0
    s_waitcnt vmcnt(11)
    v_mfma_f32_16x16x32_bf16 v[20:23], v[176:179], v[68:71], v[20:23]
    v_max3_u32 v6, v6, v68, v69
    v_mfma_f32_16x16x32_bf16 v[24:27], v[180:183], v[68:71], v[24:27]
    v_max3_u32 v6, v6, v70, v71
    v_mfma_f32_16x16x32_bf16 v[28:31], v[184:187], v[68:71], v[28:31]
    v_mfma_f32_16x16x32_bf16 v[32:35], v[188:191], v[68:71], v[32:35]
    s_waitcnt vmcnt(10)
    v_mfma_f32_16x16x32_bf16 v[36:39], v[176:179], v[72:75], v[36:39]
    v_max3_u32 v6, v6, v72, v73
    v_mfma_f32_16x16x32_bf16 v[40:43], v[180:183], v[72:75], v[40:43]
    v_max3_u32 v6, v6, v74, v75
    v_mfma_f32_16x16x32_bf16 v[44:47], v[184:187], v[72:75], v[44:47]
    v_mfma_f32_16x16x32_bf16 v[48:51], v[188:191], v[72:75], v[48:51]
    s_waitcnt vmcnt(9)
    v_mfma_f32_16x16x32_bf16 v[224:227], v[176:179], v[76:79], v[224:227]
    v_max3_u32 v6, v6, v76, v77
    v_mfma_f32_16x16x32_bf16 v[228:231], v[180:183], v[76:79], v[228:231]
    v_max3_u32 v6, v6, v78, v79
    v_mfma_f32_16x16x32_bf16 v[232:235], v[184:187], v[76:79], v[232:235]
    v_mfma_f32_16x16x32_bf16 v[236:239], v[188:191], v[76:79], v[236:239]
    s_waitcnt vmcnt(8)
    v_mfma_f32_16x16x32_bf16 v[240:243], v[176:179], v[80:83], v[240:243]
    v_max3_u32 v6, v6, v80, v81
    v_mfma_f32_16x16x32_bf16 v[244:247], v[180:183], v[80:83], v[244:247]
    v_max3_u32 v6, v6, v82, v83
    v_mfma_f32_16x16x32_bf16 v[248:251], v[184:187], v[80:83], v[248:251]
    v_mfma_f32_16x16x32_bf16 v[252:255], v[188:191], v[80:83], v[252:255]
    v_cmp_eq_u32 vcc, -1, v6
    s_cmp_eq_u64 vcc, 0
    s_cbranch_scc0 gf_kernel_h0
    s_waitcnt vmcnt(7)
    v_mfma_f32_16x16x32_bf16 v[20:23], v[192:195], v[84:87], v[20:23]
    v_max3_u32 v6, v6, v84, v85
    v_mfma_f32_16x16x32_bf16 v[24:27], v[196:199], v[84:87], v[24:27]
    v_max3_u32 v6, v6, v86, v87
    v_mfma_f32_16x16x32_bf16 v[28:31], v[200:203], v[84:87], v[28:31]
    v_mfma_f32_16x16x32_bf16 v[32:35], v[204:207], v[84:87], v[32:35]
    s_waitcnt vmcnt(6)
    v_mfma_f32_16x16x32_bf16 v[36:39], v[192:195], v[88:91], v[36:39]
    v_max3_u32 v6, v6, v88, v89
    v_mfma_f32_16x16x32_bf16 v[40:43], v[196:199], v[88:91], v[40:43]
    v_max3_u32 v6, v6, v90, v91
    v_mfma_f32_16x16x32_bf16 v[44:47], v[200:203], v[88:91], v[44:47]
    v_mfma_f32_16x16x32_bf16 v[48:51], v[204:207], v[88:91], v[48:51]
    s_waitcnt vmcnt(5)
    v_mfma_f32_16x16x32_bf16 v[224:227], v[192:195], v[92:95], v[224:227]
    v_max3_u32 v6, v6, v92, v93
    v_mfma_f32_16x16x32_bf16 v[228:231], v[196:199], v[92:95], v[228:231]
    v_max3_u32 v6, v6, v94, v95
    v_mfma_f32_16x16x32_bf16 v[232:235], v[200:203], v[92:95], v[232:235]
    v_mfma_f32_16x16x32_bf16 v[236:239], v[204:207], v[92:95], v[236:239]
    s_waitcnt vmcnt(4)
    v_mfma_f32_16x16x32_bf16 v[240:243], v[192:195], v[96:99], v[240:243]
    v_max3_u32 v6, v6, v96, v97
    v_mfma_f32_16x16x32_bf16 v[244:247], v[196:199], v[96:99], v[244:247]
    v_max3_u32 v6, v6, v98, v99
    v_mfma_f32_16x16x32_bf16 v[248:251], v[200:203], v[96:99], v[248:251]
    v_mfma_f32_16x16x32_bf16 v[252:255], v[204:207], v[96:99], v[252:255]
    v_cmp_eq_u32 vcc, -1, v6
    s_cmp_eq_u64 vcc, 0
    s_cbranch_scc0 gf_kernel_h0
    s_waitcnt vmcnt(3)
    v_mfma_f32_16x16x32_bf16 v[20:23], v[208:211], v[100:103], v[20:23]
    v_max3_u32 v6, v6, v100, v101
    v_mfma_f32_16x16x32_bf16 v[24:27], v[212:215], v[100:103], v[24:27]
    v_max3_u32 v6, v6, v102, v103
    v_mfma_f32_16x16x32_bf16 v[28:31], v[216:219], v[100:103], v[28:31]
    v_mfma_f32_16x16x32_bf16 v[32:35], v[220:223], v[100:103], v[32:35]
    s_waitcnt vmcnt(2)
    v_mfma_f32_16x16x32_bf16 v[36:39], v[208:211], v[104:107], v[36:39]
    v_max3_u32 v6, v6, v104, v105
    v_mfma_f32_16x16x32_bf16 v[40:43], v[212:215], v[104:107], v[40:43]
    v_max3_u32 v6, v6, v106, v107
    v_mfma_f32_16x16x32_bf16 v[44:47], v[216:219], v[104:107], v[44:47]
    v_mfma_f32_16x16x32_bf16 v[48:51], v[220:223], v[104:107], v[48:51]
    s_waitcnt vmcnt(1)
    v_mfma_f32_16x16x32_bf16 v[224:227], v[208:211], v[108:111], v[224:227]
    v_max3_u32 v6, v6, v108, v109
    v_mfma_f32_16x16x32_bf16 v[228:231], v[212:215], v[108:111], v[228:231]
    v_max3_u32 v6, v6, v110, v111
    v_mfma_f32_16x16x32_bf16 v[232:235], v[216:219], v[108:111], v[232:235]
    v_mfma_f32_16x16x32_bf16 v[236:239], v[220:223], v[108:111], v[236:239]
    s_waitcnt vmcnt(0)
    v_mfma_f32_16x16x32_bf16 v[240:243], v[208:211], v[112:115], v[240:243]
    v_max3_u32 v6, v6, v112, v113
    v_mfma_f32_16x16x32_bf16 v[244:247], v[212:215], v[112:115], v[244:247]
    v_max3_u32 v6, v6, v114, v115
    v_mfma_f32_16x16x32_bf16 v[248:251], v[216:219], v[112:115], v[248:251]
    v_mfma_f32_16x16x32_bf16 v[252:255], v[220:223], v[112:115], v[252:255]
    v_cmp_eq_u32 vcc, -1, v6
    s_cmp_eq_u64 vcc, 0
    s_cbranch_scc1 gf_kernel_h1
gf_kernel_h0:
    v_bfe_u32 v7, v1, 2, 1
    v_mul_u32_u24 v7, 57344, v7
    v_and_b32 v6, 3, v1
    v_lshl_add_u32 v7, v6, 10, v7
    v_add_u32 v7, 29692, v7
gf_kernel_h2:
    buffer_load_dword v6, v7, s[24:27], s38 offen sc1
    s_add_u32 s42, s42, 1
    s_cmp_gt_u32 s42, 20000
    s_cbranch_scc1 gf_kernel_h3
    s_waitcnt vmcnt(0)
    v_cmp_eq_u32 vcc, -1, v6
    s_cmp_eq_u64 vcc, 0
    s_cbranch_scc1 gf_kernel_h3
    s_sleep 2
    s_branch gf_kernel_h2
gf_kernel_h3:
    s_waitcnt vmcnt(0)
    buffer_load_dwordx4 v[52:55], v5, s[24:27], s38 offen offset:0 sc1
    buffer_load_dwordx4 v[56:59], v5, s[24:27], s33 offen offset:0 sc1
    buffer_load_dwordx4 v[60:63], v5, s[24:27], s34 offen offset:0 sc1
    buffer_load_dwordx4 v[64:67], v5, s[24:27], s35 offen offset:0 sc1
    buffer_load_dwordx4 v[68:71], v5, s[24:27], s38 offen offset:1024 sc1
    buffer_load_dwordx4 v[72:75], v5, s[24:27], s33 offen offset:1024 sc1
    buffer_load_dwordx4 v[76:79], v5, s[24:27], s34 offen offset:1024 sc1
    buffer_load_dwordx4 v[80:83], v5, s[24:27], s35 offen offset:1024 sc1
    buffer_load_dwordx4 v[84:87], v5, s[24:27], s38 offen offset:2048 sc1
    buffer_load_dwordx4 v[88:91], v5, s[24:27], s33 offen offset:2048 sc1
    buffer_load_dwordx4 v[92:95], v5, s[24:27], s34 offen offset:2048 sc1
    buffer_load_dwordx4 v[96:99], v5, s[24:27], s35 offen offset:2048 sc1
    buffer_load_dwordx4 v[100:103], v5, s[24:27], s38 offen offset:3072 sc1
    buffer_load_dwordx4 v[104:107], v5, s[24:27], s33 offen offset:3072 sc1
    buffer_load_dwordx4 v[108:111], v5, s[24:27], s34 offen offset:3072 sc1
    buffer_load_dwordx4 v[112:115], v5, s[24:27], s35 offen offset:3072 sc1
    v_mov_b32 v6, 0
    s_waitcnt vmcnt(15)
    v_mfma_f32_16x16x32_bf16 v[20:23], v[160:163], v[52:55], 0
    v_max3_u32 v6, v6, v52, v53
    v_mfma_f32_16x16x32_bf16 v[24:27], v[164:167], v[52:55], 0
    v_max3_u32 v6, v6, v54, v55
    v_mfma_f32_16x16x32_bf16 v[28:31], v[168:171], v[52:55], 0
    v_mfma_f32_16x16x32_bf16 v[32:35], v[172:175], v[52:55], 0
    s_waitcnt vmcnt(14)
    v_mfma_f32_16x16x32_bf16 v[36:39], v[160:163], v[56:59], 0
    v_max3_u32 v6, v6, v56, v57
    v_mfma_f32_16x16x32_bf16 v[40:43], v[164:167], v[56:59], 0
    v_max3_u32 v6, v6, v58, v59
    v_mfma_f32_16x16x32_bf16 v[44:47], v[168:171], v[56:59], 0
    v_mfma_f32_16x16x32_bf16 v[48:51], v[172:175], v[56:59], 0
    s_waitcnt vmcnt(13)
    v_mfma_f32_16x16x32_bf16 v[224:227], v[160:163], v[60:63], 0
    v_max3_u32 v6, v6, v60, v61
    v_mfma_f32_16x16x32_bf16 v[228:231], v[164:167], v[60:63], 0
    v_max3_u32 v6, v6, v62, v63
    v_mfma_f32_16x16x32_bf16 v[232:235], v[168:171], v[60:63], 0
    v_mfma_f32_16x16x32_bf16 v[236:239], v[172:175], v[60:63], 0
    s_waitcnt vmcnt(12)
    v_mfma_f32_16x16x32_bf16 v[240:243], v[160:163], v[64:67], 0
    v_max3_u32 v6, v6, v64, v65
    v_mfma_f32_16x16x32_bf16 v[244:247], v[164:167], v[64:67], 0
    v_max3_u32 v6, v6, v66, v67
    v_mfma_f32_16x16x32_bf16 v[248:251], v[168:171], v[64:67], 0
    v_mfma_f32_16x16x32_bf16 v[252:255], v[172:175], v[64:67], 0
    s_waitcnt vmcnt(11)
    v_mfma_f32_16x16x32_bf16 v[20:23], v[176:179], v[68:71], v[20:23]
    v_max3_u32 v6, v6, v68, v69
    v_mfma_f32_16x16x32_bf16 v[24:27], v[180:183], v[68:71], v[24:27]
    v_max3_u32 v6, v6, v70, v71
    v_mfma_f32_16x16x32_bf16 v[28:31], v[184:187], v[68:71], v[28:31]
    v_mfma_f32_16x16x32_bf16 v[32:35], v[188:191], v[68:71], v[32:35]
    s_waitcnt vmcnt(10)
    v_mfma_f32_16x16x32_bf16 v[36:39], v[176:179], v[72:75], v[36:39]
    v_max3_u32 v6, v6, v72, v73
    v_mfma_f32_16x16x32_bf16 v[40:43], v[180:183], v[72:75], v[40:43]
    v_max3_u32 v6, v6, v74, v75
    v_mfma_f32_16x16x32_bf16 v[44:47], v[184:187], v[72:75], v[44:47]
    v_mfma_f32_16x16x32_bf16 v[48:51], v[188:191], v[72:75], v[48:51]
    s_waitcnt vmcnt(9)
    v_mfma_f32_16x16x32_bf16 v[224:227], v[176:179], v[76:79], v[224:227]
    v_max3_u32 v6, v6, v76, v77
    v_mfma_f32_16x16x32_bf16 v[228:231], v[180:183], v[76:79], v[228:231]
    v_max3_u32 v6, v6, v78, v79
    v_mfma_f32_16x16x32_bf16 v[232:235], v[184:187], v[76:79], v[232:235]
    v_mfma_f32_16x16x32_bf16 v[236:239], v[188:191], v[76:79], v[236:239]
    s_waitcnt vmcnt(8)
    v_mfma_f32_16x16x32_bf16 v[240:243], v[176:179], v[80:83], v[240:243]
    v_max3_u32 v6, v6, v80, v81
    v_mfma_f32_16x16x32_bf16 v[244:247], v[180:183], v[80:83], v[244:247]
    v_max3_u32 v6, v6, v82, v83
    v_mfma_f32_16x16x32_bf16 v[248:251], v[184:187], v[80:83], v[248:251]
    v_mfma_f32_16x16x32_bf16 v[252:255], v[188:191], v[80:83], v[252:255]
    s_waitcnt vmcnt(7)
    v_mfma_f32_16x16x32_bf16 v[20:23], v[192:195], v[84:87], v[20:23]
    v_max3_u32 v6, v6, v84, v85
    v_mfma_f32_16x16x32_bf16 v[24:27], v[196:199], v[84:87], v[24:27]
    v_max3_u32 v6, v6, v86, v87
    v_mfma_f32_16x16x32_bf16 v[28:31], v[200:203], v[84:87], v[28:31]
    v_mfma_f32_16x16x32_bf16 v[32:35], v[204:207], v[84:87], v[32:35]
    s_waitcnt vmcnt(6)
    v_mfma_f32_16x16x32_bf16 v[36:39], v[192:195], v[88:91], v[36:39]
    v_max3_u32 v6, v6, v88, v89
    v_mfma_f32_16x16x32_bf16 v[40:43], v[196:199], v[88:91], v[40:43]
    v_max3_u32 v6, v6, v90, v91
    v_mfma_f32_16x16x32_bf16 v[44:47], v[200:203], v[88:91], v[44:47]
    v_mfma_f32_16x16x32_bf16 v[48:51], v[204:207], v[88:91], v[48:51]
    s_waitcnt vmcnt(5)
    v_mfma_f32_16x16x32_bf16 v[224:227], v[192:195], v[92:95], v[224:227]
    v_max3_u32 v6, v6, v92, v93
    v_mfma_f32_16x16x32_bf16 v[228:231], v[196:199], v[92:95], v[228:231]
    v_max3_u32 v6, v6, v94, v95
    v_mfma_f32_16x16x32_bf16 v[232:235], v[200:203], v[92:95], v[232:235]
    v_mfma_f32_16x16x32_bf16 v[236:239], v[204:207], v[92:95], v[236:239]
    s_waitcnt vmcnt(4)
    v_mfma_f32_16x16x32_bf16 v[240:243], v[192:195], v[96:99], v[240:243]
    v_max3_u32 v6, v6, v96, v97
    v_mfma_f32_16x16x32_bf16 v[244:247], v[196:199], v[96:99], v[244:247]
    v_max3_u32 v6, v6, v98, v99
    v_mfma_f32_16x16x32_bf16 v[248:251], v[200:203], v[96:99], v[248:251]
    v_mfma_f32_16x16x32_bf16 v[252:255], v[204:207], v[96:99], v[252:255]
    s_waitcnt vmcnt(3)
    v_mfma_f32_16x16x32_bf16 v[20:23], v[208:211], v[100:103], v[20:23]
    v_max3_u32 v6, v6, v100, v101
    v_mfma_f32_16x16x32_bf16 v[24:27], v[212:215], v[100:103], v[24:27]
    v_max3_u32 v6, v6, v102, v103
    v_mfma_f32_16x16x32_bf16 v[28:31], v[216:219], v[100:103], v[28:31]
    v_mfma_f32_16x16x32_bf16 v[32:35], v[220:223], v[100:103], v[32:35]
    s_waitcnt vmcnt(2)
    v_mfma_f32_16x16x32_bf16 v[36:39], v[208:211], v[104:107], v[36:39]
    v_max3_u32 v6, v6, v104, v105
    v_mfma_f32_16x16x32_bf16 v[40:43], v[212:215], v[104:107], v[40:43]
    v_max3_u32 v6, v6, v106, v107
    v_mfma_f32_16x16x32_bf16 v[44:47], v[216:219], v[104:107], v[44:47]
    v_mfma_f32_16x16x32_bf16 v[48:51], v[220:223], v[104:107], v[48:51]
    s_waitcnt vmcnt(1)
    v_mfma_f32_16x16x32_bf16 v[224:227], v[208:211], v[108:111], v[224:227]
    v_max3_u32 v6, v6, v108, v109
    v_mfma_f32_16x16x32_bf16 v[228:231], v[212:215], v[108:111], v[228:231]
    v_max3_u32 v6, v6, v110, v111
    v_mfma_f32_16x16x32_bf16 v[232:235], v[216:219], v[108:111], v[232:235]
    v_mfma_f32_16x16x32_bf16 v[236:239], v[220:223], v[108:111], v[236:239]
    s_waitcnt vmcnt(0)
    v_mfma_f32_16x16x32_bf16 v[240:243], v[208:211], v[112:115], v[240:243]
    v_max3_u32 v6, v6, v112, v113
    v_mfma_f32_16x16x32_bf16 v[244:247], v[212:215], v[112:115], v[244:247]
    v_max3_u32 v6, v6, v114, v115
    v_mfma_f32_16x16x32_bf16 v[248:251], v[216:219], v[112:115], v[248:251]
    v_mfma_f32_16x16x32_bf16 v[252:255], v[220:223], v[112:115], v[252:255]
    v_cmp_eq_u32 vcc, -1, v6
    s_cmp_eq_u64 vcc, 0
    s_cbranch_scc1 gf_kernel_h1
    s_cmp_lt_u32 s42, 20000
    s_cbranch_scc1 gf_kernel_h2
gf_kernel_h1:
    s_lshl_b32 s38, s3, 14
    s_add_u32 s38, s38, 8192
    v_add_u32 v7, s38, v5
    s_nop 7
    ds_write_b128 v7, v[20:23] offset:0
    ds_write_b128 v7, v[24:27] offset:1024
    ds_write_b128 v7, v[28:31] offset:2048
    ds_write_b128 v7, v[32:35] offset:3072
    ds_write_b128 v7, v[36:39] offset:4096
    ds_write_b128 v7, v[40:43] offset:5120
    ds_write_b128 v7, v[44:47] offset:6144
    ds_write_b128 v7, v[48:51] offset:7168
    ds_write_b128 v7, v[224:227] offset:8192
    ds_write_b128 v7, v[228:231] offset:9216
    ds_write_b128 v7, v[232:235] offset:10240
    ds_write_b128 v7, v[236:239] offset:11264
    ds_write_b128 v7, v[240:243] offset:12288
    ds_write_b128 v7, v[244:247] offset:13312
    ds_write_b128 v7, v[248:251] offset:14336
    ds_write_b128 v7, v[252:255] offset:15360
    s_branch gf_kernel_w7d
gf_kernel_w7:
    s_barrier
    s_lshl_b32 s38, s31, 10
    s_lshr_b32 s33, s30, 3
    s_lshl_b32 s33, s33, 8
    s_add_u32 s38, s38, s33
    s_add_u32 s38, s38, 18104320
    v_mul_u32_u24 v6, 4, v1
    s_mov_b32 s42, 0
    s_mov_b32 exec_hi, -1
    s_mov_b32 exec_lo, 0xffffffff
pf_39:
    buffer_load_dword v7, v6, s[24:27], s38 offen sc1
    s_waitcnt vmcnt(0)
    v_cmp_eq_u32 vcc, 0, v7
    s_add_u32 s42, s42, 1
    s_cmp_gt_u32 s42, 30000
    s_cbranch_scc1 pfd_40
    s_cmp_eq_u64 vcc, 0
    s_cbranch_scc1 pfd_40
    s_sleep 6
    s_branch pf_39
pfd_40:
    s_mov_b64 exec, -1
    v_lshrrev_b32 v6, 3, v1
    v_and_b32 v7, 7, v1
    v_lshlrev_b32 v6, 12, v6
    v_lshl_add_u32 v6, v7, 4, v6
    s_lshl_b32 s38, s31, 18
    s_lshl_b32 s33, s30, 7
    s_add_u32 s38, s38, s33
    s_add_u32 s38, s38, 15728640
    s_mov_b32 m0, 0
    s_nop 0
    buffer_load_dwordx4 v6, s[24:27], s38 offen lds
    s_add_u32 s38, s38, 32768
    s_mov_b32 m0, 1024
    s_nop 0
    buffer_load_dwordx4 v6, s[24:27], s38 offen lds
    s_add_u32 s38, s38, 32768
    s_mov_b32 m0, 2048
    s_nop 0
    buffer_load_dwordx4 v6, s[24:27], s38 offen lds
    s_add_u32 s38, s38, 32768
    s_mov_b32 m0, 3072
    s_nop 0
    buffer_load_dwordx4 v6, s[24:27], s38 offen lds
    s_add_u32 s38, s38, 32768
    s_mov_b32 m0, 4096
    s_nop 0
    buffer_load_dwordx4 v6, s[24:27], s38 offen lds
    s_add_u32 s38, s38, 32768
    s_mov_b32 m0, 5120
    s_nop 0
    buffer_load_dwordx4 v6, s[24:27], s38 offen lds
    s_add_u32 s38, s38, 32768
    s_mov_b32 m0, 6144
    s_nop 0
    buffer_load_dwordx4 v6, s[24:27], s38 offen lds
    s_add_u32 s38, s38, 32768
    s_mov_b32 m0, 7168
    s_nop 0
    buffer_load_dwordx4 v6, s[24:27], s38 offen lds
    s_add_u32 s38, s38, 32768
gf_kernel_w7d:
    v_bfe_u32 v6, v1, 2, 2
    v_lshl_add_u32 v6, v4, 4, v6
    v_lshlrev_b32 v6, 7, v6
    v_and_b32 v7, 3, v1
    v_lshl_add_u32 v6, v7, 3, v6
    s_lshl_b32 s38, s32, 5
    s_and_b32 s33, s3, 1
    s_lshl_b32 s33, s33, 10
    s_add_u32 s38, s38, s33
    v_add_u32 v6, s38, v6
    s_mov_b32 s20, s62
    s_mov_b32 s21, s63
    s_mov_b32 s22, 1835008
    s_mov_b32 s23, 0x20000
    s_lshl_b32 s38, s3, 11
    s_add_u32 s38, s38, 8192
    v_add_u32 v7, s38, v5
    v_add_u32 v8, 65536, v7
    s_waitcnt vmcnt(0) lgkmcnt(0)
    s_barrier
    ds_read_b128 v[52:55], v7 offset:0
    ds_read_b128 v[56:59], v7 offset:1024
    ds_read_b128 v[60:63], v7 offset:16384
    ds_read_b128 v[64:67], v7 offset:17408
    ds_read_b128 v[68:71], v7 offset:32768
    ds_read_b128 v[72:75], v7 offset:33792
    ds_read_b128 v[76:79], v7 offset:49152
    ds_read_b128 v[80:83], v7 offset:50176
    ds_read_b128 v[84:87], v8 offset:0
    ds_read_b128 v[88:91], v8 offset:1024
    ds_read_b128 v[92:95], v8 offset:16384
    ds_read_b128 v[96:99], v8 offset:17408
    ds_read_b128 v[100:103], v8 offset:32768
    ds_read_b128 v[104:107], v8 offset:33792
    ds_read_b64_tr_b16 v[112:113], v6 offset:0
    ds_read_b64_tr_b16 v[114:115], v6 offset:512
    v_lshlrev_b32 v20, 16, v12
    v_and_b32 v21, 0xffff0000, v12
    v_lshlrev_b32 v22, 16, v13
    v_and_b32 v23, 0xffff0000, v13
    v_lshlrev_b32 v24, 16, v14
    v_and_b32 v25, 0xffff0000, v14
    v_lshlrev_b32 v26, 16, v15
    v_and_b32 v27, 0xffff0000, v15
    s_waitcnt lgkmcnt(0)
    v_lshlrev_b32 v28, 16, v112
    v_and_b32 v29, 0xffff0000, v112
    v_pk_add_f32 v[20:21], v[20:21], v[28:29]
    v_cvt_pk_bf16_f32 v12, v20, v21
    v_lshlrev_b32 v20, 16, v12
    v_and_b32 v21, 0xffff0000, v12
    v_pk_add_f32 v[52:53], v[52:53], v[60:61]
    v_pk_add_f32 v[68:69], v[68:69], v[76:77]
    v_pk_add_f32 v[84:85], v[84:85], v[92:93]
    v_pk_add_f32 v[52:53], v[52:53], v[68:69]
    v_pk_add_f32 v[84:85], v[84:85], v[100:101]
    v_pk_add_f32 v[52:53], v[52:53], v[84:85]
    v_cvt_pk_bf16_f32 v12, v52, v53
    v_lshlrev_b32 v52, 16, v12
    v_and_b32 v53, 0xffff0000, v12
    v_pk_add_f32 v[52:53], v[52:53], v[20:21]
    v_cvt_pk_bf16_f32 v12, v52, v53
    v_lshlrev_b32 v30, 16, v113
    v_and_b32 v31, 0xffff0000, v113
    v_pk_add_f32 v[22:23], v[22:23], v[30:31]
    v_cvt_pk_bf16_f32 v13, v22, v23
    v_lshlrev_b32 v22, 16, v13
    v_and_b32 v23, 0xffff0000, v13
    v_pk_add_f32 v[54:55], v[54:55], v[62:63]
    v_pk_add_f32 v[70:71], v[70:71], v[78:79]
    v_pk_add_f32 v[86:87], v[86:87], v[94:95]
    v_pk_add_f32 v[54:55], v[54:55], v[70:71]
    v_pk_add_f32 v[86:87], v[86:87], v[102:103]
    v_pk_add_f32 v[54:55], v[54:55], v[86:87]
    v_cvt_pk_bf16_f32 v13, v54, v55
    v_lshlrev_b32 v54, 16, v13
    v_and_b32 v55, 0xffff0000, v13
    v_pk_add_f32 v[54:55], v[54:55], v[22:23]
    v_cvt_pk_bf16_f32 v13, v54, v55
    v_lshlrev_b32 v32, 16, v114
    v_and_b32 v33, 0xffff0000, v114
    v_pk_add_f32 v[24:25], v[24:25], v[32:33]
    v_cvt_pk_bf16_f32 v14, v24, v25
    v_lshlrev_b32 v24, 16, v14
    v_and_b32 v25, 0xffff0000, v14
    v_pk_add_f32 v[56:57], v[56:57], v[64:65]
    v_pk_add_f32 v[72:73], v[72:73], v[80:81]
    v_pk_add_f32 v[88:89], v[88:89], v[96:97]
    v_pk_add_f32 v[56:57], v[56:57], v[72:73]
    v_pk_add_f32 v[88:89], v[88:89], v[104:105]
    v_pk_add_f32 v[56:57], v[56:57], v[88:89]
    v_cvt_pk_bf16_f32 v14, v56, v57
    v_lshlrev_b32 v56, 16, v14
    v_and_b32 v57, 0xffff0000, v14
    v_pk_add_f32 v[56:57], v[56:57], v[24:25]
    v_cvt_pk_bf16_f32 v14, v56, v57
    v_lshlrev_b32 v34, 16, v115
    v_and_b32 v35, 0xffff0000, v115
    v_pk_add_f32 v[26:27], v[26:27], v[34:35]
    v_cvt_pk_bf16_f32 v15, v26, v27
    v_lshlrev_b32 v26, 16, v15
    v_and_b32 v27, 0xffff0000, v15
    v_pk_add_f32 v[58:59], v[58:59], v[66:67]
    v_pk_add_f32 v[74:75], v[74:75], v[82:83]
    v_pk_add_f32 v[90:91], v[90:91], v[98:99]
    v_pk_add_f32 v[58:59], v[58:59], v[74:75]
    v_pk_add_f32 v[90:91], v[90:91], v[106:107]
    v_pk_add_f32 v[58:59], v[58:59], v[90:91]
    v_cvt_pk_bf16_f32 v15, v58, v59
    v_lshlrev_b32 v58, 16, v15
    v_and_b32 v59, 0xffff0000, v15
    v_pk_add_f32 v[58:59], v[58:59], v[26:27]
    v_cvt_pk_bf16_f32 v15, v58, v59
    buffer_store_dwordx4 v[12:15], v18, s[20:23], s67 offen
    s_endpgm
gf_kernel_prep:
    s_mov_b32 s16, s12
    s_mov_b32 s17, s13
    s_mov_b32 s18, 802816
    s_mov_b32 s19, 0x20000
    s_mov_b32 s24, s10
    s_mov_b32 s25, s11
    s_mov_b32 s26, 18874368
    s_mov_b32 s27, 0x20000
    s_mov_b32 s20, s14
    s_mov_b32 s21, s15
    s_mov_b32 s22, 8388608
    s_mov_b32 s23, 0x20000
    s_sub_u32 s30, s2, 224
    s_mul_i32 s31, s30, 28672
    v_lshlrev_b32 v3, 4, v0
    v_mov_b32 v8, 0
    v_mov_b32 v9, 0
    v_mov_b32 v10, 0
    v_mov_b32 v11, 0
    v_mov_b32 v12, -1
    v_mov_b32 v13, -1
    v_mov_b32 v14, -1
    v_mov_b32 v15, -1
    s_lshl_b32 s32, s30, 10
    s_add_u32 s32, s32, 18083840
    s_mul_i32 s33, s30, 3584
    s_add_u32 s33, s33, 17825792
    s_cmp_lg_u32 s3, 4
    s_cbranch_scc1 gf_kernel_cl1
    buffer_store_dwordx4 v[8:11], v3, s[24:27], s32 offen sc1
gf_kernel_cl1:
    s_cmp_ge_u32 s3, 4
    s_cbranch_scc1 gf_kernel_cl2
    v_cmp_gt_u32 vcc, 224, v0
    s_and_saveexec_b64 s[40:41], vcc
    buffer_store_dwordx4 v[12:15], v3, s[24:27], s33 offen sc1
    s_mov_b64 exec, s[40:41]
gf_kernel_cl2:
    s_waitcnt vmcnt(0)
    s_barrier
    s_cmp_lg_u32 s3, 0
    s_cbranch_scc1 gf_kernel_cl3
    v_mov_b32 v6, s30
    v_mov_b32 v7, 1
    s_mov_b64 exec, 1
    global_store_byte v6, v7, s[8:9] sc1
    s_mov_b64 exec, -1
gf_kernel_cl3:
    s_cmp_ge_u32 s30, 28
    s_cbranch_scc1 gf_kernel_pf
    s_add_u32 s32, s31, 0
    buffer_load_dwordx4 v[8:11], v3, s[16:19], s32 offen
    s_add_u32 s32, s31, 8192
    buffer_load_dwordx4 v[12:15], v3, s[16:19], s32 offen
    s_add_u32 s32, s31, 16384
    buffer_load_dwordx4 v[16:19], v3, s[16:19], s32 offen
    v_cmp_gt_u32 vcc, 256, v0
    s_and_saveexec_b64 s[40:41], vcc
    s_add_u32 s32, s31, 24576
    buffer_load_dwordx4 v[20:23], v3, s[16:19], s32 offen
    s_waitcnt vmcnt(0)
    ds_write_b128 v3, v[20:23] offset:24576
    s_mov_b64 exec, s[40:41]
    ds_write_b128 v3, v[8:11] offset:0
    ds_write_b128 v3, v[12:15] offset:8192
    ds_write_b128 v3, v[16:19] offset:16384
    s_waitcnt lgkmcnt(0)
    s_barrier
    v_lshrrev_b32 v4, 2, v1
    v_mul_u32_u24 v4, 896, v4
    v_and_b32 v5, 3, v1
    v_lshl_add_u32 v4, v5, 5, v4
    s_lshr_b32 s32, s3, 2
    s_lshl_b32 s32, s32, 7
    s_and_b32 s33, s3, 3
    s_lshl_b32 s33, s33, 3
    s_add_u32 s32, s32, s33
    v_add_u32 v4, s32, v4
    v_lshlrev_b32 v5, 4, v1
    s_mul_i32 s33, s3, 28672
    s_lshl_b32 s34, s30, 10
    s_add_u32 s33, s33, s34
    s_add_u32 s33, s33, 14680064
    ds_read_b64_tr_b16 v[8:9], v4 offset:0
    ds_read_b64_tr_b16 v[10:11], v4 offset:14336
    s_add_u32 s34, s33, 0
    s_waitcnt lgkmcnt(0)
    buffer_store_dwordx4 v[8:11], v5, s[24:27], s34 offen sc1
    ds_read_b64_tr_b16 v[12:13], v4 offset:256
    ds_read_b64_tr_b16 v[14:15], v4 offset:14592
    s_add_u32 s34, s33, 229376
    s_waitcnt lgkmcnt(0)
    buffer_store_dwordx4 v[12:15], v5, s[24:27], s34 offen sc1
    ds_read_b64_tr_b16 v[16:17], v4 offset:512
    ds_read_b64_tr_b16 v[18:19], v4 offset:14848
    s_add_u32 s34, s33, 458752
    s_waitcnt lgkmcnt(0)
    buffer_store_dwordx4 v[16:19], v5, s[24:27], s34 offen sc1
    s_cmp_ge_u32 s3, 4
    s_cbranch_scc1 gf_kernel_pf
    ds_read_b64_tr_b16 v[20:21], v4 offset:768
    ds_read_b64_tr_b16 v[22:23], v4 offset:15104
    s_add_u32 s34, s33, 688128
    s_waitcnt lgkmcnt(0)
    buffer_store_dwordx4 v[20:23], v5, s[24:27], s34 offen sc1
gf_kernel_pf:
    s_cmp_ge_u32 s30, 28
    s_cbranch_scc1 gf_kernel_pf2
    s_waitcnt vmcnt(0)
    s_barrier
    s_cmp_lg_u32 s3, 0
    s_cbranch_scc1 gf_kernel_pf2
    v_and_b32 v21, 7, v1
    v_lshlrev_b32 v21, 2, v21
    global_load_dword v28, v21, s[8:9] sc1
    s_waitcnt vmcnt(0)
    s_mov_b32 s42, 0
ck_41:
    v_cmp_ne_u32 vcc, 0x01010101, v28
    s_add_u32 s42, s42, 1
    s_cmp_gt_u32 s42, 30000
    s_cbranch_scc1 ckd_42
    s_cmp_eq_u64 vcc, 0
    s_cbranch_scc1 ckd_42
    s_sleep 2
    global_load_dword v28, v21, s[8:9] sc1
    s_waitcnt vmcnt(0)
    s_branch ck_41
ckd_42:
    s_lshl_b32 s33, s30, 2
    s_add_u32 s33, s33, 18119680
    v_mov_b32 v6, s33
    v_mov_b32 v7, 1
    s_mov_b64 exec, 1
    buffer_store_dword v7, v6, s[24:27], 0 offen sc1
    s_mov_b64 exec, -1
gf_kernel_pf2:
    s_sleep 60
    s_and_b32 s32, s30, 7
    s_lshr_b32 s32, s32, 1
    s_lshl_b32 s32, s32, 2
    s_lshr_b32 s33, s30, 3
    s_add_u32 s32, s32, s33
    s_lshl_b32 s32, s32, 19
    v_lshrrev_b32 v4, 4, v0
    v_lshlrev_b32 v4, 12, v4
    v_and_b32 v5, 15, v0
    v_lshl_add_u32 v4, v5, 4, v4
    s_add_u32 s33, s32, 0
    buffer_load_dwordx4 v[24:27], v4, s[20:23], s33 offen
    s_add_u32 s33, s32, 131072
    buffer_load_dwordx4 v[28:31], v4, s[20:23], s33 offen
    s_add_u32 s33, s32, 262144
    buffer_load_dwordx4 v[32:35], v4, s[20:23], s33 offen
    s_add_u32 s33, s32, 393216
    buffer_load_dwordx4 v[36:39], v4, s[20:23], s33 offen
    s_add_u32 s33, s32, 256
    buffer_load_dwordx4 v[40:43], v4, s[20:23], s33 offen
    s_add_u32 s33, s32, 131328
    buffer_load_dwordx4 v[44:47], v4, s[20:23], s33 offen
    s_add_u32 s33, s32, 262400
    buffer_load_dwordx4 v[48:51], v4, s[20:23], s33 offen
    s_add_u32 s33, s32, 393472
    buffer_load_dwordx4 v[52:55], v4, s[20:23], s33 offen
    s_add_u32 s33, s32, 512
    buffer_load_dwordx4 v[56:59], v4, s[20:23], s33 offen
    s_add_u32 s33, s32, 131584
    buffer_load_dwordx4 v[60:63], v4, s[20:23], s33 offen
    s_add_u32 s33, s32, 262656
    buffer_load_dwordx4 v[64:67], v4, s[20:23], s33 offen
    s_add_u32 s33, s32, 393728
    buffer_load_dwordx4 v[68:71], v4, s[20:23], s33 offen
    s_add_u32 s33, s32, 768
    buffer_load_dwordx4 v[72:75], v4, s[20:23], s33 offen
    s_add_u32 s33, s32, 131840
    buffer_load_dwordx4 v[76:79], v4, s[20:23], s33 offen
    s_add_u32 s33, s32, 262912
    buffer_load_dwordx4 v[80:83], v4, s[20:23], s33 offen
    s_add_u32 s33, s32, 393984
    buffer_load_dwordx4 v[84:87], v4, s[20:23], s33 offen
    s_add_u32 s33, s32, 1024
    buffer_load_dwordx4 v[88:91], v4, s[20:23], s33 offen
    s_add_u32 s33, s32, 132096
    buffer_load_dwordx4 v[92:95], v4, s[20:23], s33 offen
    s_add_u32 s33, s32, 263168
    buffer_load_dwordx4 v[96:99], v4, s[20:23], s33 offen
    s_add_u32 s33, s32, 394240
    buffer_load_dwordx4 v[100:103], v4, s[20:23], s33 offen
    s_add_u32 s33, s32, 1280
    buffer_load_dwordx4 v[104:107], v4, s[20:23], s33 offen
    s_add_u32 s33, s32, 132352
    buffer_load_dwordx4 v[108:111], v4, s[20:23], s33 offen
    s_add_u32 s33, s32, 263424
    buffer_load_dwordx4 v[112:115], v4, s[20:23], s33 offen
    s_add_u32 s33, s32, 394496
    buffer_load_dwordx4 v[116:119], v4, s[20:23], s33 offen
    s_add_u32 s33, s32, 1536
    buffer_load_dwordx4 v[120:123], v4, s[20:23], s33 offen
    s_add_u32 s33, s32, 132608
    buffer_load_dwordx4 v[124:127], v4, s[20:23], s33 offen
    s_add_u32 s33, s32, 263680
    buffer_load_dwordx4 v[128:131], v4, s[20:23], s33 offen
    s_add_u32 s33, s32, 394752
    buffer_load_dwordx4 v[132:135], v4, s[20:23], s33 offen
    s_add_u32 s33, s32, 1792
    buffer_load_dwordx4 v[136:139], v4, s[20:23], s33 offen
    s_add_u32 s33, s32, 132864
    buffer_load_dwordx4 v[140:143], v4, s[20:23], s33 offen
    s_add_u32 s33, s32, 263936
    buffer_load_dwordx4 v[144:147], v4, s[20:23], s33 offen
    s_add_u32 s33, s32, 395008
    buffer_load_dwordx4 v[148:151], v4, s[20:23], s33 offen
    s_add_u32 s33, s32, 2048
    buffer_load_dwordx4 v[152:155], v4, s[20:23], s33 offen
    s_add_u32 s33, s32, 133120
    buffer_load_dwordx4 v[156:159], v4, s[20:23], s33 offen
    s_add_u32 s33, s32, 264192
    buffer_load_dwordx4 v[160:163], v4, s[20:23], s33 offen
    s_add_u32 s33, s32, 395264
    buffer_load_dwordx4 v[164:167], v4, s[20:23], s33 offen
    s_add_u32 s33, s32, 2304
    buffer_load_dwordx4 v[168:171], v4, s[20:23], s33 offen
    s_add_u32 s33, s32, 133376
    buffer_load_dwordx4 v[172:175], v4, s[20:23], s33 offen
    s_add_u32 s33, s32, 264448
    buffer_load_dwordx4 v[176:179], v4, s[20:23], s33 offen
    s_add_u32 s33, s32, 395520
    buffer_load_dwordx4 v[180:183], v4, s[20:23], s33 offen
    s_add_u32 s33, s32, 2560
    buffer_load_dwordx4 v[184:187], v4, s[20:23], s33 offen
    s_add_u32 s33, s32, 133632
    buffer_load_dwordx4 v[188:191], v4, s[20:23], s33 offen
    s_add_u32 s33, s32, 264704
    buffer_load_dwordx4 v[192:195], v4, s[20:23], s33 offen
    s_add_u32 s33, s32, 395776
    buffer_load_dwordx4 v[196:199], v4, s[20:23], s33 offen
    s_add_u32 s33, s32, 2816
    buffer_load_dwordx4 v[200:203], v4, s[20:23], s33 offen
    s_add_u32 s33, s32, 133888
    buffer_load_dwordx4 v[204:207], v4, s[20:23], s33 offen
    s_add_u32 s33, s32, 264960
    buffer_load_dwordx4 v[208:211], v4, s[20:23], s33 offen
    s_add_u32 s33, s32, 396032
    buffer_load_dwordx4 v[212:215], v4, s[20:23], s33 offen
    s_waitcnt vmcnt(47)
    s_add_u32 s33, s32, 3072
    buffer_load_dwordx4 v[24:27], v4, s[20:23], s33 offen
    s_waitcnt vmcnt(47)
    s_add_u32 s33, s32, 134144
    buffer_load_dwordx4 v[28:31], v4, s[20:23], s33 offen
    s_waitcnt vmcnt(47)
    s_add_u32 s33, s32, 265216
    buffer_load_dwordx4 v[32:35], v4, s[20:23], s33 offen
    s_waitcnt vmcnt(47)
    s_add_u32 s33, s32, 396288
    buffer_load_dwordx4 v[36:39], v4, s[20:23], s33 offen
    s_waitcnt vmcnt(47)
    s_add_u32 s33, s32, 3328
    buffer_load_dwordx4 v[40:43], v4, s[20:23], s33 offen
    s_waitcnt vmcnt(47)
    s_add_u32 s33, s32, 134400
    buffer_load_dwordx4 v[44:47], v4, s[20:23], s33 offen
    s_waitcnt vmcnt(47)
    s_add_u32 s33, s32, 265472
    buffer_load_dwordx4 v[48:51], v4, s[20:23], s33 offen
    s_waitcnt vmcnt(47)
    s_add_u32 s33, s32, 396544
    buffer_load_dwordx4 v[52:55], v4, s[20:23], s33 offen
    s_waitcnt vmcnt(47)
    s_add_u32 s33, s32, 3584
    buffer_load_dwordx4 v[56:59], v4, s[20:23], s33 offen
    s_waitcnt vmcnt(47)
    s_add_u32 s33, s32, 134656
    buffer_load_dwordx4 v[60:63], v4, s[20:23], s33 offen
    s_waitcnt vmcnt(47)
    s_add_u32 s33, s32, 265728
    buffer_load_dwordx4 v[64:67], v4, s[20:23], s33 offen
    s_waitcnt vmcnt(47)
    s_add_u32 s33, s32, 396800
    buffer_load_dwordx4 v[68:71], v4, s[20:23], s33 offen
    s_waitcnt vmcnt(47)
    s_add_u32 s33, s32, 3840
    buffer_load_dwordx4 v[72:75], v4, s[20:23], s33 offen
    s_waitcnt vmcnt(47)
    s_add_u32 s33, s32, 134912
    buffer_load_dwordx4 v[76:79], v4, s[20:23], s33 offen
    s_waitcnt vmcnt(47)
    s_add_u32 s33, s32, 265984
    buffer_load_dwordx4 v[80:83], v4, s[20:23], s33 offen
    s_waitcnt vmcnt(47)
    s_add_u32 s33, s32, 397056
    buffer_load_dwordx4 v[84:87], v4, s[20:23], s33 offen
    s_waitcnt vmcnt(0)
gf_kernel_end:
    s_endpgm
.section .rodata,"a"
.p2align 6
.amdhsa_kernel gf_kernel
  .amdhsa_next_free_vgpr 256
  .amdhsa_next_free_sgpr 102
  .amdhsa_accum_offset 256
  .amdhsa_group_segment_fixed_size 0
  .amdhsa_kernarg_size 120
  .amdhsa_user_sgpr_count 2
  .amdhsa_user_sgpr_kernarg_segment_ptr 1
  .amdhsa_system_sgpr_workgroup_id_x 1
.end_amdhsa_kernel
```
